```python
import torch

def _softmax(x, axis=-1):
    return torch.softmax(x, dim=axis)
def _gelu(x):
    return torch.nn.functional.gelu(x, approximate="tanh")
def _silu(x):
    return torch.nn.functional.silu(x)
def _sigmoid(x):
    return torch.sigmoid(x)
def _layernorm(x, axis=-1, eps=1e-5):
    m = x.mean(dim=axis, keepdim=True)
    v = x.var(dim=axis, keepdim=True, unbiased=False)
    return (x - m) / torch.sqrt(v + eps)
def _scatter_add(tgt, idx, src, axis=0):
    return tgt.clone().index_add_(axis, idx, src)
def _segment_sum(src, seg, n):
    out = torch.zeros((n,) + src.shape[1:], dtype=src.dtype)
    return out.index_add_(0, seg, src)
def _pad(x, pw):
    flat = tuple(v for pair in reversed(pw) for v in pair)
    return torch.nn.functional.pad(x, flat)

kernel_name = 'standalone__mha_block_cached__near_ridge'

def setup_inputs():

    _w = (lambda a: (lambda t: t.to(torch.bfloat16) if t.is_floating_point() else t)(torch.as_tensor(a)))
    B, Sq, D = 8, 96, 512
    H, Sk, Dh = 32, 512, 128
    return {
        "x": _w((lambda *s: torch.randn(*s, dtype=torch.bfloat16) * 0.8)(B, Sq, D)),
        "k_cache": _w((lambda *s: torch.randn(*s, dtype=torch.bfloat16) * 0.8)(B, H, Sk, Dh)),
        "v_cache": _w((lambda *s: torch.randn(*s, dtype=torch.bfloat16) * 0.05)(B, H, Sk, Dh)),
        "wq": _w((lambda *s: torch.randn(*s, dtype=torch.bfloat16) * 0.8)(D, H * Dh) * (D ** -0.5)),
        "wo": _w((lambda *s: torch.randn(*s, dtype=torch.bfloat16) * 0.05)(H * Dh, D) * ((H * Dh) ** -0.5)),
    }

def reference(x, k_cache, v_cache, wq, wo):
    B, Sq, D = x.shape
    H, Dh = 32, 128
    q = (lambda x, *d: x.permute(*d))((x @ wq).reshape(B, Sq, H, Dh), 0, 2, 1, 3)
    scores = torch.einsum("bhqd,bhkd->bhqk", q, k_cache) * (Dh ** -0.5)
    p = _softmax(scores, axis=-1)
    o = torch.einsum("bhqk,bhkd->bhqd", p, v_cache)
    return (lambda x, *d: x.permute(*d))(o, 0, 2, 1, 3).reshape(B, Sq, H * Dh) @ wo
```

```asm
; @launch grid=(256,1,1) block=(256,1,1) lds=163840
.amdgcn_target "amdgcn-amd-amdhsa--gfx950"
.text
.globl standalone__mha_block_cached__near_ridge_kernel
.p2align 8
.type standalone__mha_block_cached__near_ridge_kernel,@function
standalone__mha_block_cached__near_ridge_kernel:
    s_cmp_ge_u32 s2, 256
    s_cbranch_scc1 A_end
    s_load_dwordx16 s[4:19], s[0:1], 0
    s_mov_b32 s57, 1000000
    v_lshrrev_b32 v1, 6, v0
    s_getpc_b64 s[34:35]
A_pc:
    s_sub_u32 s34, s34, A_pc-standalone__mha_block_cached__near_ridge_kernel
    s_subb_u32 s35, s35, 0
    s_lshr_b32 s22, s2, 3
    v_and_b32 v2, 3, v0
    v_lshl_add_u32 v2, v1, 7, v2
    v_lshl_add_u32 v2, s22, 2, v2
    v_lshlrev_b32 v2, 7, v2
    v_min_u32 v2, A_codeend-standalone__mha_block_cached__near_ridge_kernel-4, v2
    global_load_dword v25, v2, s[34:35]
    v_and_b32 v0, 63, v0
    v_readfirstlane_b32 s3, v1
    s_and_b32 s20, s2, 3
    s_lshl_b32 s20, s20, 3
    s_lshr_b32 s22, s2, 3
    s_and_b32 s23, s22, 7
    s_add_u32 s20, s20, s23
    s_bfe_u32 s21, s2, 0x10002
    s_lshl_b32 s21, s21, 2
    s_lshr_b32 s22, s22, 3
    s_add_u32 s21, s21, s22
    s_cmp_lg_u32 s3, 0
    s_cbranch_scc1 A_compute
    v_lshrrev_b32 v1, 4, v0
    v_and_b32 v2, 15, v0
    v_and_b32 v3, 7, v0
    v_xor_b32 v3, v3, v1
    v_lshlrev_b32 v3, 4, v3
    v_lshrrev_b32 v30, 3, v0
    v_lshl_add_u32 v8, v30, 10, v3
    v_xor_b32 v9, 64, v8
    v_add_u32 v9, 7168, v9
    v_add_u32 v10, 14336, v8
    v_add_u32 v11, 14336, v9
    v_lshlrev_b32 v3, 2, v1
    v_xor_b32 v3, v2, v3
    v_lshlrev_b32 v3, 4, v3
    v_lshl_add_u32 v12, v1, 13, v3
    v_add_u32 v13, 31744, v12
    v_add_u32 v14, 63488, v12
    v_add_u32 v15, 95232, v12
    v_mov_b32 v17, 163584
    v_mov_b32 v20, 0
    v_mov_b32 v24, 0
    s_add_u32 s58, s21, s20
    s_and_b32 s58, s58, 3
    s_lshl_b32 s58, s58, 8
    s_mov_b32 s54, 0
    s_mul_i32 s22, s21, 98304
    s_lshl_b32 s23, s20, 8
    s_waitcnt lgkmcnt(0)
    s_add_u32 s24, s4, s22
    s_addc_u32 s25, s5, 0
    s_mov_b32 s26, 98304
    s_mov_b32 s27, 0x20000
    s_add_u32 s36, s10, s23
    s_addc_u32 s37, s11, 0
    s_mov_b32 s38, 0
    s_mov_b32 s39, 0x20000
    s_sub_u32 s38, 0x400000, s23
    s_mov_b32 m0, 0
    s_add_u32 s59, s58, 0
    s_and_b32 s59, s59, 1023
    s_add_u32 s52, s59, 0
    buffer_load_dwordx4 v8, s[24:27], s52 offen sc1 lds
    buffer_load_dwordx4 v9, s[24:27], s52 offen offset:1024 sc1 lds
    buffer_load_dwordx4 v10, s[24:27], s52 offen offset:2048 sc1 lds
    buffer_load_dwordx4 v11, s[24:27], s52 offen offset:3072 sc1 lds
    s_mov_b32 m0, 4096
    s_add_u32 s52, s59, 32768
    buffer_load_dwordx4 v8, s[24:27], s52 offen sc1 lds
    buffer_load_dwordx4 v9, s[24:27], s52 offen offset:1024 sc1 lds
    buffer_load_dwordx4 v10, s[24:27], s52 offen offset:2048 sc1 lds
    buffer_load_dwordx4 v11, s[24:27], s52 offen offset:3072 sc1 lds
    s_mov_b32 m0, 8192
    s_add_u32 s52, s59, 65536
    buffer_load_dwordx4 v8, s[24:27], s52 offen sc1 lds
    buffer_load_dwordx4 v9, s[24:27], s52 offen offset:1024 sc1 lds
    buffer_load_dwordx4 v10, s[24:27], s52 offen offset:2048 sc1 lds
    buffer_load_dwordx4 v11, s[24:27], s52 offen offset:3072 sc1 lds
    s_mov_b32 m0, 81920
    s_add_u32 s55, s58, 0
    s_and_b32 s55, s55, 1023
    s_lshl_b32 s55, s55, 12
    s_add_u32 s52, s55, 0
    buffer_load_dwordx4 v12, s[36:39], s52 offen sc1 lds
    buffer_load_dwordx4 v13, s[36:39], s52 offen offset:1024 sc1 lds
    buffer_load_dwordx4 v14, s[36:39], s52 offen offset:2048 sc1 lds
    buffer_load_dwordx4 v15, s[36:39], s52 offen offset:3072 sc1 lds
    s_mov_b32 m0, 86016
    s_add_u32 s52, s55, 131072
    buffer_load_dwordx4 v12, s[36:39], s52 offen sc1 lds
    buffer_load_dwordx4 v13, s[36:39], s52 offen offset:1024 sc1 lds
    buffer_load_dwordx4 v14, s[36:39], s52 offen offset:2048 sc1 lds
    buffer_load_dwordx4 v15, s[36:39], s52 offen offset:3072 sc1 lds
    v_xor_b32 v3, v2, v1
    v_lshlrev_b32 v3, 4, v3
    v_lshl_add_u32 v4, v1, 8, v3
    v_xor_b32 v5, 64, v4
    v_xor_b32 v6, 128, v4
    v_xor_b32 v7, 192, v4
    v_lshlrev_b32 v18, 4, v0
    v_mov_b32 v41, 384
    s_add_u32 s22, s20, s21
    s_add_u32 s23, s22, 0
    s_and_b32 s23, s23, 3
    s_lshl_b32 s84, s23, 12
    s_lshl_b32 s88, s23, 13
    v_add_u32 v48, s84, v18
    s_add_u32 s23, s22, 1
    s_and_b32 s23, s23, 3
    s_lshl_b32 s85, s23, 12
    s_lshl_b32 s89, s23, 13
    v_add_u32 v49, s85, v18
    s_add_u32 s23, s22, 2
    s_and_b32 s23, s23, 3
    s_lshl_b32 s86, s23, 12
    s_lshl_b32 s90, s23, 13
    v_add_u32 v50, s86, v18
    s_add_u32 s23, s22, 3
    s_and_b32 s23, s23, 3
    s_lshl_b32 s87, s23, 12
    s_lshl_b32 s91, s23, 13
    v_add_u32 v51, s87, v18
    s_lshl_b32 s22, s21, 5
    s_add_u32 s22, s22, s20
    s_lshl_b32 s22, s22, 17
    s_add_u32 s28, s6, s22
    s_addc_u32 s29, s7, 0
    s_mov_b32 s30, 131072
    s_mov_b32 s31, 0x20000
    s_add_u32 s32, s8, s22
    s_addc_u32 s33, s9, 0
    s_mov_b32 s34, 131072
    s_mov_b32 s35, 0x20000
    v_and_b32 v2, 7, v0
    v_bfe_u32 v3, v0, 4, 1
    v_lshlrev_b32 v3, 2, v3
    v_xor_b32 v2, v2, v3
    v_lshlrev_b32 v2, 4, v2
    v_lshl_add_u32 v32, v30, 10, v2
    v_add_u32 v33, 7168, v32
    v_add_u32 v34, 14336, v32
    v_add_u32 v35, 21504, v32
    v_lshl_add_u32 v36, v30, 8, v2
    v_add_u32 v37, 1024, v36
    v_add_u32 v38, 2048, v36
    v_add_u32 v39, 3072, v36
    s_lshr_b32 s22, s20, 3
    s_lshl_b32 s22, s22, 20
    s_and_b32 s23, s20, 7
    s_lshl_b32 s23, s23, 7
    s_add_u32 s22, s22, s23
    s_add_u32 s44, s12, s22
    s_addc_u32 s45, s13, 0
    s_mov_b32 s46, 0
    s_mov_b32 s47, 0x20000
    s_sub_u32 s46, 0x400000, s22
    s_and_b32 s22, s21, 0
    s_lshl_b32 s22, s22, 1
    s_add_u32 s53, s20, s22
    s_mov_b32 m0, 12288
    s_add_u32 s59, s58, 128
    s_and_b32 s59, s59, 1023
    s_add_u32 s52, s59, 0
    buffer_load_dwordx4 v8, s[24:27], s52 offen sc1 lds
    buffer_load_dwordx4 v9, s[24:27], s52 offen offset:1024 sc1 lds
    buffer_load_dwordx4 v10, s[24:27], s52 offen offset:2048 sc1 lds
    buffer_load_dwordx4 v11, s[24:27], s52 offen offset:3072 sc1 lds
    s_mov_b32 m0, 16384
    s_add_u32 s52, s59, 32768
    buffer_load_dwordx4 v8, s[24:27], s52 offen sc1 lds
    buffer_load_dwordx4 v9, s[24:27], s52 offen offset:1024 sc1 lds
    buffer_load_dwordx4 v10, s[24:27], s52 offen offset:2048 sc1 lds
    buffer_load_dwordx4 v11, s[24:27], s52 offen offset:3072 sc1 lds
    s_mov_b32 m0, 20480
    s_add_u32 s52, s59, 65536
    buffer_load_dwordx4 v8, s[24:27], s52 offen sc1 lds
    buffer_load_dwordx4 v9, s[24:27], s52 offen offset:1024 sc1 lds
    buffer_load_dwordx4 v10, s[24:27], s52 offen offset:2048 sc1 lds
    buffer_load_dwordx4 v11, s[24:27], s52 offen offset:3072 sc1 lds
    s_waitcnt vmcnt(28)
    s_mov_b32 m0, 24576
    s_add_u32 s55, s58, 64
    s_and_b32 s55, s55, 1023
    s_lshl_b32 s55, s55, 12
    s_add_u32 s52, s55, 0
    buffer_load_dwordx4 v12, s[36:39], s52 offen sc1 lds
    buffer_load_dwordx4 v13, s[36:39], s52 offen offset:1024 sc1 lds
    buffer_load_dwordx4 v14, s[36:39], s52 offen offset:2048 sc1 lds
    buffer_load_dwordx4 v15, s[36:39], s52 offen offset:3072 sc1 lds
    s_waitcnt vmcnt(28)
    s_mov_b32 m0, 28672
    s_add_u32 s52, s55, 131072
    buffer_load_dwordx4 v12, s[36:39], s52 offen sc1 lds
    buffer_load_dwordx4 v13, s[36:39], s52 offen offset:1024 sc1 lds
    buffer_load_dwordx4 v14, s[36:39], s52 offen offset:2048 sc1 lds
    buffer_load_dwordx4 v15, s[36:39], s52 offen offset:3072 sc1 lds
    ds_write_b32 v17, v20
    ds_write_b32 v17, v20 offset:4
    s_waitcnt lgkmcnt(0)
    s_barrier
    s_waitcnt vmcnt(28)
    s_mov_b32 m0, 32768
    s_add_u32 s55, s58, 128
    s_and_b32 s55, s55, 1023
    s_lshl_b32 s55, s55, 12
    s_add_u32 s52, s55, 0
    buffer_load_dwordx4 v12, s[36:39], s52 offen sc1 lds
    buffer_load_dwordx4 v13, s[36:39], s52 offen offset:1024 sc1 lds
    buffer_load_dwordx4 v14, s[36:39], s52 offen offset:2048 sc1 lds
    buffer_load_dwordx4 v15, s[36:39], s52 offen offset:3072 sc1 lds
    s_waitcnt vmcnt(28)
    s_mov_b32 m0, 36864
    s_add_u32 s52, s55, 131072
    buffer_load_dwordx4 v12, s[36:39], s52 offen sc1 lds
    buffer_load_dwordx4 v13, s[36:39], s52 offen offset:1024 sc1 lds
    buffer_load_dwordx4 v14, s[36:39], s52 offen offset:2048 sc1 lds
    buffer_load_dwordx4 v15, s[36:39], s52 offen offset:3072 sc1 lds
    s_waitcnt vmcnt(28)
    s_max_u32 s54, s54, 1
    v_mov_b32 v20, s54
    ds_write_b32 v17, v20
    s_mov_b32 m0, 53248
    s_add_u32 s55, s58, 192
    s_and_b32 s55, s55, 1023
    s_lshl_b32 s55, s55, 12
    s_add_u32 s52, s55, 0
    buffer_load_dwordx4 v12, s[36:39], s52 offen sc1 lds
    buffer_load_dwordx4 v13, s[36:39], s52 offen offset:1024 sc1 lds
    buffer_load_dwordx4 v14, s[36:39], s52 offen offset:2048 sc1 lds
    buffer_load_dwordx4 v15, s[36:39], s52 offen offset:3072 sc1 lds
    s_waitcnt vmcnt(28)
    s_mov_b32 m0, 57344
    s_add_u32 s52, s55, 131072
    buffer_load_dwordx4 v12, s[36:39], s52 offen sc1 lds
    buffer_load_dwordx4 v13, s[36:39], s52 offen offset:1024 sc1 lds
    buffer_load_dwordx4 v14, s[36:39], s52 offen offset:2048 sc1 lds
    buffer_load_dwordx4 v15, s[36:39], s52 offen offset:3072 sc1 lds
    s_waitcnt vmcnt(28)
    s_mov_b32 m0, 40960
    s_add_u32 s59, s58, 256
    s_and_b32 s59, s59, 1023
    s_add_u32 s52, s59, 0
    buffer_load_dwordx4 v8, s[24:27], s52 offen sc1 lds
    buffer_load_dwordx4 v9, s[24:27], s52 offen offset:1024 sc1 lds
    buffer_load_dwordx4 v10, s[24:27], s52 offen offset:2048 sc1 lds
    buffer_load_dwordx4 v11, s[24:27], s52 offen offset:3072 sc1 lds
    s_waitcnt vmcnt(28)
    s_mov_b32 m0, 45056
    s_add_u32 s52, s59, 32768
    buffer_load_dwordx4 v8, s[24:27], s52 offen sc1 lds
    buffer_load_dwordx4 v9, s[24:27], s52 offen offset:1024 sc1 lds
    buffer_load_dwordx4 v10, s[24:27], s52 offen offset:2048 sc1 lds
    buffer_load_dwordx4 v11, s[24:27], s52 offen offset:3072 sc1 lds
    s_waitcnt vmcnt(28)
    s_mov_b32 m0, 49152
    s_add_u32 s52, s59, 65536
    buffer_load_dwordx4 v8, s[24:27], s52 offen sc1 lds
    buffer_load_dwordx4 v9, s[24:27], s52 offen offset:1024 sc1 lds
    buffer_load_dwordx4 v10, s[24:27], s52 offen offset:2048 sc1 lds
    buffer_load_dwordx4 v11, s[24:27], s52 offen offset:3072 sc1 lds
    s_xor_b32 s22, s21, s20
    s_bitcmp1_b32 s22, 0
    s_cbranch_scc1 A_loadB
    s_waitcnt vmcnt(28)
    s_max_u32 s54, s54, 2
    v_mov_b32 v20, s54
    ds_write_b32 v17, v20
    s_mov_b32 m0, 61440
    s_add_u32 s55, s58, 256
    s_and_b32 s55, s55, 1023
    s_lshl_b32 s55, s55, 12
    s_add_u32 s52, s55, 0
    buffer_load_dwordx4 v12, s[36:39], s52 offen sc1 lds
    buffer_load_dwordx4 v13, s[36:39], s52 offen offset:1024 sc1 lds
    buffer_load_dwordx4 v14, s[36:39], s52 offen offset:2048 sc1 lds
    buffer_load_dwordx4 v15, s[36:39], s52 offen offset:3072 sc1 lds
    s_waitcnt vmcnt(28)
    s_mov_b32 m0, 65536
    s_add_u32 s52, s55, 131072
    buffer_load_dwordx4 v12, s[36:39], s52 offen sc1 lds
    buffer_load_dwordx4 v13, s[36:39], s52 offen offset:1024 sc1 lds
    buffer_load_dwordx4 v14, s[36:39], s52 offen offset:2048 sc1 lds
    buffer_load_dwordx4 v15, s[36:39], s52 offen offset:3072 sc1 lds
    s_waitcnt vmcnt(28)
    s_max_u32 s54, s54, 3
    v_mov_b32 v20, s54
    ds_write_b32 v17, v20
    s_mov_b32 m0, 69632
    s_add_u32 s59, s58, 384
    s_and_b32 s59, s59, 1023
    s_add_u32 s52, s59, 0
    buffer_load_dwordx4 v8, s[24:27], s52 offen sc1 lds
    buffer_load_dwordx4 v9, s[24:27], s52 offen offset:1024 sc1 lds
    buffer_load_dwordx4 v10, s[24:27], s52 offen offset:2048 sc1 lds
    buffer_load_dwordx4 v11, s[24:27], s52 offen offset:3072 sc1 lds
    s_waitcnt vmcnt(28)
    s_mov_b32 m0, 73728
    s_add_u32 s52, s59, 32768
    buffer_load_dwordx4 v8, s[24:27], s52 offen sc1 lds
    buffer_load_dwordx4 v9, s[24:27], s52 offen offset:1024 sc1 lds
    buffer_load_dwordx4 v10, s[24:27], s52 offen offset:2048 sc1 lds
    buffer_load_dwordx4 v11, s[24:27], s52 offen offset:3072 sc1 lds
    s_waitcnt vmcnt(28)
    s_max_u32 s54, s54, 4
    v_mov_b32 v20, s54
    ds_write_b32 v17, v20
    s_mov_b32 m0, 77824
    s_add_u32 s52, s59, 65536
    buffer_load_dwordx4 v8, s[24:27], s52 offen sc1 lds
    buffer_load_dwordx4 v9, s[24:27], s52 offen offset:1024 sc1 lds
    buffer_load_dwordx4 v10, s[24:27], s52 offen offset:2048 sc1 lds
    buffer_load_dwordx4 v11, s[24:27], s52 offen offset:3072 sc1 lds
    s_waitcnt vmcnt(28)
    v_cmp_lt_u32 vcc, 0, v24
    s_cbranch_vccnz A_lA1_ok
    s_cmp_ge_u32 s54, 5
    s_cbranch_scc1 A_lA1_5
    ds_read_b96 v[24:26], v17 offset:16
    s_waitcnt lgkmcnt(0)
    v_min3_u32 v24, v24, v25, v26
    v_cmp_lt_u32 vcc, 0, v24
    s_cbranch_vccnz A_lA1_ok
    s_waitcnt vmcnt(12)
    s_max_u32 s54, s54, 5
    v_mov_b32 v20, s54
    ds_write_b32 v17, v20
A_lA1_5:
A_lA1:
    s_sub_u32 s57, s57, 1
    s_cbranch_scc1 A_end
    ds_read_b96 v[24:26], v17 offset:16
    s_waitcnt lgkmcnt(0)
    v_min3_u32 v24, v24, v25, v26
    v_cmp_lt_u32 vcc, 0, v24
    s_cbranch_vccz A_lA1
A_lA1_ok:
    s_mov_b32 m0, 81920
    s_add_u32 s55, s58, 320
    s_and_b32 s55, s55, 1023
    s_lshl_b32 s55, s55, 12
    s_add_u32 s52, s55, 0
    buffer_load_dwordx4 v12, s[36:39], s52 offen sc1 lds
    buffer_load_dwordx4 v13, s[36:39], s52 offen offset:1024 sc1 lds
    buffer_load_dwordx4 v14, s[36:39], s52 offen offset:2048 sc1 lds
    buffer_load_dwordx4 v15, s[36:39], s52 offen offset:3072 sc1 lds
    s_waitcnt vmcnt(28)
    s_mov_b32 m0, 86016
    s_add_u32 s52, s55, 131072
    buffer_load_dwordx4 v12, s[36:39], s52 offen sc1 lds
    buffer_load_dwordx4 v13, s[36:39], s52 offen offset:1024 sc1 lds
    buffer_load_dwordx4 v14, s[36:39], s52 offen offset:2048 sc1 lds
    buffer_load_dwordx4 v15, s[36:39], s52 offen offset:3072 sc1 lds
    s_waitcnt vmcnt(28)
    v_cmp_lt_u32 vcc, 1, v24
    s_cbranch_vccnz A_lA2_ok
    s_cmp_ge_u32 s54, 5
    s_cbranch_scc1 A_lA2_5
    ds_read_b96 v[24:26], v17 offset:16
    s_waitcnt lgkmcnt(0)
    v_min3_u32 v24, v24, v25, v26
    v_cmp_lt_u32 vcc, 1, v24
    s_cbranch_vccnz A_lA2_ok
    s_waitcnt vmcnt(20)
    s_max_u32 s54, s54, 5
    v_mov_b32 v20, s54
    ds_write_b32 v17, v20
A_lA2_5:
    s_cmp_ge_u32 s54, 6
    s_cbranch_scc1 A_lA2_6
    ds_read_b96 v[24:26], v17 offset:16
    s_waitcnt lgkmcnt(0)
    v_min3_u32 v24, v24, v25, v26
    v_cmp_lt_u32 vcc, 1, v24
    s_cbranch_vccnz A_lA2_ok
    s_waitcnt vmcnt(0)
    s_max_u32 s54, s54, 6
    v_mov_b32 v20, s54
    ds_write_b32 v17, v20
A_lA2_6:
A_lA2:
    s_sub_u32 s57, s57, 1
    s_cbranch_scc1 A_end
    ds_read_b96 v[24:26], v17 offset:16
    s_waitcnt lgkmcnt(0)
    v_min3_u32 v24, v24, v25, v26
    v_cmp_lt_u32 vcc, 1, v24
    s_cbranch_vccz A_lA2
A_lA2_ok:
    s_mov_b32 m0, 24576
    s_add_u32 s55, s58, 384
    s_and_b32 s55, s55, 1023
    s_lshl_b32 s55, s55, 12
    s_add_u32 s52, s55, 0
    buffer_load_dwordx4 v12, s[36:39], s52 offen sc1 lds
    buffer_load_dwordx4 v13, s[36:39], s52 offen offset:1024 sc1 lds
    buffer_load_dwordx4 v14, s[36:39], s52 offen offset:2048 sc1 lds
    buffer_load_dwordx4 v15, s[36:39], s52 offen offset:3072 sc1 lds
    s_waitcnt vmcnt(28)
    s_mov_b32 m0, 28672
    s_add_u32 s52, s55, 131072
    buffer_load_dwordx4 v12, s[36:39], s52 offen sc1 lds
    buffer_load_dwordx4 v13, s[36:39], s52 offen offset:1024 sc1 lds
    buffer_load_dwordx4 v14, s[36:39], s52 offen offset:2048 sc1 lds
    buffer_load_dwordx4 v15, s[36:39], s52 offen offset:3072 sc1 lds
    s_waitcnt vmcnt(28)
    s_max_u32 s54, s54, 5
    v_mov_b32 v20, s54
    ds_write_b32 v17, v20
    s_mov_b32 m0, 0
    s_add_u32 s59, s58, 512
    s_and_b32 s59, s59, 1023
    s_add_u32 s52, s59, 0
    buffer_load_dwordx4 v8, s[24:27], s52 offen sc1 lds
    buffer_load_dwordx4 v9, s[24:27], s52 offen offset:1024 sc1 lds
    buffer_load_dwordx4 v10, s[24:27], s52 offen offset:2048 sc1 lds
    buffer_load_dwordx4 v11, s[24:27], s52 offen offset:3072 sc1 lds
    s_waitcnt vmcnt(28)
    s_mov_b32 m0, 4096
    s_add_u32 s52, s59, 32768
    buffer_load_dwordx4 v8, s[24:27], s52 offen sc1 lds
    buffer_load_dwordx4 v9, s[24:27], s52 offen offset:1024 sc1 lds
    buffer_load_dwordx4 v10, s[24:27], s52 offen offset:2048 sc1 lds
    buffer_load_dwordx4 v11, s[24:27], s52 offen offset:3072 sc1 lds
    s_waitcnt vmcnt(28)
    s_mov_b32 m0, 8192
    s_add_u32 s52, s59, 65536
    buffer_load_dwordx4 v8, s[24:27], s52 offen sc1 lds
    buffer_load_dwordx4 v9, s[24:27], s52 offen offset:1024 sc1 lds
    buffer_load_dwordx4 v10, s[24:27], s52 offen offset:2048 sc1 lds
    buffer_load_dwordx4 v11, s[24:27], s52 offen offset:3072 sc1 lds
    s_waitcnt vmcnt(28)
    v_cmp_lt_u32 vcc, 2, v24
    s_cbranch_vccnz A_lA3_ok
    s_cmp_ge_u32 s54, 6
    s_cbranch_scc1 A_lA3_6
    ds_read_b96 v[24:26], v17 offset:16
    s_waitcnt lgkmcnt(0)
    v_min3_u32 v24, v24, v25, v26
    v_cmp_lt_u32 vcc, 2, v24
    s_cbranch_vccnz A_lA3_ok
    s_waitcnt vmcnt(20)
    s_max_u32 s54, s54, 6
    v_mov_b32 v20, s54
    ds_write_b32 v17, v20
A_lA3_6:
    s_cmp_ge_u32 s54, 7
    s_cbranch_scc1 A_lA3_7
    ds_read_b96 v[24:26], v17 offset:16
    s_waitcnt lgkmcnt(0)
    v_min3_u32 v24, v24, v25, v26
    v_cmp_lt_u32 vcc, 2, v24
    s_cbranch_vccnz A_lA3_ok
    s_waitcnt vmcnt(12)
    s_max_u32 s54, s54, 7
    v_mov_b32 v20, s54
    ds_write_b32 v17, v20
A_lA3_7:
A_lA3:
    s_sub_u32 s57, s57, 1
    s_cbranch_scc1 A_end
    ds_read_b96 v[24:26], v17 offset:16
    s_waitcnt lgkmcnt(0)
    v_min3_u32 v24, v24, v25, v26
    v_cmp_lt_u32 vcc, 2, v24
    s_cbranch_vccz A_lA3
A_lA3_ok:
    s_mov_b32 m0, 32768
    s_add_u32 s55, s58, 448
    s_and_b32 s55, s55, 1023
    s_lshl_b32 s55, s55, 12
    s_add_u32 s52, s55, 0
    buffer_load_dwordx4 v12, s[36:39], s52 offen sc1 lds
    buffer_load_dwordx4 v13, s[36:39], s52 offen offset:1024 sc1 lds
    buffer_load_dwordx4 v14, s[36:39], s52 offen offset:2048 sc1 lds
    buffer_load_dwordx4 v15, s[36:39], s52 offen offset:3072 sc1 lds
    s_waitcnt vmcnt(28)
    s_mov_b32 m0, 36864
    s_add_u32 s52, s55, 131072
    buffer_load_dwordx4 v12, s[36:39], s52 offen sc1 lds
    buffer_load_dwordx4 v13, s[36:39], s52 offen offset:1024 sc1 lds
    buffer_load_dwordx4 v14, s[36:39], s52 offen offset:2048 sc1 lds
    buffer_load_dwordx4 v15, s[36:39], s52 offen offset:3072 sc1 lds
    s_waitcnt vmcnt(28)
    s_max_u32 s54, s54, 6
    v_mov_b32 v20, s54
    ds_write_b32 v17, v20
    v_cmp_lt_u32 vcc, 3, v24
    s_cbranch_vccnz A_lA4_ok
    s_cmp_ge_u32 s54, 7
    s_cbranch_scc1 A_lA4_7
    ds_read_b96 v[24:26], v17 offset:16
    s_waitcnt lgkmcnt(0)
    v_min3_u32 v24, v24, v25, v26
    v_cmp_lt_u32 vcc, 3, v24
    s_cbranch_vccnz A_lA4_ok
    s_waitcnt vmcnt(20)
    s_max_u32 s54, s54, 7
    v_mov_b32 v20, s54
    ds_write_b32 v17, v20
A_lA4_7:
    s_cmp_ge_u32 s54, 8
    s_cbranch_scc1 A_lA4_8
    ds_read_b96 v[24:26], v17 offset:16
    s_waitcnt lgkmcnt(0)
    v_min3_u32 v24, v24, v25, v26
    v_cmp_lt_u32 vcc, 3, v24
    s_cbranch_vccnz A_lA4_ok
    s_waitcnt vmcnt(0)
    s_max_u32 s54, s54, 8
    v_mov_b32 v20, s54
    ds_write_b32 v17, v20
A_lA4_8:
A_lA4:
    s_sub_u32 s57, s57, 1
    s_cbranch_scc1 A_end
    ds_read_b96 v[24:26], v17 offset:16
    s_waitcnt lgkmcnt(0)
    v_min3_u32 v24, v24, v25, v26
    v_cmp_lt_u32 vcc, 3, v24
    s_cbranch_vccz A_lA4
A_lA4_ok:
    s_mov_b32 m0, 53248
    s_add_u32 s55, s58, 512
    s_and_b32 s55, s55, 1023
    s_lshl_b32 s55, s55, 12
    s_add_u32 s52, s55, 0
    buffer_load_dwordx4 v12, s[36:39], s52 offen sc1 lds
    buffer_load_dwordx4 v13, s[36:39], s52 offen offset:1024 sc1 lds
    buffer_load_dwordx4 v14, s[36:39], s52 offen offset:2048 sc1 lds
    buffer_load_dwordx4 v15, s[36:39], s52 offen offset:3072 sc1 lds
    s_waitcnt vmcnt(28)
    s_mov_b32 m0, 57344
    s_add_u32 s52, s55, 131072
    buffer_load_dwordx4 v12, s[36:39], s52 offen sc1 lds
    buffer_load_dwordx4 v13, s[36:39], s52 offen offset:1024 sc1 lds
    buffer_load_dwordx4 v14, s[36:39], s52 offen offset:2048 sc1 lds
    buffer_load_dwordx4 v15, s[36:39], s52 offen offset:3072 sc1 lds
    s_waitcnt vmcnt(28)
    s_max_u32 s54, s54, 7
    v_mov_b32 v20, s54
    ds_write_b32 v17, v20
    s_mov_b32 m0, 12288
    s_add_u32 s59, s58, 640
    s_and_b32 s59, s59, 1023
    s_add_u32 s52, s59, 0
    buffer_load_dwordx4 v8, s[24:27], s52 offen sc1 lds
    buffer_load_dwordx4 v9, s[24:27], s52 offen offset:1024 sc1 lds
    buffer_load_dwordx4 v10, s[24:27], s52 offen offset:2048 sc1 lds
    buffer_load_dwordx4 v11, s[24:27], s52 offen offset:3072 sc1 lds
    s_waitcnt vmcnt(28)
    s_mov_b32 m0, 16384
    s_add_u32 s52, s59, 32768
    buffer_load_dwordx4 v8, s[24:27], s52 offen sc1 lds
    buffer_load_dwordx4 v9, s[24:27], s52 offen offset:1024 sc1 lds
    buffer_load_dwordx4 v10, s[24:27], s52 offen offset:2048 sc1 lds
    buffer_load_dwordx4 v11, s[24:27], s52 offen offset:3072 sc1 lds
    s_waitcnt vmcnt(28)
    s_mov_b32 m0, 20480
    s_add_u32 s52, s59, 65536
    buffer_load_dwordx4 v8, s[24:27], s52 offen sc1 lds
    buffer_load_dwordx4 v9, s[24:27], s52 offen offset:1024 sc1 lds
    buffer_load_dwordx4 v10, s[24:27], s52 offen offset:2048 sc1 lds
    buffer_load_dwordx4 v11, s[24:27], s52 offen offset:3072 sc1 lds
    s_waitcnt vmcnt(28)
    v_cmp_lt_u32 vcc, 4, v24
    s_cbranch_vccnz A_lA5_ok
    s_cmp_ge_u32 s54, 8
    s_cbranch_scc1 A_lA5_8
    ds_read_b96 v[24:26], v17 offset:16
    s_waitcnt lgkmcnt(0)
    v_min3_u32 v24, v24, v25, v26
    v_cmp_lt_u32 vcc, 4, v24
    s_cbranch_vccnz A_lA5_ok
    s_waitcnt vmcnt(20)
    s_max_u32 s54, s54, 8
    v_mov_b32 v20, s54
    ds_write_b32 v17, v20
A_lA5_8:
    s_cmp_ge_u32 s54, 9
    s_cbranch_scc1 A_lA5_9
    ds_read_b96 v[24:26], v17 offset:16
    s_waitcnt lgkmcnt(0)
    v_min3_u32 v24, v24, v25, v26
    v_cmp_lt_u32 vcc, 4, v24
    s_cbranch_vccnz A_lA5_ok
    s_waitcnt vmcnt(12)
    s_max_u32 s54, s54, 9
    v_mov_b32 v20, s54
    ds_write_b32 v17, v20
A_lA5_9:
A_lA5:
    s_sub_u32 s57, s57, 1
    s_cbranch_scc1 A_end
    ds_read_b96 v[24:26], v17 offset:16
    s_waitcnt lgkmcnt(0)
    v_min3_u32 v24, v24, v25, v26
    v_cmp_lt_u32 vcc, 4, v24
    s_cbranch_vccz A_lA5
A_lA5_ok:
    s_mov_b32 m0, 61440
    s_add_u32 s55, s58, 576
    s_and_b32 s55, s55, 1023
    s_lshl_b32 s55, s55, 12
    s_add_u32 s52, s55, 0
    buffer_load_dwordx4 v12, s[36:39], s52 offen sc1 lds
    buffer_load_dwordx4 v13, s[36:39], s52 offen offset:1024 sc1 lds
    buffer_load_dwordx4 v14, s[36:39], s52 offen offset:2048 sc1 lds
    buffer_load_dwordx4 v15, s[36:39], s52 offen offset:3072 sc1 lds
    s_waitcnt vmcnt(28)
    s_mov_b32 m0, 65536
    s_add_u32 s52, s55, 131072
    buffer_load_dwordx4 v12, s[36:39], s52 offen sc1 lds
    buffer_load_dwordx4 v13, s[36:39], s52 offen offset:1024 sc1 lds
    buffer_load_dwordx4 v14, s[36:39], s52 offen offset:2048 sc1 lds
    buffer_load_dwordx4 v15, s[36:39], s52 offen offset:3072 sc1 lds
    s_waitcnt vmcnt(28)
    s_max_u32 s54, s54, 8
    v_mov_b32 v20, s54
    ds_write_b32 v17, v20
    v_cmp_lt_u32 vcc, 5, v24
    s_cbranch_vccnz A_lA6_ok
    s_cmp_ge_u32 s54, 9
    s_cbranch_scc1 A_lA6_9
    ds_read_b96 v[24:26], v17 offset:16
    s_waitcnt lgkmcnt(0)
    v_min3_u32 v24, v24, v25, v26
    v_cmp_lt_u32 vcc, 5, v24
    s_cbranch_vccnz A_lA6_ok
    s_waitcnt vmcnt(20)
    s_max_u32 s54, s54, 9
    v_mov_b32 v20, s54
    ds_write_b32 v17, v20
A_lA6_9:
    s_cmp_ge_u32 s54, 10
    s_cbranch_scc1 A_lA6_10
    ds_read_b96 v[24:26], v17 offset:16
    s_waitcnt lgkmcnt(0)
    v_min3_u32 v24, v24, v25, v26
    v_cmp_lt_u32 vcc, 5, v24
    s_cbranch_vccnz A_lA6_ok
    s_waitcnt vmcnt(0)
    s_max_u32 s54, s54, 10
    v_mov_b32 v20, s54
    ds_write_b32 v17, v20
A_lA6_10:
A_lA6:
    s_sub_u32 s57, s57, 1
    s_cbranch_scc1 A_end
    ds_read_b96 v[24:26], v17 offset:16
    s_waitcnt lgkmcnt(0)
    v_min3_u32 v24, v24, v25, v26
    v_cmp_lt_u32 vcc, 5, v24
    s_cbranch_vccz A_lA6
A_lA6_ok:
    s_mov_b32 m0, 81920
    s_add_u32 s55, s58, 640
    s_and_b32 s55, s55, 1023
    s_lshl_b32 s55, s55, 12
    s_add_u32 s52, s55, 0
    buffer_load_dwordx4 v12, s[36:39], s52 offen sc1 lds
    buffer_load_dwordx4 v13, s[36:39], s52 offen offset:1024 sc1 lds
    buffer_load_dwordx4 v14, s[36:39], s52 offen offset:2048 sc1 lds
    buffer_load_dwordx4 v15, s[36:39], s52 offen offset:3072 sc1 lds
    s_waitcnt vmcnt(28)
    s_mov_b32 m0, 86016
    s_add_u32 s52, s55, 131072
    buffer_load_dwordx4 v12, s[36:39], s52 offen sc1 lds
    buffer_load_dwordx4 v13, s[36:39], s52 offen offset:1024 sc1 lds
    buffer_load_dwordx4 v14, s[36:39], s52 offen offset:2048 sc1 lds
    buffer_load_dwordx4 v15, s[36:39], s52 offen offset:3072 sc1 lds
    s_waitcnt vmcnt(28)
    s_max_u32 s54, s54, 9
    v_mov_b32 v20, s54
    ds_write_b32 v17, v20
    s_mov_b32 m0, 40960
    s_add_u32 s59, s58, 768
    s_and_b32 s59, s59, 1023
    s_add_u32 s52, s59, 0
    buffer_load_dwordx4 v8, s[24:27], s52 offen sc1 lds
    buffer_load_dwordx4 v9, s[24:27], s52 offen offset:1024 sc1 lds
    buffer_load_dwordx4 v10, s[24:27], s52 offen offset:2048 sc1 lds
    buffer_load_dwordx4 v11, s[24:27], s52 offen offset:3072 sc1 lds
    s_waitcnt vmcnt(28)
    s_mov_b32 m0, 45056
    s_add_u32 s52, s59, 32768
    buffer_load_dwordx4 v8, s[24:27], s52 offen sc1 lds
    buffer_load_dwordx4 v9, s[24:27], s52 offen offset:1024 sc1 lds
    buffer_load_dwordx4 v10, s[24:27], s52 offen offset:2048 sc1 lds
    buffer_load_dwordx4 v11, s[24:27], s52 offen offset:3072 sc1 lds
    s_waitcnt vmcnt(28)
    s_mov_b32 m0, 49152
    s_add_u32 s52, s59, 65536
    buffer_load_dwordx4 v8, s[24:27], s52 offen sc1 lds
    buffer_load_dwordx4 v9, s[24:27], s52 offen offset:1024 sc1 lds
    buffer_load_dwordx4 v10, s[24:27], s52 offen offset:2048 sc1 lds
    buffer_load_dwordx4 v11, s[24:27], s52 offen offset:3072 sc1 lds
    s_waitcnt vmcnt(28)
    v_cmp_lt_u32 vcc, 6, v24
    s_cbranch_vccnz A_lA7_ok
    s_cmp_ge_u32 s54, 10
    s_cbranch_scc1 A_lA7_10
    ds_read_b96 v[24:26], v17 offset:16
    s_waitcnt lgkmcnt(0)
    v_min3_u32 v24, v24, v25, v26
    v_cmp_lt_u32 vcc, 6, v24
    s_cbranch_vccnz A_lA7_ok
    s_waitcnt vmcnt(20)
    s_max_u32 s54, s54, 10
    v_mov_b32 v20, s54
    ds_write_b32 v17, v20
A_lA7_10:
    s_cmp_ge_u32 s54, 11
    s_cbranch_scc1 A_lA7_11
    ds_read_b96 v[24:26], v17 offset:16
    s_waitcnt lgkmcnt(0)
    v_min3_u32 v24, v24, v25, v26
    v_cmp_lt_u32 vcc, 6, v24
    s_cbranch_vccnz A_lA7_ok
    s_waitcnt vmcnt(12)
    s_max_u32 s54, s54, 11
    v_mov_b32 v20, s54
    ds_write_b32 v17, v20
A_lA7_11:
A_lA7:
    s_sub_u32 s57, s57, 1
    s_cbranch_scc1 A_end
    ds_read_b96 v[24:26], v17 offset:16
    s_waitcnt lgkmcnt(0)
    v_min3_u32 v24, v24, v25, v26
    v_cmp_lt_u32 vcc, 6, v24
    s_cbranch_vccz A_lA7
A_lA7_ok:
    s_mov_b32 m0, 24576
    s_add_u32 s55, s58, 704
    s_and_b32 s55, s55, 1023
    s_lshl_b32 s55, s55, 12
    s_add_u32 s52, s55, 0
    buffer_load_dwordx4 v12, s[36:39], s52 offen sc1 lds
    buffer_load_dwordx4 v13, s[36:39], s52 offen offset:1024 sc1 lds
    buffer_load_dwordx4 v14, s[36:39], s52 offen offset:2048 sc1 lds
    buffer_load_dwordx4 v15, s[36:39], s52 offen offset:3072 sc1 lds
    s_waitcnt vmcnt(28)
    s_mov_b32 m0, 28672
    s_add_u32 s52, s55, 131072
    buffer_load_dwordx4 v12, s[36:39], s52 offen sc1 lds
    buffer_load_dwordx4 v13, s[36:39], s52 offen offset:1024 sc1 lds
    buffer_load_dwordx4 v14, s[36:39], s52 offen offset:2048 sc1 lds
    buffer_load_dwordx4 v15, s[36:39], s52 offen offset:3072 sc1 lds
    s_waitcnt vmcnt(28)
    s_max_u32 s54, s54, 10
    v_mov_b32 v20, s54
    ds_write_b32 v17, v20
    v_cmp_lt_u32 vcc, 7, v24
    s_cbranch_vccnz A_lA8_ok
    s_cmp_ge_u32 s54, 11
    s_cbranch_scc1 A_lA8_11
    ds_read_b96 v[24:26], v17 offset:16
    s_waitcnt lgkmcnt(0)
    v_min3_u32 v24, v24, v25, v26
    v_cmp_lt_u32 vcc, 7, v24
    s_cbranch_vccnz A_lA8_ok
    s_waitcnt vmcnt(20)
    s_max_u32 s54, s54, 11
    v_mov_b32 v20, s54
    ds_write_b32 v17, v20
A_lA8_11:
    s_cmp_ge_u32 s54, 12
    s_cbranch_scc1 A_lA8_12
    ds_read_b96 v[24:26], v17 offset:16
    s_waitcnt lgkmcnt(0)
    v_min3_u32 v24, v24, v25, v26
    v_cmp_lt_u32 vcc, 7, v24
    s_cbranch_vccnz A_lA8_ok
    s_waitcnt vmcnt(0)
    s_max_u32 s54, s54, 12
    v_mov_b32 v20, s54
    ds_write_b32 v17, v20
A_lA8_12:
A_lA8:
    s_sub_u32 s57, s57, 1
    s_cbranch_scc1 A_end
    ds_read_b96 v[24:26], v17 offset:16
    s_waitcnt lgkmcnt(0)
    v_min3_u32 v24, v24, v25, v26
    v_cmp_lt_u32 vcc, 7, v24
    s_cbranch_vccz A_lA8
A_lA8_ok:
    s_mov_b32 m0, 32768
    s_add_u32 s55, s58, 768
    s_and_b32 s55, s55, 1023
    s_lshl_b32 s55, s55, 12
    s_add_u32 s52, s55, 0
    buffer_load_dwordx4 v12, s[36:39], s52 offen sc1 lds
    buffer_load_dwordx4 v13, s[36:39], s52 offen offset:1024 sc1 lds
    buffer_load_dwordx4 v14, s[36:39], s52 offen offset:2048 sc1 lds
    buffer_load_dwordx4 v15, s[36:39], s52 offen offset:3072 sc1 lds
    s_waitcnt vmcnt(28)
    s_mov_b32 m0, 36864
    s_add_u32 s52, s55, 131072
    buffer_load_dwordx4 v12, s[36:39], s52 offen sc1 lds
    buffer_load_dwordx4 v13, s[36:39], s52 offen offset:1024 sc1 lds
    buffer_load_dwordx4 v14, s[36:39], s52 offen offset:2048 sc1 lds
    buffer_load_dwordx4 v15, s[36:39], s52 offen offset:3072 sc1 lds
    s_waitcnt vmcnt(28)
    s_max_u32 s54, s54, 11
    v_mov_b32 v20, s54
    ds_write_b32 v17, v20
    s_mov_b32 m0, 69632
    s_add_u32 s59, s58, 896
    s_and_b32 s59, s59, 1023
    s_add_u32 s52, s59, 0
    buffer_load_dwordx4 v8, s[24:27], s52 offen sc1 lds
    buffer_load_dwordx4 v9, s[24:27], s52 offen offset:1024 sc1 lds
    buffer_load_dwordx4 v10, s[24:27], s52 offen offset:2048 sc1 lds
    buffer_load_dwordx4 v11, s[24:27], s52 offen offset:3072 sc1 lds
    s_waitcnt vmcnt(28)
    s_mov_b32 m0, 73728
    s_add_u32 s52, s59, 32768
    buffer_load_dwordx4 v8, s[24:27], s52 offen sc1 lds
    buffer_load_dwordx4 v9, s[24:27], s52 offen offset:1024 sc1 lds
    buffer_load_dwordx4 v10, s[24:27], s52 offen offset:2048 sc1 lds
    buffer_load_dwordx4 v11, s[24:27], s52 offen offset:3072 sc1 lds
    s_waitcnt vmcnt(28)
    s_mov_b32 m0, 77824
    s_add_u32 s52, s59, 65536
    buffer_load_dwordx4 v8, s[24:27], s52 offen sc1 lds
    buffer_load_dwordx4 v9, s[24:27], s52 offen offset:1024 sc1 lds
    buffer_load_dwordx4 v10, s[24:27], s52 offen offset:2048 sc1 lds
    buffer_load_dwordx4 v11, s[24:27], s52 offen offset:3072 sc1 lds
    s_waitcnt vmcnt(28)
    v_cmp_lt_u32 vcc, 8, v24
    s_cbranch_vccnz A_lA9_ok
    s_cmp_ge_u32 s54, 12
    s_cbranch_scc1 A_lA9_12
    ds_read_b96 v[24:26], v17 offset:16
    s_waitcnt lgkmcnt(0)
    v_min3_u32 v24, v24, v25, v26
    v_cmp_lt_u32 vcc, 8, v24
    s_cbranch_vccnz A_lA9_ok
    s_waitcnt vmcnt(20)
    s_max_u32 s54, s54, 12
    v_mov_b32 v20, s54
    ds_write_b32 v17, v20
A_lA9_12:
    s_cmp_ge_u32 s54, 13
    s_cbranch_scc1 A_lA9_13
    ds_read_b96 v[24:26], v17 offset:16
    s_waitcnt lgkmcnt(0)
    v_min3_u32 v24, v24, v25, v26
    v_cmp_lt_u32 vcc, 8, v24
    s_cbranch_vccnz A_lA9_ok
    s_waitcnt vmcnt(12)
    s_max_u32 s54, s54, 13
    v_mov_b32 v20, s54
    ds_write_b32 v17, v20
A_lA9_13:
A_lA9:
    s_sub_u32 s57, s57, 1
    s_cbranch_scc1 A_end
    ds_read_b96 v[24:26], v17 offset:16
    s_waitcnt lgkmcnt(0)
    v_min3_u32 v24, v24, v25, v26
    v_cmp_lt_u32 vcc, 8, v24
    s_cbranch_vccz A_lA9
A_lA9_ok:
    s_mov_b32 m0, 53248
    s_add_u32 s55, s58, 832
    s_and_b32 s55, s55, 1023
    s_lshl_b32 s55, s55, 12
    s_add_u32 s52, s55, 0
    buffer_load_dwordx4 v12, s[36:39], s52 offen sc1 lds
    buffer_load_dwordx4 v13, s[36:39], s52 offen offset:1024 sc1 lds
    buffer_load_dwordx4 v14, s[36:39], s52 offen offset:2048 sc1 lds
    buffer_load_dwordx4 v15, s[36:39], s52 offen offset:3072 sc1 lds
    s_waitcnt vmcnt(28)
    s_mov_b32 m0, 57344
    s_add_u32 s52, s55, 131072
    buffer_load_dwordx4 v12, s[36:39], s52 offen sc1 lds
    buffer_load_dwordx4 v13, s[36:39], s52 offen offset:1024 sc1 lds
    buffer_load_dwordx4 v14, s[36:39], s52 offen offset:2048 sc1 lds
    buffer_load_dwordx4 v15, s[36:39], s52 offen offset:3072 sc1 lds
    s_waitcnt vmcnt(28)
    s_max_u32 s54, s54, 12
    v_mov_b32 v20, s54
    ds_write_b32 v17, v20
    v_cmp_lt_u32 vcc, 9, v24
    s_cbranch_vccnz A_lA10_ok
    s_cmp_ge_u32 s54, 13
    s_cbranch_scc1 A_lA10_13
    ds_read_b96 v[24:26], v17 offset:16
    s_waitcnt lgkmcnt(0)
    v_min3_u32 v24, v24, v25, v26
    v_cmp_lt_u32 vcc, 9, v24
    s_cbranch_vccnz A_lA10_ok
    s_waitcnt vmcnt(20)
    s_max_u32 s54, s54, 13
    v_mov_b32 v20, s54
    ds_write_b32 v17, v20
A_lA10_13:
    s_cmp_ge_u32 s54, 14
    s_cbranch_scc1 A_lA10_14
    ds_read_b96 v[24:26], v17 offset:16
    s_waitcnt lgkmcnt(0)
    v_min3_u32 v24, v24, v25, v26
    v_cmp_lt_u32 vcc, 9, v24
    s_cbranch_vccnz A_lA10_ok
    s_waitcnt vmcnt(0)
    s_max_u32 s54, s54, 14
    v_mov_b32 v20, s54
    ds_write_b32 v17, v20
A_lA10_14:
A_lA10:
    s_sub_u32 s57, s57, 1
    s_cbranch_scc1 A_end
    ds_read_b96 v[24:26], v17 offset:16
    s_waitcnt lgkmcnt(0)
    v_min3_u32 v24, v24, v25, v26
    v_cmp_lt_u32 vcc, 9, v24
    s_cbranch_vccz A_lA10
A_lA10_ok:
    s_mov_b32 m0, 61440
    s_add_u32 s55, s58, 896
    s_and_b32 s55, s55, 1023
    s_lshl_b32 s55, s55, 12
    s_add_u32 s52, s55, 0
    buffer_load_dwordx4 v12, s[36:39], s52 offen sc1 lds
    buffer_load_dwordx4 v13, s[36:39], s52 offen offset:1024 sc1 lds
    buffer_load_dwordx4 v14, s[36:39], s52 offen offset:2048 sc1 lds
    buffer_load_dwordx4 v15, s[36:39], s52 offen offset:3072 sc1 lds
    s_waitcnt vmcnt(28)
    s_mov_b32 m0, 65536
    s_add_u32 s52, s55, 131072
    buffer_load_dwordx4 v12, s[36:39], s52 offen sc1 lds
    buffer_load_dwordx4 v13, s[36:39], s52 offen offset:1024 sc1 lds
    buffer_load_dwordx4 v14, s[36:39], s52 offen offset:2048 sc1 lds
    buffer_load_dwordx4 v15, s[36:39], s52 offen offset:3072 sc1 lds
    s_waitcnt vmcnt(28)
    s_max_u32 s54, s54, 13
    v_mov_b32 v20, s54
    ds_write_b32 v17, v20
    v_cmp_lt_u32 vcc, 10, v24
    s_cbranch_vccnz A_lA11_ok
    s_cmp_ge_u32 s54, 14
    s_cbranch_scc1 A_lA11_14
    ds_read_b96 v[24:26], v17 offset:16
    s_waitcnt lgkmcnt(0)
    v_min3_u32 v24, v24, v25, v26
    v_cmp_lt_u32 vcc, 10, v24
    s_cbranch_vccnz A_lA11_ok
    s_waitcnt vmcnt(8)
    s_max_u32 s54, s54, 14
    v_mov_b32 v20, s54
    ds_write_b32 v17, v20
A_lA11_14:
    s_cmp_ge_u32 s54, 15
    s_cbranch_scc1 A_lA11_15
    ds_read_b96 v[24:26], v17 offset:16
    s_waitcnt lgkmcnt(0)
    v_min3_u32 v24, v24, v25, v26
    v_cmp_lt_u32 vcc, 10, v24
    s_cbranch_vccnz A_lA11_ok
    s_waitcnt vmcnt(0)
    s_max_u32 s54, s54, 15
    v_mov_b32 v20, s54
    ds_write_b32 v17, v20
A_lA11_15:
A_lA11:
    s_sub_u32 s57, s57, 1
    s_cbranch_scc1 A_end
    ds_read_b96 v[24:26], v17 offset:16
    s_waitcnt lgkmcnt(0)
    v_min3_u32 v24, v24, v25, v26
    v_cmp_lt_u32 vcc, 10, v24
    s_cbranch_vccz A_lA11
A_lA11_ok:
    s_mov_b32 m0, 81920
    s_add_u32 s55, s58, 960
    s_and_b32 s55, s55, 1023
    s_lshl_b32 s55, s55, 12
    s_add_u32 s52, s55, 0
    buffer_load_dwordx4 v12, s[36:39], s52 offen sc1 lds
    buffer_load_dwordx4 v13, s[36:39], s52 offen offset:1024 sc1 lds
    buffer_load_dwordx4 v14, s[36:39], s52 offen offset:2048 sc1 lds
    buffer_load_dwordx4 v15, s[36:39], s52 offen offset:3072 sc1 lds
    s_waitcnt vmcnt(28)
    s_mov_b32 m0, 86016
    s_add_u32 s52, s55, 131072
    buffer_load_dwordx4 v12, s[36:39], s52 offen sc1 lds
    buffer_load_dwordx4 v13, s[36:39], s52 offen offset:1024 sc1 lds
    buffer_load_dwordx4 v14, s[36:39], s52 offen offset:2048 sc1 lds
    buffer_load_dwordx4 v15, s[36:39], s52 offen offset:3072 sc1 lds
    s_waitcnt vmcnt(28)
    s_lshr_b32 s22, s2, 3
    s_lshl_b32 s22, s22, 15
    s_and_b32 s23, s20, 7
    s_lshl_b32 s23, s23, 7
    s_sub_u32 s52, s22, s23
    v_lshlrev_b32 v40, 7, v0
    v_add_u32 v40, s52, v40
    buffer_load_dword v56, v40, s[44:47], 0 offen
    v_add_u32 v40, 8192, v40
    buffer_load_dword v57, v40, s[44:47], 0 offen
    v_add_u32 v40, 8192, v40
    buffer_load_dword v58, v40, s[44:47], 0 offen
    v_add_u32 v40, 8192, v40
    buffer_load_dword v59, v40, s[44:47], 0 offen
    v_add_u32 v40, 8192, v40
    s_add_u32 m0, s84, 90112
    s_add_u32 s52, s84, 0
    buffer_load_dwordx4 v4, s[28:31], s52 offen nt lds
    buffer_load_dwordx4 v5, s[28:31], s52 offen offset:1024 nt lds
    buffer_load_dwordx4 v6, s[28:31], s52 offen offset:2048 nt lds
    buffer_load_dwordx4 v7, s[28:31], s52 offen offset:3072 nt lds
    s_add_u32 m0, s85, 90112
    s_add_u32 s52, s85, 0
    buffer_load_dwordx4 v4, s[28:31], s52 offen nt lds
    buffer_load_dwordx4 v5, s[28:31], s52 offen offset:1024 nt lds
    buffer_load_dwordx4 v6, s[28:31], s52 offen offset:2048 nt lds
    buffer_load_dwordx4 v7, s[28:31], s52 offen offset:3072 nt lds
    s_waitcnt vmcnt(36)
    s_add_u32 m0, s86, 90112
    s_add_u32 s52, s86, 0
    buffer_load_dwordx4 v4, s[28:31], s52 offen nt lds
    buffer_load_dwordx4 v5, s[28:31], s52 offen offset:1024 nt lds
    buffer_load_dwordx4 v6, s[28:31], s52 offen offset:2048 nt lds
    buffer_load_dwordx4 v7, s[28:31], s52 offen offset:3072 nt lds
    s_waitcnt vmcnt(36)
    s_waitcnt vmcnt(16)
    s_max_u32 s54, s54, 16
    v_mov_b32 v20, s54
    ds_write_b32 v17, v20
    s_add_u32 m0, s87, 90112
    s_add_u32 s52, s87, 0
    buffer_load_dwordx4 v4, s[28:31], s52 offen nt lds
    buffer_load_dwordx4 v5, s[28:31], s52 offen offset:1024 nt lds
    buffer_load_dwordx4 v6, s[28:31], s52 offen offset:2048 nt lds
    buffer_load_dwordx4 v7, s[28:31], s52 offen offset:3072 nt lds
    s_add_u32 m0, s84, 106496
    s_add_u32 s52, s84, 16384
    buffer_load_dwordx4 v4, s[28:31], s52 offen nt lds
    buffer_load_dwordx4 v5, s[28:31], s52 offen offset:1024 nt lds
    buffer_load_dwordx4 v6, s[28:31], s52 offen offset:2048 nt lds
    buffer_load_dwordx4 v7, s[28:31], s52 offen offset:3072 nt lds
    s_add_u32 m0, s85, 106496
    s_add_u32 s52, s85, 16384
    buffer_load_dwordx4 v4, s[28:31], s52 offen nt lds
    buffer_load_dwordx4 v5, s[28:31], s52 offen offset:1024 nt lds
    buffer_load_dwordx4 v6, s[28:31], s52 offen offset:2048 nt lds
    buffer_load_dwordx4 v7, s[28:31], s52 offen offset:3072 nt lds
    s_add_u32 m0, s86, 106496
    s_add_u32 s52, s86, 16384
    buffer_load_dwordx4 v4, s[28:31], s52 offen nt lds
    buffer_load_dwordx4 v5, s[28:31], s52 offen offset:1024 nt lds
    buffer_load_dwordx4 v6, s[28:31], s52 offen offset:2048 nt lds
    buffer_load_dwordx4 v7, s[28:31], s52 offen offset:3072 nt lds
    s_add_u32 m0, s87, 106496
    s_add_u32 s52, s87, 16384
    buffer_load_dwordx4 v4, s[28:31], s52 offen nt lds
    buffer_load_dwordx4 v5, s[28:31], s52 offen offset:1024 nt lds
    buffer_load_dwordx4 v6, s[28:31], s52 offen offset:2048 nt lds
    buffer_load_dwordx4 v7, s[28:31], s52 offen offset:3072 nt lds
    s_add_u32 m0, s84, 122880
    s_add_u32 s52, s84, 32768
    buffer_load_dwordx4 v4, s[28:31], s52 offen nt lds
    buffer_load_dwordx4 v5, s[28:31], s52 offen offset:1024 nt lds
    buffer_load_dwordx4 v6, s[28:31], s52 offen offset:2048 nt lds
    buffer_load_dwordx4 v7, s[28:31], s52 offen offset:3072 nt lds
    s_waitcnt vmcnt(36)
    s_add_u32 m0, s85, 122880
    s_add_u32 s52, s85, 32768
    buffer_load_dwordx4 v4, s[28:31], s52 offen nt lds
    buffer_load_dwordx4 v5, s[28:31], s52 offen offset:1024 nt lds
    buffer_load_dwordx4 v6, s[28:31], s52 offen offset:2048 nt lds
    buffer_load_dwordx4 v7, s[28:31], s52 offen offset:3072 nt lds
    s_waitcnt vmcnt(36)
    s_add_u32 m0, s86, 122880
    s_add_u32 s52, s86, 32768
    buffer_load_dwordx4 v4, s[28:31], s52 offen nt lds
    buffer_load_dwordx4 v5, s[28:31], s52 offen offset:1024 nt lds
    buffer_load_dwordx4 v6, s[28:31], s52 offen offset:2048 nt lds
    buffer_load_dwordx4 v7, s[28:31], s52 offen offset:3072 nt lds
    s_waitcnt vmcnt(36)
    s_add_u32 m0, s87, 122880
    s_add_u32 s52, s87, 32768
    buffer_load_dwordx4 v4, s[28:31], s52 offen nt lds
    buffer_load_dwordx4 v5, s[28:31], s52 offen offset:1024 nt lds
    buffer_load_dwordx4 v6, s[28:31], s52 offen offset:2048 nt lds
    buffer_load_dwordx4 v7, s[28:31], s52 offen offset:3072 nt lds
    s_waitcnt vmcnt(36)
    s_add_u32 m0, s84, 139264
    s_add_u32 s52, s84, 49152
    buffer_load_dwordx4 v4, s[28:31], s52 offen nt lds
    buffer_load_dwordx4 v5, s[28:31], s52 offen offset:1024 nt lds
    buffer_load_dwordx4 v6, s[28:31], s52 offen offset:2048 nt lds
    buffer_load_dwordx4 v7, s[28:31], s52 offen offset:3072 nt lds
    s_waitcnt vmcnt(36)
    s_max_u32 s54, s54, 17
    v_mov_b32 v20, s54
    ds_write_b32 v17, v20
    s_add_u32 m0, s85, 139264
    s_add_u32 s52, s85, 49152
    buffer_load_dwordx4 v4, s[28:31], s52 offen nt lds
    buffer_load_dwordx4 v5, s[28:31], s52 offen offset:1024 nt lds
    buffer_load_dwordx4 v6, s[28:31], s52 offen offset:2048 nt lds
    buffer_load_dwordx4 v7, s[28:31], s52 offen offset:3072 nt lds
    s_waitcnt vmcnt(36)
    s_add_u32 m0, s86, 139264
    s_add_u32 s52, s86, 49152
    buffer_load_dwordx4 v4, s[28:31], s52 offen nt lds
    buffer_load_dwordx4 v5, s[28:31], s52 offen offset:1024 nt lds
    buffer_load_dwordx4 v6, s[28:31], s52 offen offset:2048 nt lds
    buffer_load_dwordx4 v7, s[28:31], s52 offen offset:3072 nt lds
    s_waitcnt vmcnt(36)
    s_add_u32 m0, s87, 139264
    s_add_u32 s52, s87, 49152
    buffer_load_dwordx4 v4, s[28:31], s52 offen nt lds
    buffer_load_dwordx4 v5, s[28:31], s52 offen offset:1024 nt lds
    buffer_load_dwordx4 v6, s[28:31], s52 offen offset:2048 nt lds
    buffer_load_dwordx4 v7, s[28:31], s52 offen offset:3072 nt lds
    s_waitcnt vmcnt(36)
    v_cmp_lt_u32 vcc, 11, v24
    s_cbranch_vccnz A_lA12_ok
    s_cmp_ge_u32 s54, 18
    s_cbranch_scc1 A_lA12_18
    ds_read_b96 v[24:26], v17 offset:16
    s_waitcnt lgkmcnt(0)
    v_min3_u32 v24, v24, v25, v26
    v_cmp_lt_u32 vcc, 11, v24
    s_cbranch_vccnz A_lA12_ok
    s_waitcnt vmcnt(32)
    s_max_u32 s54, s54, 18
    v_mov_b32 v20, s54
    ds_write_b32 v17, v20
A_lA12_18:
    s_cmp_ge_u32 s54, 19
    s_cbranch_scc1 A_lA12_19
    ds_read_b96 v[24:26], v17 offset:16
    s_waitcnt lgkmcnt(0)
    v_min3_u32 v24, v24, v25, v26
    v_cmp_lt_u32 vcc, 11, v24
    s_cbranch_vccnz A_lA12_ok
    s_waitcnt vmcnt(16)
    s_max_u32 s54, s54, 19
    v_mov_b32 v20, s54
    ds_write_b32 v17, v20
A_lA12_19:
    s_cmp_ge_u32 s54, 20
    s_cbranch_scc1 A_lA12_20
    ds_read_b96 v[24:26], v17 offset:16
    s_waitcnt lgkmcnt(0)
    v_min3_u32 v24, v24, v25, v26
    v_cmp_lt_u32 vcc, 11, v24
    s_cbranch_vccnz A_lA12_ok
    s_waitcnt vmcnt(0)
    s_max_u32 s54, s54, 20
    v_mov_b32 v20, s54
    ds_write_b32 v17, v20
A_lA12_20:
A_lA12:
    s_sub_u32 s57, s57, 1
    s_cbranch_scc1 A_end
    ds_read_b96 v[24:26], v17 offset:16
    s_waitcnt lgkmcnt(0)
    v_min3_u32 v24, v24, v25, v26
    v_cmp_lt_u32 vcc, 11, v24
    s_cbranch_vccz A_lA12
A_lA12_ok:
    s_add_u32 m0, s84, 0
    s_add_u32 s52, s84, 65536
    buffer_load_dwordx4 v4, s[28:31], s52 offen nt lds
    buffer_load_dwordx4 v5, s[28:31], s52 offen offset:1024 nt lds
    buffer_load_dwordx4 v6, s[28:31], s52 offen offset:2048 nt lds
    buffer_load_dwordx4 v7, s[28:31], s52 offen offset:3072 nt lds
    s_waitcnt vmcnt(36)
    s_max_u32 s54, s54, 18
    v_mov_b32 v20, s54
    ds_write_b32 v17, v20
    s_add_u32 m0, s85, 0
    s_add_u32 s52, s85, 65536
    buffer_load_dwordx4 v4, s[28:31], s52 offen nt lds
    buffer_load_dwordx4 v5, s[28:31], s52 offen offset:1024 nt lds
    buffer_load_dwordx4 v6, s[28:31], s52 offen offset:2048 nt lds
    buffer_load_dwordx4 v7, s[28:31], s52 offen offset:3072 nt lds
    s_waitcnt vmcnt(36)
    s_add_u32 m0, s86, 0
    s_add_u32 s52, s86, 65536
    buffer_load_dwordx4 v4, s[28:31], s52 offen nt lds
    buffer_load_dwordx4 v5, s[28:31], s52 offen offset:1024 nt lds
    buffer_load_dwordx4 v6, s[28:31], s52 offen offset:2048 nt lds
    buffer_load_dwordx4 v7, s[28:31], s52 offen offset:3072 nt lds
    s_waitcnt vmcnt(36)
    s_add_u32 m0, s87, 0
    s_add_u32 s52, s87, 65536
    buffer_load_dwordx4 v4, s[28:31], s52 offen nt lds
    buffer_load_dwordx4 v5, s[28:31], s52 offen offset:1024 nt lds
    buffer_load_dwordx4 v6, s[28:31], s52 offen offset:2048 nt lds
    buffer_load_dwordx4 v7, s[28:31], s52 offen offset:3072 nt lds
    s_waitcnt vmcnt(36)
    s_add_u32 m0, s84, 16384
    s_add_u32 s52, s84, 81920
    buffer_load_dwordx4 v4, s[28:31], s52 offen nt lds
    buffer_load_dwordx4 v5, s[28:31], s52 offen offset:1024 nt lds
    buffer_load_dwordx4 v6, s[28:31], s52 offen offset:2048 nt lds
    buffer_load_dwordx4 v7, s[28:31], s52 offen offset:3072 nt lds
    s_waitcnt vmcnt(36)
    s_max_u32 s54, s54, 19
    v_mov_b32 v20, s54
    ds_write_b32 v17, v20
    s_add_u32 m0, s85, 16384
    s_add_u32 s52, s85, 81920
    buffer_load_dwordx4 v4, s[28:31], s52 offen nt lds
    buffer_load_dwordx4 v5, s[28:31], s52 offen offset:1024 nt lds
    buffer_load_dwordx4 v6, s[28:31], s52 offen offset:2048 nt lds
    buffer_load_dwordx4 v7, s[28:31], s52 offen offset:3072 nt lds
    s_waitcnt vmcnt(36)
    s_add_u32 m0, s86, 16384
    s_add_u32 s52, s86, 81920
    buffer_load_dwordx4 v4, s[28:31], s52 offen nt lds
    buffer_load_dwordx4 v5, s[28:31], s52 offen offset:1024 nt lds
    buffer_load_dwordx4 v6, s[28:31], s52 offen offset:2048 nt lds
    buffer_load_dwordx4 v7, s[28:31], s52 offen offset:3072 nt lds
    s_waitcnt vmcnt(36)
    s_add_u32 m0, s87, 16384
    s_add_u32 s52, s87, 81920
    buffer_load_dwordx4 v4, s[28:31], s52 offen nt lds
    buffer_load_dwordx4 v5, s[28:31], s52 offen offset:1024 nt lds
    buffer_load_dwordx4 v6, s[28:31], s52 offen offset:2048 nt lds
    buffer_load_dwordx4 v7, s[28:31], s52 offen offset:3072 nt lds
    s_waitcnt vmcnt(36)
    v_cmp_lt_u32 vcc, 13, v24
    s_cbranch_vccnz A_lA13_ok
    s_cmp_ge_u32 s54, 20
    s_cbranch_scc1 A_lA13_20
    ds_read_b96 v[24:26], v17 offset:16
    s_waitcnt lgkmcnt(0)
    v_min3_u32 v24, v24, v25, v26
    v_cmp_lt_u32 vcc, 13, v24
    s_cbranch_vccnz A_lA13_ok
    s_waitcnt vmcnt(32)
    s_max_u32 s54, s54, 20
    v_mov_b32 v20, s54
    ds_write_b32 v17, v20
A_lA13_20:
    s_cmp_ge_u32 s54, 21
    s_cbranch_scc1 A_lA13_21
    ds_read_b96 v[24:26], v17 offset:16
    s_waitcnt lgkmcnt(0)
    v_min3_u32 v24, v24, v25, v26
    v_cmp_lt_u32 vcc, 13, v24
    s_cbranch_vccnz A_lA13_ok
    s_waitcnt vmcnt(16)
    s_max_u32 s54, s54, 21
    v_mov_b32 v20, s54
    ds_write_b32 v17, v20
A_lA13_21:
    s_cmp_ge_u32 s54, 22
    s_cbranch_scc1 A_lA13_22
    ds_read_b96 v[24:26], v17 offset:16
    s_waitcnt lgkmcnt(0)
    v_min3_u32 v24, v24, v25, v26
    v_cmp_lt_u32 vcc, 13, v24
    s_cbranch_vccnz A_lA13_ok
    s_waitcnt vmcnt(0)
    s_max_u32 s54, s54, 22
    v_mov_b32 v20, s54
    ds_write_b32 v17, v20
A_lA13_22:
A_lA13:
    s_sub_u32 s57, s57, 1
    s_cbranch_scc1 A_end
    ds_read_b96 v[24:26], v17 offset:16
    s_waitcnt lgkmcnt(0)
    v_min3_u32 v24, v24, v25, v26
    v_cmp_lt_u32 vcc, 13, v24
    s_cbranch_vccz A_lA13
A_lA13_ok:
    s_add_u32 m0, s84, 32768
    s_add_u32 s52, s84, 98304
    buffer_load_dwordx4 v4, s[28:31], s52 offen nt lds
    buffer_load_dwordx4 v5, s[28:31], s52 offen offset:1024 nt lds
    buffer_load_dwordx4 v6, s[28:31], s52 offen offset:2048 nt lds
    buffer_load_dwordx4 v7, s[28:31], s52 offen offset:3072 nt lds
    s_waitcnt vmcnt(36)
    s_max_u32 s54, s54, 20
    v_mov_b32 v20, s54
    ds_write_b32 v17, v20
    s_add_u32 m0, s85, 32768
    s_add_u32 s52, s85, 98304
    buffer_load_dwordx4 v4, s[28:31], s52 offen nt lds
    buffer_load_dwordx4 v5, s[28:31], s52 offen offset:1024 nt lds
    buffer_load_dwordx4 v6, s[28:31], s52 offen offset:2048 nt lds
    buffer_load_dwordx4 v7, s[28:31], s52 offen offset:3072 nt lds
    s_waitcnt vmcnt(36)
    s_add_u32 m0, s86, 32768
    s_add_u32 s52, s86, 98304
    buffer_load_dwordx4 v4, s[28:31], s52 offen nt lds
    buffer_load_dwordx4 v5, s[28:31], s52 offen offset:1024 nt lds
    buffer_load_dwordx4 v6, s[28:31], s52 offen offset:2048 nt lds
    buffer_load_dwordx4 v7, s[28:31], s52 offen offset:3072 nt lds
    s_waitcnt vmcnt(36)
    s_add_u32 m0, s87, 32768
    s_add_u32 s52, s87, 98304
    buffer_load_dwordx4 v4, s[28:31], s52 offen nt lds
    buffer_load_dwordx4 v5, s[28:31], s52 offen offset:1024 nt lds
    buffer_load_dwordx4 v6, s[28:31], s52 offen offset:2048 nt lds
    buffer_load_dwordx4 v7, s[28:31], s52 offen offset:3072 nt lds
    s_waitcnt vmcnt(36)
    v_cmp_lt_u32 vcc, 14, v24
    s_cbranch_vccnz A_lA14_ok
    s_cmp_ge_u32 s54, 21
    s_cbranch_scc1 A_lA14_21
    ds_read_b96 v[24:26], v17 offset:16
    s_waitcnt lgkmcnt(0)
    v_min3_u32 v24, v24, v25, v26
    v_cmp_lt_u32 vcc, 14, v24
    s_cbranch_vccnz A_lA14_ok
    s_waitcnt vmcnt(32)
    s_max_u32 s54, s54, 21
    v_mov_b32 v20, s54
    ds_write_b32 v17, v20
A_lA14_21:
    s_cmp_ge_u32 s54, 22
    s_cbranch_scc1 A_lA14_22
    ds_read_b96 v[24:26], v17 offset:16
    s_waitcnt lgkmcnt(0)
    v_min3_u32 v24, v24, v25, v26
    v_cmp_lt_u32 vcc, 14, v24
    s_cbranch_vccnz A_lA14_ok
    s_waitcnt vmcnt(16)
    s_max_u32 s54, s54, 22
    v_mov_b32 v20, s54
    ds_write_b32 v17, v20
A_lA14_22:
    s_cmp_ge_u32 s54, 23
    s_cbranch_scc1 A_lA14_23
    ds_read_b96 v[24:26], v17 offset:16
    s_waitcnt lgkmcnt(0)
    v_min3_u32 v24, v24, v25, v26
    v_cmp_lt_u32 vcc, 14, v24
    s_cbranch_vccnz A_lA14_ok
    s_waitcnt vmcnt(0)
    s_max_u32 s54, s54, 23
    v_mov_b32 v20, s54
    ds_write_b32 v17, v20
A_lA14_23:
A_lA14:
    s_sub_u32 s57, s57, 1
    s_cbranch_scc1 A_end
    ds_read_b96 v[24:26], v17 offset:16
    s_waitcnt lgkmcnt(0)
    v_min3_u32 v24, v24, v25, v26
    v_cmp_lt_u32 vcc, 14, v24
    s_cbranch_vccz A_lA14
A_lA14_ok:
    s_add_u32 m0, s84, 49152
    s_add_u32 s52, s84, 114688
    buffer_load_dwordx4 v4, s[28:31], s52 offen nt lds
    buffer_load_dwordx4 v5, s[28:31], s52 offen offset:1024 nt lds
    buffer_load_dwordx4 v6, s[28:31], s52 offen offset:2048 nt lds
    buffer_load_dwordx4 v7, s[28:31], s52 offen offset:3072 nt lds
    s_waitcnt vmcnt(36)
    s_max_u32 s54, s54, 21
    v_mov_b32 v20, s54
    ds_write_b32 v17, v20
    s_add_u32 m0, s85, 49152
    s_add_u32 s52, s85, 114688
    buffer_load_dwordx4 v4, s[28:31], s52 offen nt lds
    buffer_load_dwordx4 v5, s[28:31], s52 offen offset:1024 nt lds
    buffer_load_dwordx4 v6, s[28:31], s52 offen offset:2048 nt lds
    buffer_load_dwordx4 v7, s[28:31], s52 offen offset:3072 nt lds
    s_waitcnt vmcnt(36)
    s_add_u32 m0, s86, 49152
    s_add_u32 s52, s86, 114688
    buffer_load_dwordx4 v4, s[28:31], s52 offen nt lds
    buffer_load_dwordx4 v5, s[28:31], s52 offen offset:1024 nt lds
    buffer_load_dwordx4 v6, s[28:31], s52 offen offset:2048 nt lds
    buffer_load_dwordx4 v7, s[28:31], s52 offen offset:3072 nt lds
    s_waitcnt vmcnt(36)
    s_add_u32 m0, s87, 49152
    s_add_u32 s52, s87, 114688
    buffer_load_dwordx4 v4, s[28:31], s52 offen nt lds
    buffer_load_dwordx4 v5, s[28:31], s52 offen offset:1024 nt lds
    buffer_load_dwordx4 v6, s[28:31], s52 offen offset:2048 nt lds
    buffer_load_dwordx4 v7, s[28:31], s52 offen offset:3072 nt lds
    s_waitcnt vmcnt(36)
    v_cmp_lt_u32 vcc, 15, v24
    s_cbranch_vccnz A_lA15_ok
    s_cmp_ge_u32 s54, 22
    s_cbranch_scc1 A_lA15_22
    ds_read_b96 v[24:26], v17 offset:16
    s_waitcnt lgkmcnt(0)
    v_min3_u32 v24, v24, v25, v26
    v_cmp_lt_u32 vcc, 15, v24
    s_cbranch_vccnz A_lA15_ok
    s_waitcnt vmcnt(32)
    s_max_u32 s54, s54, 22
    v_mov_b32 v20, s54
    ds_write_b32 v17, v20
A_lA15_22:
    s_cmp_ge_u32 s54, 23
    s_cbranch_scc1 A_lA15_23
    ds_read_b96 v[24:26], v17 offset:16
    s_waitcnt lgkmcnt(0)
    v_min3_u32 v24, v24, v25, v26
    v_cmp_lt_u32 vcc, 15, v24
    s_cbranch_vccnz A_lA15_ok
    s_waitcnt vmcnt(16)
    s_max_u32 s54, s54, 23
    v_mov_b32 v20, s54
    ds_write_b32 v17, v20
A_lA15_23:
    s_cmp_ge_u32 s54, 24
    s_cbranch_scc1 A_lA15_24
    ds_read_b96 v[24:26], v17 offset:16
    s_waitcnt lgkmcnt(0)
    v_min3_u32 v24, v24, v25, v26
    v_cmp_lt_u32 vcc, 15, v24
    s_cbranch_vccnz A_lA15_ok
    s_waitcnt vmcnt(0)
    s_max_u32 s54, s54, 24
    v_mov_b32 v20, s54
    ds_write_b32 v17, v20
A_lA15_24:
A_lA15:
    s_sub_u32 s57, s57, 1
    s_cbranch_scc1 A_end
    ds_read_b96 v[24:26], v17 offset:16
    s_waitcnt lgkmcnt(0)
    v_min3_u32 v24, v24, v25, v26
    v_cmp_lt_u32 vcc, 15, v24
    s_cbranch_vccz A_lA15
A_lA15_ok:
    s_add_u32 m0, s84, 65536
    s_add_u32 s52, s88, 0
    buffer_load_dwordx4 v36, s[32:35], s52 offen nt lds
    buffer_load_dwordx4 v37, s[32:35], s52 offen offset:1024 nt lds
    buffer_load_dwordx4 v38, s[32:35], s52 offen offset:2048 nt lds
    buffer_load_dwordx4 v39, s[32:35], s52 offen offset:3072 nt lds
    s_waitcnt vmcnt(36)
    s_max_u32 s54, s54, 22
    v_mov_b32 v20, s54
    ds_write_b32 v17, v20
    s_add_u32 m0, s85, 65536
    s_add_u32 s52, s89, 0
    buffer_load_dwordx4 v36, s[32:35], s52 offen nt lds
    buffer_load_dwordx4 v37, s[32:35], s52 offen offset:1024 nt lds
    buffer_load_dwordx4 v38, s[32:35], s52 offen offset:2048 nt lds
    buffer_load_dwordx4 v39, s[32:35], s52 offen offset:3072 nt lds
    s_waitcnt vmcnt(36)
    s_add_u32 m0, s86, 65536
    s_add_u32 s52, s90, 0
    buffer_load_dwordx4 v36, s[32:35], s52 offen nt lds
    buffer_load_dwordx4 v37, s[32:35], s52 offen offset:1024 nt lds
    buffer_load_dwordx4 v38, s[32:35], s52 offen offset:2048 nt lds
    buffer_load_dwordx4 v39, s[32:35], s52 offen offset:3072 nt lds
    s_waitcnt vmcnt(36)
    s_add_u32 m0, s87, 65536
    s_add_u32 s52, s91, 0
    buffer_load_dwordx4 v36, s[32:35], s52 offen nt lds
    buffer_load_dwordx4 v37, s[32:35], s52 offen offset:1024 nt lds
    buffer_load_dwordx4 v38, s[32:35], s52 offen offset:2048 nt lds
    buffer_load_dwordx4 v39, s[32:35], s52 offen offset:3072 nt lds
    s_waitcnt vmcnt(36)
    v_cmp_lt_u32 vcc, 16, v24
    s_cbranch_vccnz A_lA16_ok
    s_cmp_ge_u32 s54, 23
    s_cbranch_scc1 A_lA16_23
    ds_read_b96 v[24:26], v17 offset:16
    s_waitcnt lgkmcnt(0)
    v_min3_u32 v24, v24, v25, v26
    v_cmp_lt_u32 vcc, 16, v24
    s_cbranch_vccnz A_lA16_ok
    s_waitcnt vmcnt(32)
    s_max_u32 s54, s54, 23
    v_mov_b32 v20, s54
    ds_write_b32 v17, v20
A_lA16_23:
    s_cmp_ge_u32 s54, 24
    s_cbranch_scc1 A_lA16_24
    ds_read_b96 v[24:26], v17 offset:16
    s_waitcnt lgkmcnt(0)
    v_min3_u32 v24, v24, v25, v26
    v_cmp_lt_u32 vcc, 16, v24
    s_cbranch_vccnz A_lA16_ok
    s_waitcnt vmcnt(16)
    s_max_u32 s54, s54, 24
    v_mov_b32 v20, s54
    ds_write_b32 v17, v20
A_lA16_24:
    s_cmp_ge_u32 s54, 25
    s_cbranch_scc1 A_lA16_25
    ds_read_b96 v[24:26], v17 offset:16
    s_waitcnt lgkmcnt(0)
    v_min3_u32 v24, v24, v25, v26
    v_cmp_lt_u32 vcc, 16, v24
    s_cbranch_vccnz A_lA16_ok
    s_waitcnt vmcnt(0)
    s_max_u32 s54, s54, 25
    v_mov_b32 v20, s54
    ds_write_b32 v17, v20
A_lA16_25:
A_lA16:
    s_sub_u32 s57, s57, 1
    s_cbranch_scc1 A_end
    ds_read_b96 v[24:26], v17 offset:16
    s_waitcnt lgkmcnt(0)
    v_min3_u32 v24, v24, v25, v26
    v_cmp_lt_u32 vcc, 16, v24
    s_cbranch_vccz A_lA16
A_lA16_ok:
    s_add_u32 m0, s84, 90112
    s_add_u32 s52, s88, 32768
    buffer_load_dwordx4 v36, s[32:35], s52 offen nt lds
    buffer_load_dwordx4 v37, s[32:35], s52 offen offset:1024 nt lds
    buffer_load_dwordx4 v38, s[32:35], s52 offen offset:2048 nt lds
    buffer_load_dwordx4 v39, s[32:35], s52 offen offset:3072 nt lds
    s_waitcnt vmcnt(36)
    s_max_u32 s54, s54, 23
    v_mov_b32 v20, s54
    ds_write_b32 v17, v20
    s_add_u32 m0, s85, 90112
    s_add_u32 s52, s89, 32768
    buffer_load_dwordx4 v36, s[32:35], s52 offen nt lds
    buffer_load_dwordx4 v37, s[32:35], s52 offen offset:1024 nt lds
    buffer_load_dwordx4 v38, s[32:35], s52 offen offset:2048 nt lds
    buffer_load_dwordx4 v39, s[32:35], s52 offen offset:3072 nt lds
    s_waitcnt vmcnt(36)
    s_add_u32 m0, s86, 90112
    s_add_u32 s52, s90, 32768
    buffer_load_dwordx4 v36, s[32:35], s52 offen nt lds
    buffer_load_dwordx4 v37, s[32:35], s52 offen offset:1024 nt lds
    buffer_load_dwordx4 v38, s[32:35], s52 offen offset:2048 nt lds
    buffer_load_dwordx4 v39, s[32:35], s52 offen offset:3072 nt lds
    s_waitcnt vmcnt(36)
    s_add_u32 m0, s87, 90112
    s_add_u32 s52, s91, 32768
    buffer_load_dwordx4 v36, s[32:35], s52 offen nt lds
    buffer_load_dwordx4 v37, s[32:35], s52 offen offset:1024 nt lds
    buffer_load_dwordx4 v38, s[32:35], s52 offen offset:2048 nt lds
    buffer_load_dwordx4 v39, s[32:35], s52 offen offset:3072 nt lds
    s_waitcnt vmcnt(36)
    v_cmp_lt_u32 vcc, 17, v24
    s_cbranch_vccnz A_lA17_ok
    s_cmp_ge_u32 s54, 24
    s_cbranch_scc1 A_lA17_24
    ds_read_b96 v[24:26], v17 offset:16
    s_waitcnt lgkmcnt(0)
    v_min3_u32 v24, v24, v25, v26
    v_cmp_lt_u32 vcc, 17, v24
    s_cbranch_vccnz A_lA17_ok
    s_waitcnt vmcnt(32)
    s_max_u32 s54, s54, 24
    v_mov_b32 v20, s54
    ds_write_b32 v17, v20
A_lA17_24:
    s_cmp_ge_u32 s54, 25
    s_cbranch_scc1 A_lA17_25
    ds_read_b96 v[24:26], v17 offset:16
    s_waitcnt lgkmcnt(0)
    v_min3_u32 v24, v24, v25, v26
    v_cmp_lt_u32 vcc, 17, v24
    s_cbranch_vccnz A_lA17_ok
    s_waitcnt vmcnt(16)
    s_max_u32 s54, s54, 25
    v_mov_b32 v20, s54
    ds_write_b32 v17, v20
A_lA17_25:
    s_cmp_ge_u32 s54, 26
    s_cbranch_scc1 A_lA17_26
    ds_read_b96 v[24:26], v17 offset:16
    s_waitcnt lgkmcnt(0)
    v_min3_u32 v24, v24, v25, v26
    v_cmp_lt_u32 vcc, 17, v24
    s_cbranch_vccnz A_lA17_ok
    s_waitcnt vmcnt(0)
    s_max_u32 s54, s54, 26
    v_mov_b32 v20, s54
    ds_write_b32 v17, v20
A_lA17_26:
A_lA17:
    s_sub_u32 s57, s57, 1
    s_cbranch_scc1 A_end
    ds_read_b96 v[24:26], v17 offset:16
    s_waitcnt lgkmcnt(0)
    v_min3_u32 v24, v24, v25, v26
    v_cmp_lt_u32 vcc, 17, v24
    s_cbranch_vccz A_lA17
A_lA17_ok:
    s_add_u32 m0, s84, 106496
    s_add_u32 s52, s88, 65536
    buffer_load_dwordx4 v36, s[32:35], s52 offen nt lds
    buffer_load_dwordx4 v37, s[32:35], s52 offen offset:1024 nt lds
    buffer_load_dwordx4 v38, s[32:35], s52 offen offset:2048 nt lds
    buffer_load_dwordx4 v39, s[32:35], s52 offen offset:3072 nt lds
    s_waitcnt vmcnt(36)
    s_max_u32 s54, s54, 24
    v_mov_b32 v20, s54
    ds_write_b32 v17, v20
    s_add_u32 m0, s85, 106496
    s_add_u32 s52, s89, 65536
    buffer_load_dwordx4 v36, s[32:35], s52 offen nt lds
    buffer_load_dwordx4 v37, s[32:35], s52 offen offset:1024 nt lds
    buffer_load_dwordx4 v38, s[32:35], s52 offen offset:2048 nt lds
    buffer_load_dwordx4 v39, s[32:35], s52 offen offset:3072 nt lds
    s_waitcnt vmcnt(36)
    s_add_u32 m0, s86, 106496
    s_add_u32 s52, s90, 65536
    buffer_load_dwordx4 v36, s[32:35], s52 offen nt lds
    buffer_load_dwordx4 v37, s[32:35], s52 offen offset:1024 nt lds
    buffer_load_dwordx4 v38, s[32:35], s52 offen offset:2048 nt lds
    buffer_load_dwordx4 v39, s[32:35], s52 offen offset:3072 nt lds
    s_waitcnt vmcnt(36)
    s_add_u32 m0, s87, 106496
    s_add_u32 s52, s91, 65536
    buffer_load_dwordx4 v36, s[32:35], s52 offen nt lds
    buffer_load_dwordx4 v37, s[32:35], s52 offen offset:1024 nt lds
    buffer_load_dwordx4 v38, s[32:35], s52 offen offset:2048 nt lds
    buffer_load_dwordx4 v39, s[32:35], s52 offen offset:3072 nt lds
    s_waitcnt vmcnt(36)
    v_cmp_lt_u32 vcc, 18, v24
    s_cbranch_vccnz A_lA18_ok
    s_cmp_ge_u32 s54, 25
    s_cbranch_scc1 A_lA18_25
    ds_read_b96 v[24:26], v17 offset:16
    s_waitcnt lgkmcnt(0)
    v_min3_u32 v24, v24, v25, v26
    v_cmp_lt_u32 vcc, 18, v24
    s_cbranch_vccnz A_lA18_ok
    s_waitcnt vmcnt(32)
    s_max_u32 s54, s54, 25
    v_mov_b32 v20, s54
    ds_write_b32 v17, v20
A_lA18_25:
    s_cmp_ge_u32 s54, 26
    s_cbranch_scc1 A_lA18_26
    ds_read_b96 v[24:26], v17 offset:16
    s_waitcnt lgkmcnt(0)
    v_min3_u32 v24, v24, v25, v26
    v_cmp_lt_u32 vcc, 18, v24
    s_cbranch_vccnz A_lA18_ok
    s_waitcnt vmcnt(16)
    s_max_u32 s54, s54, 26
    v_mov_b32 v20, s54
    ds_write_b32 v17, v20
A_lA18_26:
    s_cmp_ge_u32 s54, 27
    s_cbranch_scc1 A_lA18_27
    ds_read_b96 v[24:26], v17 offset:16
    s_waitcnt lgkmcnt(0)
    v_min3_u32 v24, v24, v25, v26
    v_cmp_lt_u32 vcc, 18, v24
    s_cbranch_vccnz A_lA18_ok
    s_waitcnt vmcnt(0)
    s_max_u32 s54, s54, 27
    v_mov_b32 v20, s54
    ds_write_b32 v17, v20
A_lA18_27:
A_lA18:
    s_sub_u32 s57, s57, 1
    s_cbranch_scc1 A_end
    ds_read_b96 v[24:26], v17 offset:16
    s_waitcnt lgkmcnt(0)
    v_min3_u32 v24, v24, v25, v26
    v_cmp_lt_u32 vcc, 18, v24
    s_cbranch_vccz A_lA18
A_lA18_ok:
    s_add_u32 m0, s84, 122880
    s_add_u32 s52, s88, 98304
    buffer_load_dwordx4 v36, s[32:35], s52 offen nt lds
    buffer_load_dwordx4 v37, s[32:35], s52 offen offset:1024 nt lds
    buffer_load_dwordx4 v38, s[32:35], s52 offen offset:2048 nt lds
    buffer_load_dwordx4 v39, s[32:35], s52 offen offset:3072 nt lds
    s_waitcnt vmcnt(36)
    s_max_u32 s54, s54, 25
    v_mov_b32 v20, s54
    ds_write_b32 v17, v20
    s_add_u32 m0, s85, 122880
    s_add_u32 s52, s89, 98304
    buffer_load_dwordx4 v36, s[32:35], s52 offen nt lds
    buffer_load_dwordx4 v37, s[32:35], s52 offen offset:1024 nt lds
    buffer_load_dwordx4 v38, s[32:35], s52 offen offset:2048 nt lds
    buffer_load_dwordx4 v39, s[32:35], s52 offen offset:3072 nt lds
    s_waitcnt vmcnt(36)
    s_add_u32 m0, s86, 122880
    s_add_u32 s52, s90, 98304
    buffer_load_dwordx4 v36, s[32:35], s52 offen nt lds
    buffer_load_dwordx4 v37, s[32:35], s52 offen offset:1024 nt lds
    buffer_load_dwordx4 v38, s[32:35], s52 offen offset:2048 nt lds
    buffer_load_dwordx4 v39, s[32:35], s52 offen offset:3072 nt lds
    s_waitcnt vmcnt(36)
    s_add_u32 m0, s87, 122880
    s_add_u32 s52, s91, 98304
    buffer_load_dwordx4 v36, s[32:35], s52 offen nt lds
    buffer_load_dwordx4 v37, s[32:35], s52 offen offset:1024 nt lds
    buffer_load_dwordx4 v38, s[32:35], s52 offen offset:2048 nt lds
    buffer_load_dwordx4 v39, s[32:35], s52 offen offset:3072 nt lds
    s_waitcnt vmcnt(36)
    v_cmp_lt_u32 vcc, 19, v24
    s_cbranch_vccnz A_lA19_ok
    s_cmp_ge_u32 s54, 26
    s_cbranch_scc1 A_lA19_26
    ds_read_b96 v[24:26], v17 offset:16
    s_waitcnt lgkmcnt(0)
    v_min3_u32 v24, v24, v25, v26
    v_cmp_lt_u32 vcc, 19, v24
    s_cbranch_vccnz A_lA19_ok
    s_waitcnt vmcnt(32)
    s_max_u32 s54, s54, 26
    v_mov_b32 v20, s54
    ds_write_b32 v17, v20
A_lA19_26:
    s_cmp_ge_u32 s54, 27
    s_cbranch_scc1 A_lA19_27
    ds_read_b96 v[24:26], v17 offset:16
    s_waitcnt lgkmcnt(0)
    v_min3_u32 v24, v24, v25, v26
    v_cmp_lt_u32 vcc, 19, v24
    s_cbranch_vccnz A_lA19_ok
    s_waitcnt vmcnt(16)
    s_max_u32 s54, s54, 27
    v_mov_b32 v20, s54
    ds_write_b32 v17, v20
A_lA19_27:
    s_cmp_ge_u32 s54, 28
    s_cbranch_scc1 A_lA19_28
    ds_read_b96 v[24:26], v17 offset:16
    s_waitcnt lgkmcnt(0)
    v_min3_u32 v24, v24, v25, v26
    v_cmp_lt_u32 vcc, 19, v24
    s_cbranch_vccnz A_lA19_ok
    s_waitcnt vmcnt(0)
    s_max_u32 s54, s54, 28
    v_mov_b32 v20, s54
    ds_write_b32 v17, v20
A_lA19_28:
A_lA19:
    s_sub_u32 s57, s57, 1
    s_cbranch_scc1 A_end
    ds_read_b96 v[24:26], v17 offset:16
    s_waitcnt lgkmcnt(0)
    v_min3_u32 v24, v24, v25, v26
    v_cmp_lt_u32 vcc, 19, v24
    s_cbranch_vccz A_lA19
A_lA19_ok:
    s_mov_b32 m0, 139264
    s_add_u32 s55, s53, 0
    s_and_b32 s55, s55, 7
    s_lshl_b32 s55, s55, 17
    s_add_u32 s52, s55, 0
    buffer_load_dwordx4 v32, s[44:47], s52 offen sc1 lds
    buffer_load_dwordx4 v33, s[44:47], s52 offen offset:1024 sc1 lds
    buffer_load_dwordx4 v34, s[44:47], s52 offen offset:2048 sc1 lds
    buffer_load_dwordx4 v35, s[44:47], s52 offen offset:3072 sc1 lds
    s_waitcnt vmcnt(36)
    s_max_u32 s54, s54, 26
    v_mov_b32 v20, s54
    ds_write_b32 v17, v20
    s_mov_b32 m0, 143360
    s_add_u32 s52, s55, 32768
    buffer_load_dwordx4 v32, s[44:47], s52 offen sc1 lds
    buffer_load_dwordx4 v33, s[44:47], s52 offen offset:1024 sc1 lds
    buffer_load_dwordx4 v34, s[44:47], s52 offen offset:2048 sc1 lds
    buffer_load_dwordx4 v35, s[44:47], s52 offen offset:3072 sc1 lds
    s_waitcnt vmcnt(36)
    s_mov_b32 m0, 147456
    s_add_u32 s55, s53, 1
    s_and_b32 s55, s55, 7
    s_lshl_b32 s55, s55, 17
    s_add_u32 s52, s55, 0
    buffer_load_dwordx4 v32, s[44:47], s52 offen sc1 lds
    buffer_load_dwordx4 v33, s[44:47], s52 offen offset:1024 sc1 lds
    buffer_load_dwordx4 v34, s[44:47], s52 offen offset:2048 sc1 lds
    buffer_load_dwordx4 v35, s[44:47], s52 offen offset:3072 sc1 lds
    s_waitcnt vmcnt(36)
    s_mov_b32 m0, 151552
    s_add_u32 s52, s55, 32768
    buffer_load_dwordx4 v32, s[44:47], s52 offen sc1 lds
    buffer_load_dwordx4 v33, s[44:47], s52 offen offset:1024 sc1 lds
    buffer_load_dwordx4 v34, s[44:47], s52 offen offset:2048 sc1 lds
    buffer_load_dwordx4 v35, s[44:47], s52 offen offset:3072 sc1 lds
    s_waitcnt vmcnt(36)
    v_cmp_lt_u32 vcc, 20, v24
    s_cbranch_vccnz A_lA20_ok
    s_cmp_ge_u32 s54, 27
    s_cbranch_scc1 A_lA20_27
    ds_read_b96 v[24:26], v17 offset:16
    s_waitcnt lgkmcnt(0)
    v_min3_u32 v24, v24, v25, v26
    v_cmp_lt_u32 vcc, 20, v24
    s_cbranch_vccnz A_lA20_ok
    s_waitcnt vmcnt(32)
    s_max_u32 s54, s54, 27
    v_mov_b32 v20, s54
    ds_write_b32 v17, v20
A_lA20_27:
    s_cmp_ge_u32 s54, 28
    s_cbranch_scc1 A_lA20_28
    ds_read_b96 v[24:26], v17 offset:16
    s_waitcnt lgkmcnt(0)
    v_min3_u32 v24, v24, v25, v26
    v_cmp_lt_u32 vcc, 20, v24
    s_cbranch_vccnz A_lA20_ok
    s_waitcnt vmcnt(16)
    s_max_u32 s54, s54, 28
    v_mov_b32 v20, s54
    ds_write_b32 v17, v20
A_lA20_28:
A_lA20:
    s_sub_u32 s57, s57, 1
    s_cbranch_scc1 A_end
    ds_read_b96 v[24:26], v17 offset:16
    s_waitcnt lgkmcnt(0)
    v_min3_u32 v24, v24, v25, v26
    v_cmp_lt_u32 vcc, 20, v24
    s_cbranch_vccz A_lA20
A_lA20_ok:
    s_add_u32 m0, s84, 0
    s_add_u32 s52, s88, 128
    buffer_load_dwordx4 v36, s[32:35], s52 offen nt lds
    buffer_load_dwordx4 v37, s[32:35], s52 offen offset:1024 nt lds
    buffer_load_dwordx4 v38, s[32:35], s52 offen offset:2048 nt lds
    buffer_load_dwordx4 v39, s[32:35], s52 offen offset:3072 nt lds
    s_waitcnt vmcnt(36)
    s_max_u32 s54, s54, 27
    v_mov_b32 v20, s54
    ds_write_b32 v17, v20
    s_add_u32 m0, s85, 0
    s_add_u32 s52, s89, 128
    buffer_load_dwordx4 v36, s[32:35], s52 offen nt lds
    buffer_load_dwordx4 v37, s[32:35], s52 offen offset:1024 nt lds
    buffer_load_dwordx4 v38, s[32:35], s52 offen offset:2048 nt lds
    buffer_load_dwordx4 v39, s[32:35], s52 offen offset:3072 nt lds
    s_waitcnt vmcnt(36)
    s_add_u32 m0, s86, 0
    s_add_u32 s52, s90, 128
    buffer_load_dwordx4 v36, s[32:35], s52 offen nt lds
    buffer_load_dwordx4 v37, s[32:35], s52 offen offset:1024 nt lds
    buffer_load_dwordx4 v38, s[32:35], s52 offen offset:2048 nt lds
    buffer_load_dwordx4 v39, s[32:35], s52 offen offset:3072 nt lds
    s_waitcnt vmcnt(36)
    s_add_u32 m0, s87, 0
    s_add_u32 s52, s91, 128
    buffer_load_dwordx4 v36, s[32:35], s52 offen nt lds
    buffer_load_dwordx4 v37, s[32:35], s52 offen offset:1024 nt lds
    buffer_load_dwordx4 v38, s[32:35], s52 offen offset:2048 nt lds
    buffer_load_dwordx4 v39, s[32:35], s52 offen offset:3072 nt lds
    s_waitcnt vmcnt(36)
    v_cmp_lt_u32 vcc, 21, v24
    s_cbranch_vccnz A_lA21_ok
    s_cmp_ge_u32 s54, 28
    s_cbranch_scc1 A_lA21_28
    ds_read_b96 v[24:26], v17 offset:16
    s_waitcnt lgkmcnt(0)
    v_min3_u32 v24, v24, v25, v26
    v_cmp_lt_u32 vcc, 21, v24
    s_cbranch_vccnz A_lA21_ok
    s_waitcnt vmcnt(32)
    s_max_u32 s54, s54, 28
    v_mov_b32 v20, s54
    ds_write_b32 v17, v20
A_lA21_28:
    s_cmp_ge_u32 s54, 29
    s_cbranch_scc1 A_lA21_29
    ds_read_b96 v[24:26], v17 offset:16
    s_waitcnt lgkmcnt(0)
    v_min3_u32 v24, v24, v25, v26
    v_cmp_lt_u32 vcc, 21, v24
    s_cbranch_vccnz A_lA21_ok
    s_waitcnt vmcnt(0)
    s_max_u32 s54, s54, 29
    v_mov_b32 v20, s54
    ds_write_b32 v17, v20
A_lA21_29:
A_lA21:
    s_sub_u32 s57, s57, 1
    s_cbranch_scc1 A_end
    ds_read_b96 v[24:26], v17 offset:16
    s_waitcnt lgkmcnt(0)
    v_min3_u32 v24, v24, v25, v26
    v_cmp_lt_u32 vcc, 21, v24
    s_cbranch_vccz A_lA21
A_lA21_ok:
    s_mov_b32 m0, 16384
    s_add_u32 s55, s53, 2
    s_and_b32 s55, s55, 7
    s_lshl_b32 s55, s55, 17
    s_add_u32 s52, s55, 0
    buffer_load_dwordx4 v32, s[44:47], s52 offen sc1 lds
    buffer_load_dwordx4 v33, s[44:47], s52 offen offset:1024 sc1 lds
    buffer_load_dwordx4 v34, s[44:47], s52 offen offset:2048 sc1 lds
    buffer_load_dwordx4 v35, s[44:47], s52 offen offset:3072 sc1 lds
    s_waitcnt vmcnt(36)
    s_max_u32 s54, s54, 28
    v_mov_b32 v20, s54
    ds_write_b32 v17, v20
    s_mov_b32 m0, 20480
    s_add_u32 s52, s55, 32768
    buffer_load_dwordx4 v32, s[44:47], s52 offen sc1 lds
    buffer_load_dwordx4 v33, s[44:47], s52 offen offset:1024 sc1 lds
    buffer_load_dwordx4 v34, s[44:47], s52 offen offset:2048 sc1 lds
    buffer_load_dwordx4 v35, s[44:47], s52 offen offset:3072 sc1 lds
    s_waitcnt vmcnt(36)
    s_mov_b32 m0, 24576
    s_add_u32 s55, s53, 3
    s_and_b32 s55, s55, 7
    s_lshl_b32 s55, s55, 17
    s_add_u32 s52, s55, 0
    buffer_load_dwordx4 v32, s[44:47], s52 offen sc1 lds
    buffer_load_dwordx4 v33, s[44:47], s52 offen offset:1024 sc1 lds
    buffer_load_dwordx4 v34, s[44:47], s52 offen offset:2048 sc1 lds
    buffer_load_dwordx4 v35, s[44:47], s52 offen offset:3072 sc1 lds
    s_waitcnt vmcnt(36)
    s_mov_b32 m0, 28672
    s_add_u32 s52, s55, 32768
    buffer_load_dwordx4 v32, s[44:47], s52 offen sc1 lds
    buffer_load_dwordx4 v33, s[44:47], s52 offen offset:1024 sc1 lds
    buffer_load_dwordx4 v34, s[44:47], s52 offen offset:2048 sc1 lds
    buffer_load_dwordx4 v35, s[44:47], s52 offen offset:3072 sc1 lds
    s_waitcnt vmcnt(36)
    v_cmp_lt_u32 vcc, 22, v24
    s_cbranch_vccnz A_lA22_ok
    s_cmp_ge_u32 s54, 29
    s_cbranch_scc1 A_lA22_29
    ds_read_b96 v[24:26], v17 offset:16
    s_waitcnt lgkmcnt(0)
    v_min3_u32 v24, v24, v25, v26
    v_cmp_lt_u32 vcc, 22, v24
    s_cbranch_vccnz A_lA22_ok
    s_waitcnt vmcnt(16)
    s_max_u32 s54, s54, 29
    v_mov_b32 v20, s54
    ds_write_b32 v17, v20
A_lA22_29:
A_lA22:
    s_sub_u32 s57, s57, 1
    s_cbranch_scc1 A_end
    ds_read_b96 v[24:26], v17 offset:16
    s_waitcnt lgkmcnt(0)
    v_min3_u32 v24, v24, v25, v26
    v_cmp_lt_u32 vcc, 22, v24
    s_cbranch_vccz A_lA22
A_lA22_ok:
    s_add_u32 m0, s84, 32768
    s_add_u32 s52, s88, 32896
    buffer_load_dwordx4 v36, s[32:35], s52 offen nt lds
    buffer_load_dwordx4 v37, s[32:35], s52 offen offset:1024 nt lds
    buffer_load_dwordx4 v38, s[32:35], s52 offen offset:2048 nt lds
    buffer_load_dwordx4 v39, s[32:35], s52 offen offset:3072 nt lds
    s_waitcnt vmcnt(36)
    s_add_u32 m0, s85, 32768
    s_add_u32 s52, s89, 32896
    buffer_load_dwordx4 v36, s[32:35], s52 offen nt lds
    buffer_load_dwordx4 v37, s[32:35], s52 offen offset:1024 nt lds
    buffer_load_dwordx4 v38, s[32:35], s52 offen offset:2048 nt lds
    buffer_load_dwordx4 v39, s[32:35], s52 offen offset:3072 nt lds
    s_waitcnt vmcnt(36)
    s_add_u32 m0, s86, 32768
    s_add_u32 s52, s90, 32896
    buffer_load_dwordx4 v36, s[32:35], s52 offen nt lds
    buffer_load_dwordx4 v37, s[32:35], s52 offen offset:1024 nt lds
    buffer_load_dwordx4 v38, s[32:35], s52 offen offset:2048 nt lds
    buffer_load_dwordx4 v39, s[32:35], s52 offen offset:3072 nt lds
    s_waitcnt vmcnt(36)
    s_add_u32 m0, s87, 32768
    s_add_u32 s52, s91, 32896
    buffer_load_dwordx4 v36, s[32:35], s52 offen nt lds
    buffer_load_dwordx4 v37, s[32:35], s52 offen offset:1024 nt lds
    buffer_load_dwordx4 v38, s[32:35], s52 offen offset:2048 nt lds
    buffer_load_dwordx4 v39, s[32:35], s52 offen offset:3072 nt lds
    s_waitcnt vmcnt(36)
    v_cmp_lt_u32 vcc, 23, v24
    s_cbranch_vccnz A_lA23_ok
    s_cmp_ge_u32 s54, 29
    s_cbranch_scc1 A_lA23_29
    ds_read_b96 v[24:26], v17 offset:16
    s_waitcnt lgkmcnt(0)
    v_min3_u32 v24, v24, v25, v26
    v_cmp_lt_u32 vcc, 23, v24
    s_cbranch_vccnz A_lA23_ok
    s_waitcnt vmcnt(32)
    s_max_u32 s54, s54, 29
    v_mov_b32 v20, s54
    ds_write_b32 v17, v20
A_lA23_29:
    s_cmp_ge_u32 s54, 30
    s_cbranch_scc1 A_lA23_30
    ds_read_b96 v[24:26], v17 offset:16
    s_waitcnt lgkmcnt(0)
    v_min3_u32 v24, v24, v25, v26
    v_cmp_lt_u32 vcc, 23, v24
    s_cbranch_vccnz A_lA23_ok
    s_waitcnt vmcnt(0)
    s_max_u32 s54, s54, 30
    v_mov_b32 v20, s54
    ds_write_b32 v17, v20
A_lA23_30:
A_lA23:
    s_sub_u32 s57, s57, 1
    s_cbranch_scc1 A_end
    ds_read_b96 v[24:26], v17 offset:16
    s_waitcnt lgkmcnt(0)
    v_min3_u32 v24, v24, v25, v26
    v_cmp_lt_u32 vcc, 23, v24
    s_cbranch_vccz A_lA23
A_lA23_ok:
    s_mov_b32 m0, 49152
    s_add_u32 s55, s53, 4
    s_and_b32 s55, s55, 7
    s_lshl_b32 s55, s55, 17
    s_add_u32 s52, s55, 0
    buffer_load_dwordx4 v32, s[44:47], s52 offen sc1 lds
    buffer_load_dwordx4 v33, s[44:47], s52 offen offset:1024 sc1 lds
    buffer_load_dwordx4 v34, s[44:47], s52 offen offset:2048 sc1 lds
    buffer_load_dwordx4 v35, s[44:47], s52 offen offset:3072 sc1 lds
    s_waitcnt vmcnt(36)
    s_max_u32 s54, s54, 29
    v_mov_b32 v20, s54
    ds_write_b32 v17, v20
    s_mov_b32 m0, 53248
    s_add_u32 s52, s55, 32768
    buffer_load_dwordx4 v32, s[44:47], s52 offen sc1 lds
    buffer_load_dwordx4 v33, s[44:47], s52 offen offset:1024 sc1 lds
    buffer_load_dwordx4 v34, s[44:47], s52 offen offset:2048 sc1 lds
    buffer_load_dwordx4 v35, s[44:47], s52 offen offset:3072 sc1 lds
    s_waitcnt vmcnt(36)
    s_mov_b32 m0, 57344
    s_add_u32 s55, s53, 5
    s_and_b32 s55, s55, 7
    s_lshl_b32 s55, s55, 17
    s_add_u32 s52, s55, 0
    buffer_load_dwordx4 v32, s[44:47], s52 offen sc1 lds
    buffer_load_dwordx4 v33, s[44:47], s52 offen offset:1024 sc1 lds
    buffer_load_dwordx4 v34, s[44:47], s52 offen offset:2048 sc1 lds
    buffer_load_dwordx4 v35, s[44:47], s52 offen offset:3072 sc1 lds
    s_waitcnt vmcnt(36)
    s_mov_b32 m0, 61440
    s_add_u32 s52, s55, 32768
    buffer_load_dwordx4 v32, s[44:47], s52 offen sc1 lds
    buffer_load_dwordx4 v33, s[44:47], s52 offen offset:1024 sc1 lds
    buffer_load_dwordx4 v34, s[44:47], s52 offen offset:2048 sc1 lds
    buffer_load_dwordx4 v35, s[44:47], s52 offen offset:3072 sc1 lds
    s_waitcnt vmcnt(36)
    v_cmp_lt_u32 vcc, 24, v24
    s_cbranch_vccnz A_lA24_ok
    s_cmp_ge_u32 s54, 30
    s_cbranch_scc1 A_lA24_30
    ds_read_b96 v[24:26], v17 offset:16
    s_waitcnt lgkmcnt(0)
    v_min3_u32 v24, v24, v25, v26
    v_cmp_lt_u32 vcc, 24, v24
    s_cbranch_vccnz A_lA24_ok
    s_waitcnt vmcnt(16)
    s_max_u32 s54, s54, 30
    v_mov_b32 v20, s54
    ds_write_b32 v17, v20
A_lA24_30:
A_lA24:
    s_sub_u32 s57, s57, 1
    s_cbranch_scc1 A_end
    ds_read_b96 v[24:26], v17 offset:16
    s_waitcnt lgkmcnt(0)
    v_min3_u32 v24, v24, v25, v26
    v_cmp_lt_u32 vcc, 24, v24
    s_cbranch_vccz A_lA24
A_lA24_ok:
    s_add_u32 m0, s84, 65536
    s_add_u32 s52, s88, 65664
    buffer_load_dwordx4 v36, s[32:35], s52 offen nt lds
    buffer_load_dwordx4 v37, s[32:35], s52 offen offset:1024 nt lds
    buffer_load_dwordx4 v38, s[32:35], s52 offen offset:2048 nt lds
    buffer_load_dwordx4 v39, s[32:35], s52 offen offset:3072 nt lds
    s_waitcnt vmcnt(36)
    s_add_u32 m0, s85, 65536
    s_add_u32 s52, s89, 65664
    buffer_load_dwordx4 v36, s[32:35], s52 offen nt lds
    buffer_load_dwordx4 v37, s[32:35], s52 offen offset:1024 nt lds
    buffer_load_dwordx4 v38, s[32:35], s52 offen offset:2048 nt lds
    buffer_load_dwordx4 v39, s[32:35], s52 offen offset:3072 nt lds
    s_waitcnt vmcnt(36)
    s_add_u32 m0, s86, 65536
    s_add_u32 s52, s90, 65664
    buffer_load_dwordx4 v36, s[32:35], s52 offen nt lds
    buffer_load_dwordx4 v37, s[32:35], s52 offen offset:1024 nt lds
    buffer_load_dwordx4 v38, s[32:35], s52 offen offset:2048 nt lds
    buffer_load_dwordx4 v39, s[32:35], s52 offen offset:3072 nt lds
    s_waitcnt vmcnt(36)
    s_add_u32 m0, s87, 65536
    s_add_u32 s52, s91, 65664
    buffer_load_dwordx4 v36, s[32:35], s52 offen nt lds
    buffer_load_dwordx4 v37, s[32:35], s52 offen offset:1024 nt lds
    buffer_load_dwordx4 v38, s[32:35], s52 offen offset:2048 nt lds
    buffer_load_dwordx4 v39, s[32:35], s52 offen offset:3072 nt lds
    s_waitcnt vmcnt(36)
    v_cmp_lt_u32 vcc, 25, v24
    s_cbranch_vccnz A_lA25_ok
    s_cmp_ge_u32 s54, 30
    s_cbranch_scc1 A_lA25_30
    ds_read_b96 v[24:26], v17 offset:16
    s_waitcnt lgkmcnt(0)
    v_min3_u32 v24, v24, v25, v26
    v_cmp_lt_u32 vcc, 25, v24
    s_cbranch_vccnz A_lA25_ok
    s_waitcnt vmcnt(32)
    s_max_u32 s54, s54, 30
    v_mov_b32 v20, s54
    ds_write_b32 v17, v20
A_lA25_30:
    s_cmp_ge_u32 s54, 31
    s_cbranch_scc1 A_lA25_31
    ds_read_b96 v[24:26], v17 offset:16
    s_waitcnt lgkmcnt(0)
    v_min3_u32 v24, v24, v25, v26
    v_cmp_lt_u32 vcc, 25, v24
    s_cbranch_vccnz A_lA25_ok
    s_waitcnt vmcnt(0)
    s_max_u32 s54, s54, 31
    v_mov_b32 v20, s54
    ds_write_b32 v17, v20
A_lA25_31:
A_lA25:
    s_sub_u32 s57, s57, 1
    s_cbranch_scc1 A_end
    ds_read_b96 v[24:26], v17 offset:16
    s_waitcnt lgkmcnt(0)
    v_min3_u32 v24, v24, v25, v26
    v_cmp_lt_u32 vcc, 25, v24
    s_cbranch_vccz A_lA25
A_lA25_ok:
    s_mov_b32 m0, 90112
    s_add_u32 s55, s53, 6
    s_and_b32 s55, s55, 7
    s_lshl_b32 s55, s55, 17
    s_add_u32 s52, s55, 0
    buffer_load_dwordx4 v32, s[44:47], s52 offen sc1 lds
    buffer_load_dwordx4 v33, s[44:47], s52 offen offset:1024 sc1 lds
    buffer_load_dwordx4 v34, s[44:47], s52 offen offset:2048 sc1 lds
    buffer_load_dwordx4 v35, s[44:47], s52 offen offset:3072 sc1 lds
    s_waitcnt vmcnt(36)
    s_max_u32 s54, s54, 30
    v_mov_b32 v20, s54
    ds_write_b32 v17, v20
    s_mov_b32 m0, 94208
    s_add_u32 s52, s55, 32768
    buffer_load_dwordx4 v32, s[44:47], s52 offen sc1 lds
    buffer_load_dwordx4 v33, s[44:47], s52 offen offset:1024 sc1 lds
    buffer_load_dwordx4 v34, s[44:47], s52 offen offset:2048 sc1 lds
    buffer_load_dwordx4 v35, s[44:47], s52 offen offset:3072 sc1 lds
    s_waitcnt vmcnt(36)
    s_mov_b32 m0, 98304
    s_add_u32 s55, s53, 7
    s_and_b32 s55, s55, 7
    s_lshl_b32 s55, s55, 17
    s_add_u32 s52, s55, 0
    buffer_load_dwordx4 v32, s[44:47], s52 offen sc1 lds
    buffer_load_dwordx4 v33, s[44:47], s52 offen offset:1024 sc1 lds
    buffer_load_dwordx4 v34, s[44:47], s52 offen offset:2048 sc1 lds
    buffer_load_dwordx4 v35, s[44:47], s52 offen offset:3072 sc1 lds
    s_waitcnt vmcnt(36)
    s_mov_b32 m0, 102400
    s_add_u32 s52, s55, 32768
    buffer_load_dwordx4 v32, s[44:47], s52 offen sc1 lds
    buffer_load_dwordx4 v33, s[44:47], s52 offen offset:1024 sc1 lds
    buffer_load_dwordx4 v34, s[44:47], s52 offen offset:2048 sc1 lds
    buffer_load_dwordx4 v35, s[44:47], s52 offen offset:3072 sc1 lds
    s_waitcnt vmcnt(36)
    s_waitcnt vmcnt(16)
    s_max_u32 s54, s54, 31
    v_mov_b32 v20, s54
    ds_write_b32 v17, v20
    v_cmp_lt_u32 vcc, 26, v24
    s_cbranch_vccnz A_lA26_ok
A_lA26:
    s_sub_u32 s57, s57, 1
    s_cbranch_scc1 A_end
    ds_read_b96 v[24:26], v17 offset:16
    s_waitcnt lgkmcnt(0)
    v_min3_u32 v24, v24, v25, v26
    v_cmp_lt_u32 vcc, 26, v24
    s_cbranch_vccz A_lA26
A_lA26_ok:
    s_mov_b32 m0, 106496
    s_mov_b32 s52, 98432
    buffer_load_dwordx4 v36, s[32:35], s52 offen nt lds
    buffer_load_dwordx4 v37, s[32:35], s52 offen offset:1024 nt lds
    buffer_load_dwordx4 v38, s[32:35], s52 offen offset:2048 nt lds
    buffer_load_dwordx4 v39, s[32:35], s52 offen offset:3072 nt lds
    s_mov_b32 m0, 110592
    s_mov_b32 s52, 106624
    buffer_load_dwordx4 v36, s[32:35], s52 offen nt lds
    buffer_load_dwordx4 v37, s[32:35], s52 offen offset:1024 nt lds
    buffer_load_dwordx4 v38, s[32:35], s52 offen offset:2048 nt lds
    buffer_load_dwordx4 v39, s[32:35], s52 offen offset:3072 nt lds
    s_mov_b32 m0, 114688
    s_mov_b32 s52, 114816
    buffer_load_dwordx4 v36, s[32:35], s52 offen nt lds
    buffer_load_dwordx4 v37, s[32:35], s52 offen offset:1024 nt lds
    buffer_load_dwordx4 v38, s[32:35], s52 offen offset:2048 nt lds
    buffer_load_dwordx4 v39, s[32:35], s52 offen offset:3072 nt lds
    s_mov_b32 m0, 118784
    s_mov_b32 s52, 123008
    buffer_load_dwordx4 v36, s[32:35], s52 offen nt lds
    buffer_load_dwordx4 v37, s[32:35], s52 offen offset:1024 nt lds
    buffer_load_dwordx4 v38, s[32:35], s52 offen offset:2048 nt lds
    buffer_load_dwordx4 v39, s[32:35], s52 offen offset:3072 nt lds
    v_cmp_lt_u32 vcc, 27, v24
    s_cbranch_vccnz A_lA27_ok
    s_cmp_ge_u32 s54, 32
    s_cbranch_scc1 A_lA27_32
    ds_read_b96 v[24:26], v17 offset:16
    s_waitcnt lgkmcnt(0)
    v_min3_u32 v24, v24, v25, v26
    v_cmp_lt_u32 vcc, 27, v24
    s_cbranch_vccnz A_lA27_ok
    s_waitcnt vmcnt(8)
    s_max_u32 s54, s54, 32
    v_mov_b32 v20, s54
    ds_write_b32 v17, v20
A_lA27_32:
    s_cmp_ge_u32 s54, 37
    s_cbranch_scc1 A_lA27_37
    ds_read_b96 v[24:26], v17 offset:16
    s_waitcnt lgkmcnt(0)
    v_min3_u32 v24, v24, v25, v26
    v_cmp_lt_u32 vcc, 27, v24
    s_cbranch_vccnz A_lA27_ok
    s_waitcnt vmcnt(0)
    s_max_u32 s54, s54, 37
    v_mov_b32 v20, s54
    ds_write_b32 v17, v20
A_lA27_37:
A_lA27:
    s_sub_u32 s57, s57, 1
    s_cbranch_scc1 A_end
    ds_read_b96 v[24:26], v17 offset:16
    s_waitcnt lgkmcnt(0)
    v_min3_u32 v24, v24, v25, v26
    v_cmp_lt_u32 vcc, 27, v24
    s_cbranch_vccz A_lA27
A_lA27_ok:
    s_mov_b32 m0, 122880
    s_add_u32 s55, s53, 0
    s_and_b32 s55, s55, 7
    s_lshl_b32 s55, s55, 17
    s_add_u32 s52, s55, 65536
    buffer_load_dwordx4 v32, s[44:47], s52 offen sc1 lds
    buffer_load_dwordx4 v33, s[44:47], s52 offen offset:1024 sc1 lds
    buffer_load_dwordx4 v34, s[44:47], s52 offen offset:2048 sc1 lds
    buffer_load_dwordx4 v35, s[44:47], s52 offen offset:3072 sc1 lds
    s_mov_b32 m0, 126976
    s_add_u32 s52, s55, 98304
    buffer_load_dwordx4 v32, s[44:47], s52 offen sc1 lds
    buffer_load_dwordx4 v33, s[44:47], s52 offen offset:1024 sc1 lds
    buffer_load_dwordx4 v34, s[44:47], s52 offen offset:2048 sc1 lds
    buffer_load_dwordx4 v35, s[44:47], s52 offen offset:3072 sc1 lds
    s_waitcnt vmcnt(36)
    s_waitcnt vmcnt(16)
    v_mov_b32 v21, 1
    ds_write_b32 v17, v21 offset:4
    s_max_u32 s54, s54, 32
    v_mov_b32 v20, s54
    ds_write_b32 v17, v20
    s_mov_b32 m0, 131072
    s_add_u32 s55, s53, 1
    s_and_b32 s55, s55, 7
    s_lshl_b32 s55, s55, 17
    s_add_u32 s52, s55, 65536
    buffer_load_dwordx4 v32, s[44:47], s52 offen sc1 lds
    buffer_load_dwordx4 v33, s[44:47], s52 offen offset:1024 sc1 lds
    buffer_load_dwordx4 v34, s[44:47], s52 offen offset:2048 sc1 lds
    buffer_load_dwordx4 v35, s[44:47], s52 offen offset:3072 sc1 lds
    s_mov_b32 m0, 135168
    s_add_u32 s52, s55, 98304
    buffer_load_dwordx4 v32, s[44:47], s52 offen sc1 lds
    buffer_load_dwordx4 v33, s[44:47], s52 offen offset:1024 sc1 lds
    buffer_load_dwordx4 v34, s[44:47], s52 offen offset:2048 sc1 lds
    buffer_load_dwordx4 v35, s[44:47], s52 offen offset:3072 sc1 lds
    s_waitcnt vmcnt(16)
    s_max_u32 s54, s54, 37
    v_mov_b32 v20, s54
    ds_write_b32 v17, v20
    v_cmp_lt_u32 vcc, 28, v24
    s_cbranch_vccnz A_lA28_ok
    s_cmp_ge_u32 s54, 38
    s_cbranch_scc1 A_lA28_38
    ds_read_b96 v[24:26], v17 offset:16
    s_waitcnt lgkmcnt(0)
    v_min3_u32 v24, v24, v25, v26
    v_cmp_lt_u32 vcc, 28, v24
    s_cbranch_vccnz A_lA28_ok
    s_waitcnt vmcnt(0)
    s_max_u32 s54, s54, 38
    v_mov_b32 v20, s54
    ds_write_b32 v17, v20
A_lA28_38:
A_lA28:
    s_sub_u32 s57, s57, 1
    s_cbranch_scc1 A_end
    ds_read_b96 v[24:26], v17 offset:16
    s_waitcnt lgkmcnt(0)
    v_min3_u32 v24, v24, v25, v26
    v_cmp_lt_u32 vcc, 28, v24
    s_cbranch_vccz A_lA28
A_lA28_ok:
    s_mov_b32 m0, 0
    s_add_u32 s55, s53, 2
    s_and_b32 s55, s55, 7
    s_lshl_b32 s55, s55, 17
    s_add_u32 s52, s55, 65536
    buffer_load_dwordx4 v32, s[44:47], s52 offen sc1 lds
    buffer_load_dwordx4 v33, s[44:47], s52 offen offset:1024 sc1 lds
    buffer_load_dwordx4 v34, s[44:47], s52 offen offset:2048 sc1 lds
    buffer_load_dwordx4 v35, s[44:47], s52 offen offset:3072 sc1 lds
    s_mov_b32 m0, 4096
    s_add_u32 s52, s55, 98304
    buffer_load_dwordx4 v32, s[44:47], s52 offen sc1 lds
    buffer_load_dwordx4 v33, s[44:47], s52 offen offset:1024 sc1 lds
    buffer_load_dwordx4 v34, s[44:47], s52 offen offset:2048 sc1 lds
    buffer_load_dwordx4 v35, s[44:47], s52 offen offset:3072 sc1 lds
    s_mov_b32 m0, 8192
    s_add_u32 s55, s53, 3
    s_and_b32 s55, s55, 7
    s_lshl_b32 s55, s55, 17
    s_add_u32 s52, s55, 65536
    buffer_load_dwordx4 v32, s[44:47], s52 offen sc1 lds
    buffer_load_dwordx4 v33, s[44:47], s52 offen offset:1024 sc1 lds
    buffer_load_dwordx4 v34, s[44:47], s52 offen offset:2048 sc1 lds
    buffer_load_dwordx4 v35, s[44:47], s52 offen offset:3072 sc1 lds
    s_mov_b32 m0, 12288
    s_add_u32 s52, s55, 98304
    buffer_load_dwordx4 v32, s[44:47], s52 offen sc1 lds
    buffer_load_dwordx4 v33, s[44:47], s52 offen offset:1024 sc1 lds
    buffer_load_dwordx4 v34, s[44:47], s52 offen offset:2048 sc1 lds
    buffer_load_dwordx4 v35, s[44:47], s52 offen offset:3072 sc1 lds
    v_cmp_lt_u32 vcc, 29, v24
    s_cbranch_vccnz A_lA29_ok
    s_cmp_ge_u32 s54, 38
    s_cbranch_scc1 A_lA29_38
    ds_read_b96 v[24:26], v17 offset:16
    s_waitcnt lgkmcnt(0)
    v_min3_u32 v24, v24, v25, v26
    v_cmp_lt_u32 vcc, 29, v24
    s_cbranch_vccnz A_lA29_ok
    s_waitcnt vmcnt(16)
    s_max_u32 s54, s54, 38
    v_mov_b32 v20, s54
    ds_write_b32 v17, v20
A_lA29_38:
    s_cmp_ge_u32 s54, 39
    s_cbranch_scc1 A_lA29_39
    ds_read_b96 v[24:26], v17 offset:16
    s_waitcnt lgkmcnt(0)
    v_min3_u32 v24, v24, v25, v26
    v_cmp_lt_u32 vcc, 29, v24
    s_cbranch_vccnz A_lA29_ok
    s_waitcnt vmcnt(0)
    s_max_u32 s54, s54, 39
    v_mov_b32 v20, s54
    ds_write_b32 v17, v20
A_lA29_39:
A_lA29:
    s_sub_u32 s57, s57, 1
    s_cbranch_scc1 A_end
    ds_read_b96 v[24:26], v17 offset:16
    s_waitcnt lgkmcnt(0)
    v_min3_u32 v24, v24, v25, v26
    v_cmp_lt_u32 vcc, 29, v24
    s_cbranch_vccz A_lA29
A_lA29_ok:
    s_mov_b32 m0, 32768
    s_add_u32 s55, s53, 4
    s_and_b32 s55, s55, 7
    s_lshl_b32 s55, s55, 17
    s_add_u32 s52, s55, 65536
    buffer_load_dwordx4 v32, s[44:47], s52 offen sc1 lds
    buffer_load_dwordx4 v33, s[44:47], s52 offen offset:1024 sc1 lds
    buffer_load_dwordx4 v34, s[44:47], s52 offen offset:2048 sc1 lds
    buffer_load_dwordx4 v35, s[44:47], s52 offen offset:3072 sc1 lds
    s_mov_b32 m0, 36864
    s_add_u32 s52, s55, 98304
    buffer_load_dwordx4 v32, s[44:47], s52 offen sc1 lds
    buffer_load_dwordx4 v33, s[44:47], s52 offen offset:1024 sc1 lds
    buffer_load_dwordx4 v34, s[44:47], s52 offen offset:2048 sc1 lds
    buffer_load_dwordx4 v35, s[44:47], s52 offen offset:3072 sc1 lds
    s_waitcnt vmcnt(36)
    s_mov_b32 m0, 40960
    s_add_u32 s55, s53, 5
    s_and_b32 s55, s55, 7
    s_lshl_b32 s55, s55, 17
    s_add_u32 s52, s55, 65536
    buffer_load_dwordx4 v32, s[44:47], s52 offen sc1 lds
    buffer_load_dwordx4 v33, s[44:47], s52 offen offset:1024 sc1 lds
    buffer_load_dwordx4 v34, s[44:47], s52 offen offset:2048 sc1 lds
    buffer_load_dwordx4 v35, s[44:47], s52 offen offset:3072 sc1 lds
    s_waitcnt vmcnt(36)
    s_mov_b32 m0, 45056
    s_add_u32 s52, s55, 98304
    buffer_load_dwordx4 v32, s[44:47], s52 offen sc1 lds
    buffer_load_dwordx4 v33, s[44:47], s52 offen offset:1024 sc1 lds
    buffer_load_dwordx4 v34, s[44:47], s52 offen offset:2048 sc1 lds
    buffer_load_dwordx4 v35, s[44:47], s52 offen offset:3072 sc1 lds
    s_waitcnt vmcnt(36)
    v_cmp_lt_u32 vcc, 30, v24
    s_cbranch_vccnz A_lA30_ok
    s_cmp_ge_u32 s54, 38
    s_cbranch_scc1 A_lA30_38
    ds_read_b96 v[24:26], v17 offset:16
    s_waitcnt lgkmcnt(0)
    v_min3_u32 v24, v24, v25, v26
    v_cmp_lt_u32 vcc, 30, v24
    s_cbranch_vccnz A_lA30_ok
    s_waitcnt vmcnt(32)
    s_max_u32 s54, s54, 38
    v_mov_b32 v20, s54
    ds_write_b32 v17, v20
A_lA30_38:
    s_cmp_ge_u32 s54, 39
    s_cbranch_scc1 A_lA30_39
    ds_read_b96 v[24:26], v17 offset:16
    s_waitcnt lgkmcnt(0)
    v_min3_u32 v24, v24, v25, v26
    v_cmp_lt_u32 vcc, 30, v24
    s_cbranch_vccnz A_lA30_ok
    s_waitcnt vmcnt(16)
    s_max_u32 s54, s54, 39
    v_mov_b32 v20, s54
    ds_write_b32 v17, v20
A_lA30_39:
    s_cmp_ge_u32 s54, 40
    s_cbranch_scc1 A_lA30_40
    ds_read_b96 v[24:26], v17 offset:16
    s_waitcnt lgkmcnt(0)
    v_min3_u32 v24, v24, v25, v26
    v_cmp_lt_u32 vcc, 30, v24
    s_cbranch_vccnz A_lA30_ok
    s_waitcnt vmcnt(0)
    s_max_u32 s54, s54, 40
    v_mov_b32 v20, s54
    ds_write_b32 v17, v20
A_lA30_40:
A_lA30:
    s_sub_u32 s57, s57, 1
    s_cbranch_scc1 A_end
    ds_read_b96 v[24:26], v17 offset:16
    s_waitcnt lgkmcnt(0)
    v_min3_u32 v24, v24, v25, v26
    v_cmp_lt_u32 vcc, 30, v24
    s_cbranch_vccz A_lA30
A_lA30_ok:
    s_mov_b32 m0, 65536
    s_add_u32 s55, s53, 6
    s_and_b32 s55, s55, 7
    s_lshl_b32 s55, s55, 17
    s_add_u32 s52, s55, 65536
    buffer_load_dwordx4 v32, s[44:47], s52 offen sc1 lds
    buffer_load_dwordx4 v33, s[44:47], s52 offen offset:1024 sc1 lds
    buffer_load_dwordx4 v34, s[44:47], s52 offen offset:2048 sc1 lds
    buffer_load_dwordx4 v35, s[44:47], s52 offen offset:3072 sc1 lds
    s_waitcnt vmcnt(36)
    s_max_u32 s54, s54, 38
    v_mov_b32 v20, s54
    ds_write_b32 v17, v20
    s_mov_b32 m0, 69632
    s_add_u32 s52, s55, 98304
    buffer_load_dwordx4 v32, s[44:47], s52 offen sc1 lds
    buffer_load_dwordx4 v33, s[44:47], s52 offen offset:1024 sc1 lds
    buffer_load_dwordx4 v34, s[44:47], s52 offen offset:2048 sc1 lds
    buffer_load_dwordx4 v35, s[44:47], s52 offen offset:3072 sc1 lds
    s_waitcnt vmcnt(36)
    s_mov_b32 m0, 73728
    s_add_u32 s55, s53, 7
    s_and_b32 s55, s55, 7
    s_lshl_b32 s55, s55, 17
    s_add_u32 s52, s55, 65536
    buffer_load_dwordx4 v32, s[44:47], s52 offen sc1 lds
    buffer_load_dwordx4 v33, s[44:47], s52 offen offset:1024 sc1 lds
    buffer_load_dwordx4 v34, s[44:47], s52 offen offset:2048 sc1 lds
    buffer_load_dwordx4 v35, s[44:47], s52 offen offset:3072 sc1 lds
    s_waitcnt vmcnt(36)
    s_mov_b32 m0, 77824
    s_add_u32 s52, s55, 98304
    buffer_load_dwordx4 v32, s[44:47], s52 offen sc1 lds
    buffer_load_dwordx4 v33, s[44:47], s52 offen offset:1024 sc1 lds
    buffer_load_dwordx4 v34, s[44:47], s52 offen offset:2048 sc1 lds
    buffer_load_dwordx4 v35, s[44:47], s52 offen offset:3072 sc1 lds
    s_waitcnt vmcnt(32)
    s_max_u32 s54, s54, 39
    v_mov_b32 v20, s54
    ds_write_b32 v17, v20
    s_waitcnt vmcnt(16)
    s_max_u32 s54, s54, 40
    v_mov_b32 v20, s54
    ds_write_b32 v17, v20
    s_waitcnt vmcnt(0)
    s_max_u32 s54, s54, 41
    v_mov_b32 v20, s54
    ds_write_b32 v17, v20
    s_endpgm
A_loadB:
    s_waitcnt vmcnt(28)
    s_max_u32 s54, s54, 2
    v_mov_b32 v20, s54
    ds_write_b32 v17, v20
    s_lshr_b32 s22, s2, 3
    s_lshl_b32 s22, s22, 15
    s_and_b32 s23, s20, 7
    s_lshl_b32 s23, s23, 7
    s_sub_u32 s52, s22, s23
    v_lshlrev_b32 v40, 7, v0
    v_add_u32 v40, s52, v40
    buffer_load_dword v56, v40, s[44:47], 0 offen
    v_add_u32 v40, 8192, v40
    buffer_load_dword v57, v40, s[44:47], 0 offen
    v_add_u32 v40, 8192, v40
    buffer_load_dword v58, v40, s[44:47], 0 offen
    v_add_u32 v40, 8192, v40
    buffer_load_dword v59, v40, s[44:47], 0 offen
    v_add_u32 v40, 8192, v40
    s_add_u32 m0, s84, 90112
    s_add_u32 s52, s84, 0
    buffer_load_dwordx4 v4, s[28:31], s52 offen nt lds
    buffer_load_dwordx4 v5, s[28:31], s52 offen offset:1024 nt lds
    buffer_load_dwordx4 v6, s[28:31], s52 offen offset:2048 nt lds
    buffer_load_dwordx4 v7, s[28:31], s52 offen offset:3072 nt lds
    s_add_u32 m0, s85, 90112
    s_add_u32 s52, s85, 0
    buffer_load_dwordx4 v4, s[28:31], s52 offen nt lds
    buffer_load_dwordx4 v5, s[28:31], s52 offen offset:1024 nt lds
    buffer_load_dwordx4 v6, s[28:31], s52 offen offset:2048 nt lds
    buffer_load_dwordx4 v7, s[28:31], s52 offen offset:3072 nt lds
    s_waitcnt vmcnt(36)
    s_add_u32 m0, s86, 90112
    s_add_u32 s52, s86, 0
    buffer_load_dwordx4 v4, s[28:31], s52 offen nt lds
    buffer_load_dwordx4 v5, s[28:31], s52 offen offset:1024 nt lds
    buffer_load_dwordx4 v6, s[28:31], s52 offen offset:2048 nt lds
    buffer_load_dwordx4 v7, s[28:31], s52 offen offset:3072 nt lds
    s_waitcnt vmcnt(36)
    s_max_u32 s54, s54, 3
    v_mov_b32 v20, s54
    ds_write_b32 v17, v20
    s_waitcnt vmcnt(16)
    s_max_u32 s54, s54, 4
    v_mov_b32 v20, s54
    ds_write_b32 v17, v20
    s_add_u32 m0, s87, 90112
    s_add_u32 s52, s87, 0
    buffer_load_dwordx4 v4, s[28:31], s52 offen nt lds
    buffer_load_dwordx4 v5, s[28:31], s52 offen offset:1024 nt lds
    buffer_load_dwordx4 v6, s[28:31], s52 offen offset:2048 nt lds
    buffer_load_dwordx4 v7, s[28:31], s52 offen offset:3072 nt lds
    s_add_u32 m0, s84, 106496
    s_add_u32 s52, s84, 16384
    buffer_load_dwordx4 v4, s[28:31], s52 offen nt lds
    buffer_load_dwordx4 v5, s[28:31], s52 offen offset:1024 nt lds
    buffer_load_dwordx4 v6, s[28:31], s52 offen offset:2048 nt lds
    buffer_load_dwordx4 v7, s[28:31], s52 offen offset:3072 nt lds
    s_add_u32 m0, s85, 106496
    s_add_u32 s52, s85, 16384
    buffer_load_dwordx4 v4, s[28:31], s52 offen nt lds
    buffer_load_dwordx4 v5, s[28:31], s52 offen offset:1024 nt lds
    buffer_load_dwordx4 v6, s[28:31], s52 offen offset:2048 nt lds
    buffer_load_dwordx4 v7, s[28:31], s52 offen offset:3072 nt lds
    s_add_u32 m0, s86, 106496
    s_add_u32 s52, s86, 16384
    buffer_load_dwordx4 v4, s[28:31], s52 offen nt lds
    buffer_load_dwordx4 v5, s[28:31], s52 offen offset:1024 nt lds
    buffer_load_dwordx4 v6, s[28:31], s52 offen offset:2048 nt lds
    buffer_load_dwordx4 v7, s[28:31], s52 offen offset:3072 nt lds
    s_add_u32 m0, s87, 106496
    s_add_u32 s52, s87, 16384
    buffer_load_dwordx4 v4, s[28:31], s52 offen nt lds
    buffer_load_dwordx4 v5, s[28:31], s52 offen offset:1024 nt lds
    buffer_load_dwordx4 v6, s[28:31], s52 offen offset:2048 nt lds
    buffer_load_dwordx4 v7, s[28:31], s52 offen offset:3072 nt lds
    s_add_u32 m0, s84, 122880
    s_add_u32 s52, s84, 32768
    buffer_load_dwordx4 v4, s[28:31], s52 offen nt lds
    buffer_load_dwordx4 v5, s[28:31], s52 offen offset:1024 nt lds
    buffer_load_dwordx4 v6, s[28:31], s52 offen offset:2048 nt lds
    buffer_load_dwordx4 v7, s[28:31], s52 offen offset:3072 nt lds
    s_waitcnt vmcnt(36)
    s_add_u32 m0, s85, 122880
    s_add_u32 s52, s85, 32768
    buffer_load_dwordx4 v4, s[28:31], s52 offen nt lds
    buffer_load_dwordx4 v5, s[28:31], s52 offen offset:1024 nt lds
    buffer_load_dwordx4 v6, s[28:31], s52 offen offset:2048 nt lds
    buffer_load_dwordx4 v7, s[28:31], s52 offen offset:3072 nt lds
    s_waitcnt vmcnt(36)
    s_add_u32 m0, s86, 122880
    s_add_u32 s52, s86, 32768
    buffer_load_dwordx4 v4, s[28:31], s52 offen nt lds
    buffer_load_dwordx4 v5, s[28:31], s52 offen offset:1024 nt lds
    buffer_load_dwordx4 v6, s[28:31], s52 offen offset:2048 nt lds
    buffer_load_dwordx4 v7, s[28:31], s52 offen offset:3072 nt lds
    s_waitcnt vmcnt(36)
    s_add_u32 m0, s87, 122880
    s_add_u32 s52, s87, 32768
    buffer_load_dwordx4 v4, s[28:31], s52 offen nt lds
    buffer_load_dwordx4 v5, s[28:31], s52 offen offset:1024 nt lds
    buffer_load_dwordx4 v6, s[28:31], s52 offen offset:2048 nt lds
    buffer_load_dwordx4 v7, s[28:31], s52 offen offset:3072 nt lds
    s_waitcnt vmcnt(36)
    s_add_u32 m0, s84, 139264
    s_add_u32 s52, s84, 49152
    buffer_load_dwordx4 v4, s[28:31], s52 offen nt lds
    buffer_load_dwordx4 v5, s[28:31], s52 offen offset:1024 nt lds
    buffer_load_dwordx4 v6, s[28:31], s52 offen offset:2048 nt lds
    buffer_load_dwordx4 v7, s[28:31], s52 offen offset:3072 nt lds
    s_waitcnt vmcnt(36)
    s_add_u32 m0, s85, 139264
    s_add_u32 s52, s85, 49152
    buffer_load_dwordx4 v4, s[28:31], s52 offen nt lds
    buffer_load_dwordx4 v5, s[28:31], s52 offen offset:1024 nt lds
    buffer_load_dwordx4 v6, s[28:31], s52 offen offset:2048 nt lds
    buffer_load_dwordx4 v7, s[28:31], s52 offen offset:3072 nt lds
    s_waitcnt vmcnt(36)
    s_add_u32 m0, s86, 139264
    s_add_u32 s52, s86, 49152
    buffer_load_dwordx4 v4, s[28:31], s52 offen nt lds
    buffer_load_dwordx4 v5, s[28:31], s52 offen offset:1024 nt lds
    buffer_load_dwordx4 v6, s[28:31], s52 offen offset:2048 nt lds
    buffer_load_dwordx4 v7, s[28:31], s52 offen offset:3072 nt lds
    s_waitcnt vmcnt(36)
    s_add_u32 m0, s87, 139264
    s_add_u32 s52, s87, 49152
    buffer_load_dwordx4 v4, s[28:31], s52 offen nt lds
    buffer_load_dwordx4 v5, s[28:31], s52 offen offset:1024 nt lds
    buffer_load_dwordx4 v6, s[28:31], s52 offen offset:2048 nt lds
    buffer_load_dwordx4 v7, s[28:31], s52 offen offset:3072 nt lds
    s_waitcnt vmcnt(36)
    s_add_u32 s52, s84, 114688
    buffer_load_dwordx4 a[0:3], v4, s[28:31], s52 offen nt
    buffer_load_dwordx4 a[4:7], v5, s[28:31], s52 offen offset:1024 nt
    buffer_load_dwordx4 a[8:11], v6, s[28:31], s52 offen offset:2048 nt
    buffer_load_dwordx4 a[12:15], v7, s[28:31], s52 offen offset:3072 nt
    s_waitcnt vmcnt(36)
    s_add_u32 s52, s85, 114688
    buffer_load_dwordx4 a[16:19], v4, s[28:31], s52 offen nt
    buffer_load_dwordx4 a[20:23], v5, s[28:31], s52 offen offset:1024 nt
    buffer_load_dwordx4 a[24:27], v6, s[28:31], s52 offen offset:2048 nt
    buffer_load_dwordx4 a[28:31], v7, s[28:31], s52 offen offset:3072 nt
    s_waitcnt vmcnt(36)
    s_add_u32 s52, s86, 114688
    buffer_load_dwordx4 a[32:35], v4, s[28:31], s52 offen nt
    buffer_load_dwordx4 a[36:39], v5, s[28:31], s52 offen offset:1024 nt
    buffer_load_dwordx4 a[40:43], v6, s[28:31], s52 offen offset:2048 nt
    buffer_load_dwordx4 a[44:47], v7, s[28:31], s52 offen offset:3072 nt
    s_waitcnt vmcnt(36)
    s_add_u32 s52, s87, 114688
    buffer_load_dwordx4 a[48:51], v4, s[28:31], s52 offen nt
    buffer_load_dwordx4 a[52:55], v5, s[28:31], s52 offen offset:1024 nt
    buffer_load_dwordx4 a[56:59], v6, s[28:31], s52 offen offset:2048 nt
    buffer_load_dwordx4 a[60:63], v7, s[28:31], s52 offen offset:3072 nt
    s_waitcnt vmcnt(28)
    s_mov_b32 m0, 61440
    s_add_u32 s55, s58, 256
    s_and_b32 s55, s55, 1023
    s_lshl_b32 s55, s55, 12
    s_add_u32 s52, s55, 0
    buffer_load_dwordx4 v12, s[36:39], s52 offen sc1 lds
    buffer_load_dwordx4 v13, s[36:39], s52 offen offset:1024 sc1 lds
    buffer_load_dwordx4 v14, s[36:39], s52 offen offset:2048 sc1 lds
    buffer_load_dwordx4 v15, s[36:39], s52 offen offset:3072 sc1 lds
    s_waitcnt vmcnt(28)
    s_mov_b32 m0, 65536
    s_add_u32 s52, s55, 131072
    buffer_load_dwordx4 v12, s[36:39], s52 offen sc1 lds
    buffer_load_dwordx4 v13, s[36:39], s52 offen offset:1024 sc1 lds
    buffer_load_dwordx4 v14, s[36:39], s52 offen offset:2048 sc1 lds
    buffer_load_dwordx4 v15, s[36:39], s52 offen offset:3072 sc1 lds
    s_waitcnt vmcnt(28)
    s_mov_b32 m0, 69632
    s_add_u32 s59, s58, 384
    s_and_b32 s59, s59, 1023
    s_add_u32 s52, s59, 0
    buffer_load_dwordx4 v8, s[24:27], s52 offen sc1 lds
    buffer_load_dwordx4 v9, s[24:27], s52 offen offset:1024 sc1 lds
    buffer_load_dwordx4 v10, s[24:27], s52 offen offset:2048 sc1 lds
    buffer_load_dwordx4 v11, s[24:27], s52 offen offset:3072 sc1 lds
    s_waitcnt vmcnt(28)
    s_mov_b32 m0, 73728
    s_add_u32 s52, s59, 32768
    buffer_load_dwordx4 v8, s[24:27], s52 offen sc1 lds
    buffer_load_dwordx4 v9, s[24:27], s52 offen offset:1024 sc1 lds
    buffer_load_dwordx4 v10, s[24:27], s52 offen offset:2048 sc1 lds
    buffer_load_dwordx4 v11, s[24:27], s52 offen offset:3072 sc1 lds
    s_waitcnt vmcnt(28)
    s_mov_b32 m0, 77824
    s_add_u32 s52, s59, 65536
    buffer_load_dwordx4 v8, s[24:27], s52 offen sc1 lds
    buffer_load_dwordx4 v9, s[24:27], s52 offen offset:1024 sc1 lds
    buffer_load_dwordx4 v10, s[24:27], s52 offen offset:2048 sc1 lds
    buffer_load_dwordx4 v11, s[24:27], s52 offen offset:3072 sc1 lds
    s_waitcnt vmcnt(28)
    v_cmp_lt_u32 vcc, 0, v24
    s_cbranch_vccnz A_lB1_ok
    s_cmp_ge_u32 s54, 5
    s_cbranch_scc1 A_lB1_5
    ds_read_b96 v[24:26], v17 offset:16
    s_waitcnt lgkmcnt(0)
    v_min3_u32 v24, v24, v25, v26
    v_cmp_lt_u32 vcc, 0, v24
    s_cbranch_vccnz A_lB1_ok
    s_waitcnt vmcnt(12)
    s_max_u32 s54, s54, 5
    v_mov_b32 v20, s54
    ds_write_b32 v17, v20
A_lB1_5:
A_lB1:
    s_sub_u32 s57, s57, 1
    s_cbranch_scc1 A_end
    ds_read_b96 v[24:26], v17 offset:16
    s_waitcnt lgkmcnt(0)
    v_min3_u32 v24, v24, v25, v26
    v_cmp_lt_u32 vcc, 0, v24
    s_cbranch_vccz A_lB1
A_lB1_ok:
    s_mov_b32 m0, 81920
    s_add_u32 s55, s58, 320
    s_and_b32 s55, s55, 1023
    s_lshl_b32 s55, s55, 12
    s_add_u32 s52, s55, 0
    buffer_load_dwordx4 v12, s[36:39], s52 offen sc1 lds
    buffer_load_dwordx4 v13, s[36:39], s52 offen offset:1024 sc1 lds
    buffer_load_dwordx4 v14, s[36:39], s52 offen offset:2048 sc1 lds
    buffer_load_dwordx4 v15, s[36:39], s52 offen offset:3072 sc1 lds
    s_waitcnt vmcnt(28)
    s_mov_b32 m0, 86016
    s_add_u32 s52, s55, 131072
    buffer_load_dwordx4 v12, s[36:39], s52 offen sc1 lds
    buffer_load_dwordx4 v13, s[36:39], s52 offen offset:1024 sc1 lds
    buffer_load_dwordx4 v14, s[36:39], s52 offen offset:2048 sc1 lds
    buffer_load_dwordx4 v15, s[36:39], s52 offen offset:3072 sc1 lds
    s_waitcnt vmcnt(28)
    v_cmp_lt_u32 vcc, 1, v24
    s_cbranch_vccnz A_lB2_ok
    s_cmp_ge_u32 s54, 5
    s_cbranch_scc1 A_lB2_5
    ds_read_b96 v[24:26], v17 offset:16
    s_waitcnt lgkmcnt(0)
    v_min3_u32 v24, v24, v25, v26
    v_cmp_lt_u32 vcc, 1, v24
    s_cbranch_vccnz A_lB2_ok
    s_waitcnt vmcnt(20)
    s_max_u32 s54, s54, 5
    v_mov_b32 v20, s54
    ds_write_b32 v17, v20
A_lB2_5:
    s_cmp_ge_u32 s54, 6
    s_cbranch_scc1 A_lB2_6
    ds_read_b96 v[24:26], v17 offset:16
    s_waitcnt lgkmcnt(0)
    v_min3_u32 v24, v24, v25, v26
    v_cmp_lt_u32 vcc, 1, v24
    s_cbranch_vccnz A_lB2_ok
    s_waitcnt vmcnt(0)
    s_max_u32 s54, s54, 6
    v_mov_b32 v20, s54
    ds_write_b32 v17, v20
A_lB2_6:
A_lB2:
    s_sub_u32 s57, s57, 1
    s_cbranch_scc1 A_end
    ds_read_b96 v[24:26], v17 offset:16
    s_waitcnt lgkmcnt(0)
    v_min3_u32 v24, v24, v25, v26
    v_cmp_lt_u32 vcc, 1, v24
    s_cbranch_vccz A_lB2
A_lB2_ok:
    s_mov_b32 m0, 24576
    s_add_u32 s55, s58, 384
    s_and_b32 s55, s55, 1023
    s_lshl_b32 s55, s55, 12
    s_add_u32 s52, s55, 0
    buffer_load_dwordx4 v12, s[36:39], s52 offen sc1 lds
    buffer_load_dwordx4 v13, s[36:39], s52 offen offset:1024 sc1 lds
    buffer_load_dwordx4 v14, s[36:39], s52 offen offset:2048 sc1 lds
    buffer_load_dwordx4 v15, s[36:39], s52 offen offset:3072 sc1 lds
    s_waitcnt vmcnt(28)
    s_mov_b32 m0, 28672
    s_add_u32 s52, s55, 131072
    buffer_load_dwordx4 v12, s[36:39], s52 offen sc1 lds
    buffer_load_dwordx4 v13, s[36:39], s52 offen offset:1024 sc1 lds
    buffer_load_dwordx4 v14, s[36:39], s52 offen offset:2048 sc1 lds
    buffer_load_dwordx4 v15, s[36:39], s52 offen offset:3072 sc1 lds
    s_waitcnt vmcnt(28)
    s_max_u32 s54, s54, 5
    v_mov_b32 v20, s54
    ds_write_b32 v17, v20
    s_mov_b32 m0, 0
    s_add_u32 s59, s58, 512
    s_and_b32 s59, s59, 1023
    s_add_u32 s52, s59, 0
    buffer_load_dwordx4 v8, s[24:27], s52 offen sc1 lds
    buffer_load_dwordx4 v9, s[24:27], s52 offen offset:1024 sc1 lds
    buffer_load_dwordx4 v10, s[24:27], s52 offen offset:2048 sc1 lds
    buffer_load_dwordx4 v11, s[24:27], s52 offen offset:3072 sc1 lds
    s_waitcnt vmcnt(28)
    s_mov_b32 m0, 4096
    s_add_u32 s52, s59, 32768
    buffer_load_dwordx4 v8, s[24:27], s52 offen sc1 lds
    buffer_load_dwordx4 v9, s[24:27], s52 offen offset:1024 sc1 lds
    buffer_load_dwordx4 v10, s[24:27], s52 offen offset:2048 sc1 lds
    buffer_load_dwordx4 v11, s[24:27], s52 offen offset:3072 sc1 lds
    s_waitcnt vmcnt(28)
    s_mov_b32 m0, 8192
    s_add_u32 s52, s59, 65536
    buffer_load_dwordx4 v8, s[24:27], s52 offen sc1 lds
    buffer_load_dwordx4 v9, s[24:27], s52 offen offset:1024 sc1 lds
    buffer_load_dwordx4 v10, s[24:27], s52 offen offset:2048 sc1 lds
    buffer_load_dwordx4 v11, s[24:27], s52 offen offset:3072 sc1 lds
    s_waitcnt vmcnt(28)
    v_cmp_lt_u32 vcc, 2, v24
    s_cbranch_vccnz A_lB3_ok
    s_cmp_ge_u32 s54, 6
    s_cbranch_scc1 A_lB3_6
    ds_read_b96 v[24:26], v17 offset:16
    s_waitcnt lgkmcnt(0)
    v_min3_u32 v24, v24, v25, v26
    v_cmp_lt_u32 vcc, 2, v24
    s_cbranch_vccnz A_lB3_ok
    s_waitcnt vmcnt(20)
    s_max_u32 s54, s54, 6
    v_mov_b32 v20, s54
    ds_write_b32 v17, v20
A_lB3_6:
    s_cmp_ge_u32 s54, 7
    s_cbranch_scc1 A_lB3_7
    ds_read_b96 v[24:26], v17 offset:16
    s_waitcnt lgkmcnt(0)
    v_min3_u32 v24, v24, v25, v26
    v_cmp_lt_u32 vcc, 2, v24
    s_cbranch_vccnz A_lB3_ok
    s_waitcnt vmcnt(12)
    s_max_u32 s54, s54, 7
    v_mov_b32 v20, s54
    ds_write_b32 v17, v20
A_lB3_7:
A_lB3:
    s_sub_u32 s57, s57, 1
    s_cbranch_scc1 A_end
    ds_read_b96 v[24:26], v17 offset:16
    s_waitcnt lgkmcnt(0)
    v_min3_u32 v24, v24, v25, v26
    v_cmp_lt_u32 vcc, 2, v24
    s_cbranch_vccz A_lB3
A_lB3_ok:
    s_mov_b32 m0, 32768
    s_add_u32 s55, s58, 448
    s_and_b32 s55, s55, 1023
    s_lshl_b32 s55, s55, 12
    s_add_u32 s52, s55, 0
    buffer_load_dwordx4 v12, s[36:39], s52 offen sc1 lds
    buffer_load_dwordx4 v13, s[36:39], s52 offen offset:1024 sc1 lds
    buffer_load_dwordx4 v14, s[36:39], s52 offen offset:2048 sc1 lds
    buffer_load_dwordx4 v15, s[36:39], s52 offen offset:3072 sc1 lds
    s_waitcnt vmcnt(28)
    s_mov_b32 m0, 36864
    s_add_u32 s52, s55, 131072
    buffer_load_dwordx4 v12, s[36:39], s52 offen sc1 lds
    buffer_load_dwordx4 v13, s[36:39], s52 offen offset:1024 sc1 lds
    buffer_load_dwordx4 v14, s[36:39], s52 offen offset:2048 sc1 lds
    buffer_load_dwordx4 v15, s[36:39], s52 offen offset:3072 sc1 lds
    s_waitcnt vmcnt(28)
    s_max_u32 s54, s54, 6
    v_mov_b32 v20, s54
    ds_write_b32 v17, v20
    v_cmp_lt_u32 vcc, 3, v24
    s_cbranch_vccnz A_lB4_ok
    s_cmp_ge_u32 s54, 7
    s_cbranch_scc1 A_lB4_7
    ds_read_b96 v[24:26], v17 offset:16
    s_waitcnt lgkmcnt(0)
    v_min3_u32 v24, v24, v25, v26
    v_cmp_lt_u32 vcc, 3, v24
    s_cbranch_vccnz A_lB4_ok
    s_waitcnt vmcnt(20)
    s_max_u32 s54, s54, 7
    v_mov_b32 v20, s54
    ds_write_b32 v17, v20
A_lB4_7:
    s_cmp_ge_u32 s54, 8
    s_cbranch_scc1 A_lB4_8
    ds_read_b96 v[24:26], v17 offset:16
    s_waitcnt lgkmcnt(0)
    v_min3_u32 v24, v24, v25, v26
    v_cmp_lt_u32 vcc, 3, v24
    s_cbranch_vccnz A_lB4_ok
    s_waitcnt vmcnt(0)
    s_max_u32 s54, s54, 8
    v_mov_b32 v20, s54
    ds_write_b32 v17, v20
A_lB4_8:
A_lB4:
    s_sub_u32 s57, s57, 1
    s_cbranch_scc1 A_end
    ds_read_b96 v[24:26], v17 offset:16
    s_waitcnt lgkmcnt(0)
    v_min3_u32 v24, v24, v25, v26
    v_cmp_lt_u32 vcc, 3, v24
    s_cbranch_vccz A_lB4
A_lB4_ok:
    s_mov_b32 m0, 53248
    s_add_u32 s55, s58, 512
    s_and_b32 s55, s55, 1023
    s_lshl_b32 s55, s55, 12
    s_add_u32 s52, s55, 0
    buffer_load_dwordx4 v12, s[36:39], s52 offen sc1 lds
    buffer_load_dwordx4 v13, s[36:39], s52 offen offset:1024 sc1 lds
    buffer_load_dwordx4 v14, s[36:39], s52 offen offset:2048 sc1 lds
    buffer_load_dwordx4 v15, s[36:39], s52 offen offset:3072 sc1 lds
    s_waitcnt vmcnt(28)
    s_mov_b32 m0, 57344
    s_add_u32 s52, s55, 131072
    buffer_load_dwordx4 v12, s[36:39], s52 offen sc1 lds
    buffer_load_dwordx4 v13, s[36:39], s52 offen offset:1024 sc1 lds
    buffer_load_dwordx4 v14, s[36:39], s52 offen offset:2048 sc1 lds
    buffer_load_dwordx4 v15, s[36:39], s52 offen offset:3072 sc1 lds
    s_waitcnt vmcnt(28)
    s_max_u32 s54, s54, 7
    v_mov_b32 v20, s54
    ds_write_b32 v17, v20
    s_mov_b32 m0, 12288
    s_add_u32 s59, s58, 640
    s_and_b32 s59, s59, 1023
    s_add_u32 s52, s59, 0
    buffer_load_dwordx4 v8, s[24:27], s52 offen sc1 lds
    buffer_load_dwordx4 v9, s[24:27], s52 offen offset:1024 sc1 lds
    buffer_load_dwordx4 v10, s[24:27], s52 offen offset:2048 sc1 lds
    buffer_load_dwordx4 v11, s[24:27], s52 offen offset:3072 sc1 lds
    s_waitcnt vmcnt(28)
    s_mov_b32 m0, 16384
    s_add_u32 s52, s59, 32768
    buffer_load_dwordx4 v8, s[24:27], s52 offen sc1 lds
    buffer_load_dwordx4 v9, s[24:27], s52 offen offset:1024 sc1 lds
    buffer_load_dwordx4 v10, s[24:27], s52 offen offset:2048 sc1 lds
    buffer_load_dwordx4 v11, s[24:27], s52 offen offset:3072 sc1 lds
    s_waitcnt vmcnt(28)
    s_mov_b32 m0, 20480
    s_add_u32 s52, s59, 65536
    buffer_load_dwordx4 v8, s[24:27], s52 offen sc1 lds
    buffer_load_dwordx4 v9, s[24:27], s52 offen offset:1024 sc1 lds
    buffer_load_dwordx4 v10, s[24:27], s52 offen offset:2048 sc1 lds
    buffer_load_dwordx4 v11, s[24:27], s52 offen offset:3072 sc1 lds
    s_waitcnt vmcnt(28)
    v_cmp_lt_u32 vcc, 4, v24
    s_cbranch_vccnz A_lB5_ok
    s_cmp_ge_u32 s54, 8
    s_cbranch_scc1 A_lB5_8
    ds_read_b96 v[24:26], v17 offset:16
    s_waitcnt lgkmcnt(0)
    v_min3_u32 v24, v24, v25, v26
    v_cmp_lt_u32 vcc, 4, v24
    s_cbranch_vccnz A_lB5_ok
    s_waitcnt vmcnt(20)
    s_max_u32 s54, s54, 8
    v_mov_b32 v20, s54
    ds_write_b32 v17, v20
A_lB5_8:
    s_cmp_ge_u32 s54, 9
    s_cbranch_scc1 A_lB5_9
    ds_read_b96 v[24:26], v17 offset:16
    s_waitcnt lgkmcnt(0)
    v_min3_u32 v24, v24, v25, v26
    v_cmp_lt_u32 vcc, 4, v24
    s_cbranch_vccnz A_lB5_ok
    s_waitcnt vmcnt(12)
    s_max_u32 s54, s54, 9
    v_mov_b32 v20, s54
    ds_write_b32 v17, v20
A_lB5_9:
A_lB5:
    s_sub_u32 s57, s57, 1
    s_cbranch_scc1 A_end
    ds_read_b96 v[24:26], v17 offset:16
    s_waitcnt lgkmcnt(0)
    v_min3_u32 v24, v24, v25, v26
    v_cmp_lt_u32 vcc, 4, v24
    s_cbranch_vccz A_lB5
A_lB5_ok:
    s_mov_b32 m0, 61440
    s_add_u32 s55, s58, 576
    s_and_b32 s55, s55, 1023
    s_lshl_b32 s55, s55, 12
    s_add_u32 s52, s55, 0
    buffer_load_dwordx4 v12, s[36:39], s52 offen sc1 lds
    buffer_load_dwordx4 v13, s[36:39], s52 offen offset:1024 sc1 lds
    buffer_load_dwordx4 v14, s[36:39], s52 offen offset:2048 sc1 lds
    buffer_load_dwordx4 v15, s[36:39], s52 offen offset:3072 sc1 lds
    s_waitcnt vmcnt(28)
    s_mov_b32 m0, 65536
    s_add_u32 s52, s55, 131072
    buffer_load_dwordx4 v12, s[36:39], s52 offen sc1 lds
    buffer_load_dwordx4 v13, s[36:39], s52 offen offset:1024 sc1 lds
    buffer_load_dwordx4 v14, s[36:39], s52 offen offset:2048 sc1 lds
    buffer_load_dwordx4 v15, s[36:39], s52 offen offset:3072 sc1 lds
    s_waitcnt vmcnt(28)
    s_max_u32 s54, s54, 8
    v_mov_b32 v20, s54
    ds_write_b32 v17, v20
    v_cmp_lt_u32 vcc, 5, v24
    s_cbranch_vccnz A_lB6_ok
    s_cmp_ge_u32 s54, 9
    s_cbranch_scc1 A_lB6_9
    ds_read_b96 v[24:26], v17 offset:16
    s_waitcnt lgkmcnt(0)
    v_min3_u32 v24, v24, v25, v26
    v_cmp_lt_u32 vcc, 5, v24
    s_cbranch_vccnz A_lB6_ok
    s_waitcnt vmcnt(20)
    s_max_u32 s54, s54, 9
    v_mov_b32 v20, s54
    ds_write_b32 v17, v20
A_lB6_9:
    s_cmp_ge_u32 s54, 10
    s_cbranch_scc1 A_lB6_10
    ds_read_b96 v[24:26], v17 offset:16
    s_waitcnt lgkmcnt(0)
    v_min3_u32 v24, v24, v25, v26
    v_cmp_lt_u32 vcc, 5, v24
    s_cbranch_vccnz A_lB6_ok
    s_waitcnt vmcnt(0)
    s_max_u32 s54, s54, 10
    v_mov_b32 v20, s54
    ds_write_b32 v17, v20
A_lB6_10:
A_lB6:
    s_sub_u32 s57, s57, 1
    s_cbranch_scc1 A_end
    ds_read_b96 v[24:26], v17 offset:16
    s_waitcnt lgkmcnt(0)
    v_min3_u32 v24, v24, v25, v26
    v_cmp_lt_u32 vcc, 5, v24
    s_cbranch_vccz A_lB6
A_lB6_ok:
    s_mov_b32 m0, 81920
    s_add_u32 s55, s58, 640
    s_and_b32 s55, s55, 1023
    s_lshl_b32 s55, s55, 12
    s_add_u32 s52, s55, 0
    buffer_load_dwordx4 v12, s[36:39], s52 offen sc1 lds
    buffer_load_dwordx4 v13, s[36:39], s52 offen offset:1024 sc1 lds
    buffer_load_dwordx4 v14, s[36:39], s52 offen offset:2048 sc1 lds
    buffer_load_dwordx4 v15, s[36:39], s52 offen offset:3072 sc1 lds
    s_waitcnt vmcnt(28)
    s_mov_b32 m0, 86016
    s_add_u32 s52, s55, 131072
    buffer_load_dwordx4 v12, s[36:39], s52 offen sc1 lds
    buffer_load_dwordx4 v13, s[36:39], s52 offen offset:1024 sc1 lds
    buffer_load_dwordx4 v14, s[36:39], s52 offen offset:2048 sc1 lds
    buffer_load_dwordx4 v15, s[36:39], s52 offen offset:3072 sc1 lds
    s_waitcnt vmcnt(28)
    s_max_u32 s54, s54, 9
    v_mov_b32 v20, s54
    ds_write_b32 v17, v20
    s_mov_b32 m0, 40960
    s_add_u32 s59, s58, 768
    s_and_b32 s59, s59, 1023
    s_add_u32 s52, s59, 0
    buffer_load_dwordx4 v8, s[24:27], s52 offen sc1 lds
    buffer_load_dwordx4 v9, s[24:27], s52 offen offset:1024 sc1 lds
    buffer_load_dwordx4 v10, s[24:27], s52 offen offset:2048 sc1 lds
    buffer_load_dwordx4 v11, s[24:27], s52 offen offset:3072 sc1 lds
    s_waitcnt vmcnt(28)
    s_mov_b32 m0, 45056
    s_add_u32 s52, s59, 32768
    buffer_load_dwordx4 v8, s[24:27], s52 offen sc1 lds
    buffer_load_dwordx4 v9, s[24:27], s52 offen offset:1024 sc1 lds
    buffer_load_dwordx4 v10, s[24:27], s52 offen offset:2048 sc1 lds
    buffer_load_dwordx4 v11, s[24:27], s52 offen offset:3072 sc1 lds
    s_waitcnt vmcnt(28)
    s_mov_b32 m0, 49152
    s_add_u32 s52, s59, 65536
    buffer_load_dwordx4 v8, s[24:27], s52 offen sc1 lds
    buffer_load_dwordx4 v9, s[24:27], s52 offen offset:1024 sc1 lds
    buffer_load_dwordx4 v10, s[24:27], s52 offen offset:2048 sc1 lds
    buffer_load_dwordx4 v11, s[24:27], s52 offen offset:3072 sc1 lds
    s_waitcnt vmcnt(28)
    v_cmp_lt_u32 vcc, 6, v24
    s_cbranch_vccnz A_lB7_ok
    s_cmp_ge_u32 s54, 10
    s_cbranch_scc1 A_lB7_10
    ds_read_b96 v[24:26], v17 offset:16
    s_waitcnt lgkmcnt(0)
    v_min3_u32 v24, v24, v25, v26
    v_cmp_lt_u32 vcc, 6, v24
    s_cbranch_vccnz A_lB7_ok
    s_waitcnt vmcnt(20)
    s_max_u32 s54, s54, 10
    v_mov_b32 v20, s54
    ds_write_b32 v17, v20
A_lB7_10:
    s_cmp_ge_u32 s54, 11
    s_cbranch_scc1 A_lB7_11
    ds_read_b96 v[24:26], v17 offset:16
    s_waitcnt lgkmcnt(0)
    v_min3_u32 v24, v24, v25, v26
    v_cmp_lt_u32 vcc, 6, v24
    s_cbranch_vccnz A_lB7_ok
    s_waitcnt vmcnt(12)
    s_max_u32 s54, s54, 11
    v_mov_b32 v20, s54
    ds_write_b32 v17, v20
A_lB7_11:
A_lB7:
    s_sub_u32 s57, s57, 1
    s_cbranch_scc1 A_end
    ds_read_b96 v[24:26], v17 offset:16
    s_waitcnt lgkmcnt(0)
    v_min3_u32 v24, v24, v25, v26
    v_cmp_lt_u32 vcc, 6, v24
    s_cbranch_vccz A_lB7
A_lB7_ok:
    s_mov_b32 m0, 24576
    s_add_u32 s55, s58, 704
    s_and_b32 s55, s55, 1023
    s_lshl_b32 s55, s55, 12
    s_add_u32 s52, s55, 0
    buffer_load_dwordx4 v12, s[36:39], s52 offen sc1 lds
    buffer_load_dwordx4 v13, s[36:39], s52 offen offset:1024 sc1 lds
    buffer_load_dwordx4 v14, s[36:39], s52 offen offset:2048 sc1 lds
    buffer_load_dwordx4 v15, s[36:39], s52 offen offset:3072 sc1 lds
    s_waitcnt vmcnt(28)
    s_mov_b32 m0, 28672
    s_add_u32 s52, s55, 131072
    buffer_load_dwordx4 v12, s[36:39], s52 offen sc1 lds
    buffer_load_dwordx4 v13, s[36:39], s52 offen offset:1024 sc1 lds
    buffer_load_dwordx4 v14, s[36:39], s52 offen offset:2048 sc1 lds
    buffer_load_dwordx4 v15, s[36:39], s52 offen offset:3072 sc1 lds
    s_waitcnt vmcnt(28)
    s_max_u32 s54, s54, 10
    v_mov_b32 v20, s54
    ds_write_b32 v17, v20
    v_cmp_lt_u32 vcc, 7, v24
    s_cbranch_vccnz A_lB8_ok
    s_cmp_ge_u32 s54, 11
    s_cbranch_scc1 A_lB8_11
    ds_read_b96 v[24:26], v17 offset:16
    s_waitcnt lgkmcnt(0)
    v_min3_u32 v24, v24, v25, v26
    v_cmp_lt_u32 vcc, 7, v24
    s_cbranch_vccnz A_lB8_ok
    s_waitcnt vmcnt(20)
    s_max_u32 s54, s54, 11
    v_mov_b32 v20, s54
    ds_write_b32 v17, v20
A_lB8_11:
    s_cmp_ge_u32 s54, 12
    s_cbranch_scc1 A_lB8_12
    ds_read_b96 v[24:26], v17 offset:16
    s_waitcnt lgkmcnt(0)
    v_min3_u32 v24, v24, v25, v26
    v_cmp_lt_u32 vcc, 7, v24
    s_cbranch_vccnz A_lB8_ok
    s_waitcnt vmcnt(0)
    s_max_u32 s54, s54, 12
    v_mov_b32 v20, s54
    ds_write_b32 v17, v20
A_lB8_12:
A_lB8:
    s_sub_u32 s57, s57, 1
    s_cbranch_scc1 A_end
    ds_read_b96 v[24:26], v17 offset:16
    s_waitcnt lgkmcnt(0)
    v_min3_u32 v24, v24, v25, v26
    v_cmp_lt_u32 vcc, 7, v24
    s_cbranch_vccz A_lB8
A_lB8_ok:
    s_mov_b32 m0, 32768
    s_add_u32 s55, s58, 768
    s_and_b32 s55, s55, 1023
    s_lshl_b32 s55, s55, 12
    s_add_u32 s52, s55, 0
    buffer_load_dwordx4 v12, s[36:39], s52 offen sc1 lds
    buffer_load_dwordx4 v13, s[36:39], s52 offen offset:1024 sc1 lds
    buffer_load_dwordx4 v14, s[36:39], s52 offen offset:2048 sc1 lds
    buffer_load_dwordx4 v15, s[36:39], s52 offen offset:3072 sc1 lds
    s_waitcnt vmcnt(28)
    s_mov_b32 m0, 36864
    s_add_u32 s52, s55, 131072
    buffer_load_dwordx4 v12, s[36:39], s52 offen sc1 lds
    buffer_load_dwordx4 v13, s[36:39], s52 offen offset:1024 sc1 lds
    buffer_load_dwordx4 v14, s[36:39], s52 offen offset:2048 sc1 lds
    buffer_load_dwordx4 v15, s[36:39], s52 offen offset:3072 sc1 lds
    s_waitcnt vmcnt(28)
    s_max_u32 s54, s54, 11
    v_mov_b32 v20, s54
    ds_write_b32 v17, v20
    s_mov_b32 m0, 69632
    s_add_u32 s59, s58, 896
    s_and_b32 s59, s59, 1023
    s_add_u32 s52, s59, 0
    buffer_load_dwordx4 v8, s[24:27], s52 offen sc1 lds
    buffer_load_dwordx4 v9, s[24:27], s52 offen offset:1024 sc1 lds
    buffer_load_dwordx4 v10, s[24:27], s52 offen offset:2048 sc1 lds
    buffer_load_dwordx4 v11, s[24:27], s52 offen offset:3072 sc1 lds
    s_waitcnt vmcnt(28)
    s_mov_b32 m0, 73728
    s_add_u32 s52, s59, 32768
    buffer_load_dwordx4 v8, s[24:27], s52 offen sc1 lds
    buffer_load_dwordx4 v9, s[24:27], s52 offen offset:1024 sc1 lds
    buffer_load_dwordx4 v10, s[24:27], s52 offen offset:2048 sc1 lds
    buffer_load_dwordx4 v11, s[24:27], s52 offen offset:3072 sc1 lds
    s_waitcnt vmcnt(28)
    s_mov_b32 m0, 77824
    s_add_u32 s52, s59, 65536
    buffer_load_dwordx4 v8, s[24:27], s52 offen sc1 lds
    buffer_load_dwordx4 v9, s[24:27], s52 offen offset:1024 sc1 lds
    buffer_load_dwordx4 v10, s[24:27], s52 offen offset:2048 sc1 lds
    buffer_load_dwordx4 v11, s[24:27], s52 offen offset:3072 sc1 lds
    s_waitcnt vmcnt(28)
    v_cmp_lt_u32 vcc, 8, v24
    s_cbranch_vccnz A_lB9_ok
    s_cmp_ge_u32 s54, 12
    s_cbranch_scc1 A_lB9_12
    ds_read_b96 v[24:26], v17 offset:16
    s_waitcnt lgkmcnt(0)
    v_min3_u32 v24, v24, v25, v26
    v_cmp_lt_u32 vcc, 8, v24
    s_cbranch_vccnz A_lB9_ok
    s_waitcnt vmcnt(20)
    s_max_u32 s54, s54, 12
    v_mov_b32 v20, s54
    ds_write_b32 v17, v20
A_lB9_12:
    s_cmp_ge_u32 s54, 13
    s_cbranch_scc1 A_lB9_13
    ds_read_b96 v[24:26], v17 offset:16
    s_waitcnt lgkmcnt(0)
    v_min3_u32 v24, v24, v25, v26
    v_cmp_lt_u32 vcc, 8, v24
    s_cbranch_vccnz A_lB9_ok
    s_waitcnt vmcnt(12)
    s_max_u32 s54, s54, 13
    v_mov_b32 v20, s54
    ds_write_b32 v17, v20
A_lB9_13:
A_lB9:
    s_sub_u32 s57, s57, 1
    s_cbranch_scc1 A_end
    ds_read_b96 v[24:26], v17 offset:16
    s_waitcnt lgkmcnt(0)
    v_min3_u32 v24, v24, v25, v26
    v_cmp_lt_u32 vcc, 8, v24
    s_cbranch_vccz A_lB9
A_lB9_ok:
    s_mov_b32 m0, 53248
    s_add_u32 s55, s58, 832
    s_and_b32 s55, s55, 1023
    s_lshl_b32 s55, s55, 12
    s_add_u32 s52, s55, 0
    buffer_load_dwordx4 v12, s[36:39], s52 offen sc1 lds
    buffer_load_dwordx4 v13, s[36:39], s52 offen offset:1024 sc1 lds
    buffer_load_dwordx4 v14, s[36:39], s52 offen offset:2048 sc1 lds
    buffer_load_dwordx4 v15, s[36:39], s52 offen offset:3072 sc1 lds
    s_waitcnt vmcnt(28)
    s_mov_b32 m0, 57344
    s_add_u32 s52, s55, 131072
    buffer_load_dwordx4 v12, s[36:39], s52 offen sc1 lds
    buffer_load_dwordx4 v13, s[36:39], s52 offen offset:1024 sc1 lds
    buffer_load_dwordx4 v14, s[36:39], s52 offen offset:2048 sc1 lds
    buffer_load_dwordx4 v15, s[36:39], s52 offen offset:3072 sc1 lds
    s_waitcnt vmcnt(28)
    s_max_u32 s54, s54, 12
    v_mov_b32 v20, s54
    ds_write_b32 v17, v20
    v_cmp_lt_u32 vcc, 9, v24
    s_cbranch_vccnz A_lB10_ok
    s_cmp_ge_u32 s54, 13
    s_cbranch_scc1 A_lB10_13
    ds_read_b96 v[24:26], v17 offset:16
    s_waitcnt lgkmcnt(0)
    v_min3_u32 v24, v24, v25, v26
    v_cmp_lt_u32 vcc, 9, v24
    s_cbranch_vccnz A_lB10_ok
    s_waitcnt vmcnt(20)
    s_max_u32 s54, s54, 13
    v_mov_b32 v20, s54
    ds_write_b32 v17, v20
A_lB10_13:
    s_cmp_ge_u32 s54, 14
    s_cbranch_scc1 A_lB10_14
    ds_read_b96 v[24:26], v17 offset:16
    s_waitcnt lgkmcnt(0)
    v_min3_u32 v24, v24, v25, v26
    v_cmp_lt_u32 vcc, 9, v24
    s_cbranch_vccnz A_lB10_ok
    s_waitcnt vmcnt(0)
    s_max_u32 s54, s54, 14
    v_mov_b32 v20, s54
    ds_write_b32 v17, v20
A_lB10_14:
A_lB10:
    s_sub_u32 s57, s57, 1
    s_cbranch_scc1 A_end
    ds_read_b96 v[24:26], v17 offset:16
    s_waitcnt lgkmcnt(0)
    v_min3_u32 v24, v24, v25, v26
    v_cmp_lt_u32 vcc, 9, v24
    s_cbranch_vccz A_lB10
A_lB10_ok:
    s_mov_b32 m0, 61440
    s_add_u32 s55, s58, 896
    s_and_b32 s55, s55, 1023
    s_lshl_b32 s55, s55, 12
    s_add_u32 s52, s55, 0
    buffer_load_dwordx4 v12, s[36:39], s52 offen sc1 lds
    buffer_load_dwordx4 v13, s[36:39], s52 offen offset:1024 sc1 lds
    buffer_load_dwordx4 v14, s[36:39], s52 offen offset:2048 sc1 lds
    buffer_load_dwordx4 v15, s[36:39], s52 offen offset:3072 sc1 lds
    s_waitcnt vmcnt(28)
    s_mov_b32 m0, 65536
    s_add_u32 s52, s55, 131072
    buffer_load_dwordx4 v12, s[36:39], s52 offen sc1 lds
    buffer_load_dwordx4 v13, s[36:39], s52 offen offset:1024 sc1 lds
    buffer_load_dwordx4 v14, s[36:39], s52 offen offset:2048 sc1 lds
    buffer_load_dwordx4 v15, s[36:39], s52 offen offset:3072 sc1 lds
    s_waitcnt vmcnt(28)
    s_max_u32 s54, s54, 13
    v_mov_b32 v20, s54
    ds_write_b32 v17, v20
    v_cmp_lt_u32 vcc, 10, v24
    s_cbranch_vccnz A_lB11_ok
    s_cmp_ge_u32 s54, 14
    s_cbranch_scc1 A_lB11_14
    ds_read_b96 v[24:26], v17 offset:16
    s_waitcnt lgkmcnt(0)
    v_min3_u32 v24, v24, v25, v26
    v_cmp_lt_u32 vcc, 10, v24
    s_cbranch_vccnz A_lB11_ok
    s_waitcnt vmcnt(8)
    s_max_u32 s54, s54, 14
    v_mov_b32 v20, s54
    ds_write_b32 v17, v20
A_lB11_14:
    s_cmp_ge_u32 s54, 15
    s_cbranch_scc1 A_lB11_15
    ds_read_b96 v[24:26], v17 offset:16
    s_waitcnt lgkmcnt(0)
    v_min3_u32 v24, v24, v25, v26
    v_cmp_lt_u32 vcc, 10, v24
    s_cbranch_vccnz A_lB11_ok
    s_waitcnt vmcnt(0)
    s_max_u32 s54, s54, 15
    v_mov_b32 v20, s54
    ds_write_b32 v17, v20
A_lB11_15:
A_lB11:
    s_sub_u32 s57, s57, 1
    s_cbranch_scc1 A_end
    ds_read_b96 v[24:26], v17 offset:16
    s_waitcnt lgkmcnt(0)
    v_min3_u32 v24, v24, v25, v26
    v_cmp_lt_u32 vcc, 10, v24
    s_cbranch_vccz A_lB11
A_lB11_ok:
    s_mov_b32 m0, 81920
    s_add_u32 s55, s58, 960
    s_and_b32 s55, s55, 1023
    s_lshl_b32 s55, s55, 12
    s_add_u32 s52, s55, 0
    buffer_load_dwordx4 v12, s[36:39], s52 offen sc1 lds
    buffer_load_dwordx4 v13, s[36:39], s52 offen offset:1024 sc1 lds
    buffer_load_dwordx4 v14, s[36:39], s52 offen offset:2048 sc1 lds
    buffer_load_dwordx4 v15, s[36:39], s52 offen offset:3072 sc1 lds
    s_waitcnt vmcnt(28)
    s_mov_b32 m0, 86016
    s_add_u32 s52, s55, 131072
    buffer_load_dwordx4 v12, s[36:39], s52 offen sc1 lds
    buffer_load_dwordx4 v13, s[36:39], s52 offen offset:1024 sc1 lds
    buffer_load_dwordx4 v14, s[36:39], s52 offen offset:2048 sc1 lds
    buffer_load_dwordx4 v15, s[36:39], s52 offen offset:3072 sc1 lds
    v_cmp_lt_u32 vcc, 11, v24
    s_cbranch_vccnz A_lB12_ok
    s_cmp_ge_u32 s54, 14
    s_cbranch_scc1 A_lB12_14
    ds_read_b96 v[24:26], v17 offset:16
    s_waitcnt lgkmcnt(0)
    v_min3_u32 v24, v24, v25, v26
    v_cmp_lt_u32 vcc, 11, v24
    s_cbranch_vccnz A_lB12_ok
    s_waitcnt vmcnt(16)
    s_max_u32 s54, s54, 14
    v_mov_b32 v20, s54
    ds_write_b32 v17, v20
A_lB12_14:
    s_cmp_ge_u32 s54, 15
    s_cbranch_scc1 A_lB12_15
    ds_read_b96 v[24:26], v17 offset:16
    s_waitcnt lgkmcnt(0)
    v_min3_u32 v24, v24, v25, v26
    v_cmp_lt_u32 vcc, 11, v24
    s_cbranch_vccnz A_lB12_ok
    s_waitcnt vmcnt(8)
    s_max_u32 s54, s54, 15
    v_mov_b32 v20, s54
    ds_write_b32 v17, v20
A_lB12_15:
    s_cmp_ge_u32 s54, 20
    s_cbranch_scc1 A_lB12_20
    ds_read_b96 v[24:26], v17 offset:16
    s_waitcnt lgkmcnt(0)
    v_min3_u32 v24, v24, v25, v26
    v_cmp_lt_u32 vcc, 11, v24
    s_cbranch_vccnz A_lB12_ok
    s_waitcnt vmcnt(0)
    s_max_u32 s54, s54, 20
    v_mov_b32 v20, s54
    ds_write_b32 v17, v20
A_lB12_20:
A_lB12:
    s_sub_u32 s57, s57, 1
    s_cbranch_scc1 A_end
    ds_read_b96 v[24:26], v17 offset:16
    s_waitcnt lgkmcnt(0)
    v_min3_u32 v24, v24, v25, v26
    v_cmp_lt_u32 vcc, 11, v24
    s_cbranch_vccz A_lB12
A_lB12_ok:
    s_add_u32 m0, s84, 0
    s_add_u32 s52, s84, 65536
    buffer_load_dwordx4 v4, s[28:31], s52 offen nt lds
    buffer_load_dwordx4 v5, s[28:31], s52 offen offset:1024 nt lds
    buffer_load_dwordx4 v6, s[28:31], s52 offen offset:2048 nt lds
    buffer_load_dwordx4 v7, s[28:31], s52 offen offset:3072 nt lds
    s_add_u32 m0, s85, 0
    s_add_u32 s52, s85, 65536
    buffer_load_dwordx4 v4, s[28:31], s52 offen nt lds
    buffer_load_dwordx4 v5, s[28:31], s52 offen offset:1024 nt lds
    buffer_load_dwordx4 v6, s[28:31], s52 offen offset:2048 nt lds
    buffer_load_dwordx4 v7, s[28:31], s52 offen offset:3072 nt lds
    s_waitcnt vmcnt(36)
    s_add_u32 m0, s86, 0
    s_add_u32 s52, s86, 65536
    buffer_load_dwordx4 v4, s[28:31], s52 offen nt lds
    buffer_load_dwordx4 v5, s[28:31], s52 offen offset:1024 nt lds
    buffer_load_dwordx4 v6, s[28:31], s52 offen offset:2048 nt lds
    buffer_load_dwordx4 v7, s[28:31], s52 offen offset:3072 nt lds
    s_waitcnt vmcnt(36)
    s_add_u32 m0, s87, 0
    s_add_u32 s52, s87, 65536
    buffer_load_dwordx4 v4, s[28:31], s52 offen nt lds
    buffer_load_dwordx4 v5, s[28:31], s52 offen offset:1024 nt lds
    buffer_load_dwordx4 v6, s[28:31], s52 offen offset:2048 nt lds
    buffer_load_dwordx4 v7, s[28:31], s52 offen offset:3072 nt lds
    s_waitcnt vmcnt(36)
    s_waitcnt vmcnt(16)
    s_max_u32 s54, s54, 20
    v_mov_b32 v20, s54
    ds_write_b32 v17, v20
    s_add_u32 m0, s84, 16384
    s_add_u32 s52, s84, 81920
    buffer_load_dwordx4 v4, s[28:31], s52 offen nt lds
    buffer_load_dwordx4 v5, s[28:31], s52 offen offset:1024 nt lds
    buffer_load_dwordx4 v6, s[28:31], s52 offen offset:2048 nt lds
    buffer_load_dwordx4 v7, s[28:31], s52 offen offset:3072 nt lds
    s_add_u32 m0, s85, 16384
    s_add_u32 s52, s85, 81920
    buffer_load_dwordx4 v4, s[28:31], s52 offen nt lds
    buffer_load_dwordx4 v5, s[28:31], s52 offen offset:1024 nt lds
    buffer_load_dwordx4 v6, s[28:31], s52 offen offset:2048 nt lds
    buffer_load_dwordx4 v7, s[28:31], s52 offen offset:3072 nt lds
    s_add_u32 m0, s86, 16384
    s_add_u32 s52, s86, 81920
    buffer_load_dwordx4 v4, s[28:31], s52 offen nt lds
    buffer_load_dwordx4 v5, s[28:31], s52 offen offset:1024 nt lds
    buffer_load_dwordx4 v6, s[28:31], s52 offen offset:2048 nt lds
    buffer_load_dwordx4 v7, s[28:31], s52 offen offset:3072 nt lds
    s_add_u32 m0, s87, 16384
    s_add_u32 s52, s87, 81920
    buffer_load_dwordx4 v4, s[28:31], s52 offen nt lds
    buffer_load_dwordx4 v5, s[28:31], s52 offen offset:1024 nt lds
    buffer_load_dwordx4 v6, s[28:31], s52 offen offset:2048 nt lds
    buffer_load_dwordx4 v7, s[28:31], s52 offen offset:3072 nt lds
    v_cmp_lt_u32 vcc, 13, v24
    s_cbranch_vccnz A_lB13_ok
    s_cmp_ge_u32 s54, 21
    s_cbranch_scc1 A_lB13_21
    ds_read_b96 v[24:26], v17 offset:16
    s_waitcnt lgkmcnt(0)
    v_min3_u32 v24, v24, v25, v26
    v_cmp_lt_u32 vcc, 13, v24
    s_cbranch_vccnz A_lB13_ok
    s_waitcnt vmcnt(16)
    s_max_u32 s54, s54, 21
    v_mov_b32 v20, s54
    ds_write_b32 v17, v20
A_lB13_21:
    s_cmp_ge_u32 s54, 22
    s_cbranch_scc1 A_lB13_22
    ds_read_b96 v[24:26], v17 offset:16
    s_waitcnt lgkmcnt(0)
    v_min3_u32 v24, v24, v25, v26
    v_cmp_lt_u32 vcc, 13, v24
    s_cbranch_vccnz A_lB13_ok
    s_waitcnt vmcnt(0)
    s_max_u32 s54, s54, 22
    v_mov_b32 v20, s54
    ds_write_b32 v17, v20
A_lB13_22:
A_lB13:
    s_sub_u32 s57, s57, 1
    s_cbranch_scc1 A_end
    ds_read_b96 v[24:26], v17 offset:16
    s_waitcnt lgkmcnt(0)
    v_min3_u32 v24, v24, v25, v26
    v_cmp_lt_u32 vcc, 13, v24
    s_cbranch_vccz A_lB13
A_lB13_ok:
    s_add_u32 m0, s84, 32768
    s_add_u32 s52, s84, 98304
    buffer_load_dwordx4 v4, s[28:31], s52 offen nt lds
    buffer_load_dwordx4 v5, s[28:31], s52 offen offset:1024 nt lds
    buffer_load_dwordx4 v6, s[28:31], s52 offen offset:2048 nt lds
    buffer_load_dwordx4 v7, s[28:31], s52 offen offset:3072 nt lds
    s_add_u32 m0, s85, 32768
    s_add_u32 s52, s85, 98304
    buffer_load_dwordx4 v4, s[28:31], s52 offen nt lds
    buffer_load_dwordx4 v5, s[28:31], s52 offen offset:1024 nt lds
    buffer_load_dwordx4 v6, s[28:31], s52 offen offset:2048 nt lds
    buffer_load_dwordx4 v7, s[28:31], s52 offen offset:3072 nt lds
    s_waitcnt vmcnt(36)
    s_add_u32 m0, s86, 32768
    s_add_u32 s52, s86, 98304
    buffer_load_dwordx4 v4, s[28:31], s52 offen nt lds
    buffer_load_dwordx4 v5, s[28:31], s52 offen offset:1024 nt lds
    buffer_load_dwordx4 v6, s[28:31], s52 offen offset:2048 nt lds
    buffer_load_dwordx4 v7, s[28:31], s52 offen offset:3072 nt lds
    s_waitcnt vmcnt(36)
    s_add_u32 m0, s87, 32768
    s_add_u32 s52, s87, 98304
    buffer_load_dwordx4 v4, s[28:31], s52 offen nt lds
    buffer_load_dwordx4 v5, s[28:31], s52 offen offset:1024 nt lds
    buffer_load_dwordx4 v6, s[28:31], s52 offen offset:2048 nt lds
    buffer_load_dwordx4 v7, s[28:31], s52 offen offset:3072 nt lds
    s_waitcnt vmcnt(36)
    v_cmp_lt_u32 vcc, 14, v24
    s_cbranch_vccnz A_lB14_ok
    s_cmp_ge_u32 s54, 21
    s_cbranch_scc1 A_lB14_21
    ds_read_b96 v[24:26], v17 offset:16
    s_waitcnt lgkmcnt(0)
    v_min3_u32 v24, v24, v25, v26
    v_cmp_lt_u32 vcc, 14, v24
    s_cbranch_vccnz A_lB14_ok
    s_waitcnt vmcnt(32)
    s_max_u32 s54, s54, 21
    v_mov_b32 v20, s54
    ds_write_b32 v17, v20
A_lB14_21:
    s_cmp_ge_u32 s54, 22
    s_cbranch_scc1 A_lB14_22
    ds_read_b96 v[24:26], v17 offset:16
    s_waitcnt lgkmcnt(0)
    v_min3_u32 v24, v24, v25, v26
    v_cmp_lt_u32 vcc, 14, v24
    s_cbranch_vccnz A_lB14_ok
    s_waitcnt vmcnt(16)
    s_max_u32 s54, s54, 22
    v_mov_b32 v20, s54
    ds_write_b32 v17, v20
A_lB14_22:
    s_cmp_ge_u32 s54, 23
    s_cbranch_scc1 A_lB14_23
    ds_read_b96 v[24:26], v17 offset:16
    s_waitcnt lgkmcnt(0)
    v_min3_u32 v24, v24, v25, v26
    v_cmp_lt_u32 vcc, 14, v24
    s_cbranch_vccnz A_lB14_ok
    s_waitcnt vmcnt(0)
    s_max_u32 s54, s54, 23
    v_mov_b32 v20, s54
    ds_write_b32 v17, v20
A_lB14_23:
A_lB14:
    s_sub_u32 s57, s57, 1
    s_cbranch_scc1 A_end
    ds_read_b96 v[24:26], v17 offset:16
    s_waitcnt lgkmcnt(0)
    v_min3_u32 v24, v24, v25, v26
    v_cmp_lt_u32 vcc, 14, v24
    s_cbranch_vccz A_lB14
A_lB14_ok:
    s_waitcnt lgkmcnt(0)
    ds_write_b128 v48, a[0:3] offset:49152
    ds_write_b128 v48, a[4:7] offset:50176
    ds_write_b128 v48, a[8:11] offset:51200
    ds_write_b128 v48, a[12:15] offset:52224
    ds_write_b128 v49, a[16:19] offset:49152
    ds_write_b128 v49, a[20:23] offset:50176
    ds_write_b128 v49, a[24:27] offset:51200
    ds_write_b128 v49, a[28:31] offset:52224
    ds_write_b128 v50, a[32:35] offset:49152
    ds_write_b128 v50, a[36:39] offset:50176
    ds_write_b128 v50, a[40:43] offset:51200
    ds_write_b128 v50, a[44:47] offset:52224
    s_waitcnt lgkmcnt(6)
    ds_write_b128 v51, a[48:51] offset:49152
    ds_write_b128 v51, a[52:55] offset:50176
    ds_write_b128 v51, a[56:59] offset:51200
    ds_write_b128 v51, a[60:63] offset:52224
    s_waitcnt lgkmcnt(0)
    v_cmp_lt_u32 vcc, 15, v24
    s_cbranch_vccnz A_lB15_ok
    s_cmp_ge_u32 s54, 21
    s_cbranch_scc1 A_lB15_21
    ds_read_b96 v[24:26], v17 offset:16
    s_waitcnt lgkmcnt(0)
    v_min3_u32 v24, v24, v25, v26
    v_cmp_lt_u32 vcc, 15, v24
    s_cbranch_vccnz A_lB15_ok
    s_waitcnt vmcnt(32)
    s_max_u32 s54, s54, 21
    v_mov_b32 v20, s54
    ds_write_b32 v17, v20
A_lB15_21:
    s_cmp_ge_u32 s54, 22
    s_cbranch_scc1 A_lB15_22
    ds_read_b96 v[24:26], v17 offset:16
    s_waitcnt lgkmcnt(0)
    v_min3_u32 v24, v24, v25, v26
    v_cmp_lt_u32 vcc, 15, v24
    s_cbranch_vccnz A_lB15_ok
    s_waitcnt vmcnt(16)
    s_max_u32 s54, s54, 22
    v_mov_b32 v20, s54
    ds_write_b32 v17, v20
A_lB15_22:
    s_cmp_ge_u32 s54, 24
    s_cbranch_scc1 A_lB15_24
    ds_read_b96 v[24:26], v17 offset:16
    s_waitcnt lgkmcnt(0)
    v_min3_u32 v24, v24, v25, v26
    v_cmp_lt_u32 vcc, 15, v24
    s_cbranch_vccnz A_lB15_ok
    s_waitcnt vmcnt(0)
    s_max_u32 s54, s54, 24
    v_mov_b32 v20, s54
    ds_write_b32 v17, v20
A_lB15_24:
A_lB15:
    s_sub_u32 s57, s57, 1
    s_cbranch_scc1 A_end
    ds_read_b96 v[24:26], v17 offset:16
    s_waitcnt lgkmcnt(0)
    v_min3_u32 v24, v24, v25, v26
    v_cmp_lt_u32 vcc, 15, v24
    s_cbranch_vccz A_lB15
A_lB15_ok:
    s_add_u32 m0, s84, 65536
    s_add_u32 s52, s88, 0
    buffer_load_dwordx4 v36, s[32:35], s52 offen nt lds
    buffer_load_dwordx4 v37, s[32:35], s52 offen offset:1024 nt lds
    buffer_load_dwordx4 v38, s[32:35], s52 offen offset:2048 nt lds
    buffer_load_dwordx4 v39, s[32:35], s52 offen offset:3072 nt lds
    s_waitcnt vmcnt(36)
    s_max_u32 s54, s54, 21
    v_mov_b32 v20, s54
    ds_write_b32 v17, v20
    s_add_u32 m0, s85, 65536
    s_add_u32 s52, s89, 0
    buffer_load_dwordx4 v36, s[32:35], s52 offen nt lds
    buffer_load_dwordx4 v37, s[32:35], s52 offen offset:1024 nt lds
    buffer_load_dwordx4 v38, s[32:35], s52 offen offset:2048 nt lds
    buffer_load_dwordx4 v39, s[32:35], s52 offen offset:3072 nt lds
    s_waitcnt vmcnt(36)
    s_add_u32 m0, s86, 65536
    s_add_u32 s52, s90, 0
    buffer_load_dwordx4 v36, s[32:35], s52 offen nt lds
    buffer_load_dwordx4 v37, s[32:35], s52 offen offset:1024 nt lds
    buffer_load_dwordx4 v38, s[32:35], s52 offen offset:2048 nt lds
    buffer_load_dwordx4 v39, s[32:35], s52 offen offset:3072 nt lds
    s_waitcnt vmcnt(36)
    s_add_u32 m0, s87, 65536
    s_add_u32 s52, s91, 0
    buffer_load_dwordx4 v36, s[32:35], s52 offen nt lds
    buffer_load_dwordx4 v37, s[32:35], s52 offen offset:1024 nt lds
    buffer_load_dwordx4 v38, s[32:35], s52 offen offset:2048 nt lds
    buffer_load_dwordx4 v39, s[32:35], s52 offen offset:3072 nt lds
    s_waitcnt vmcnt(36)
    v_cmp_lt_u32 vcc, 16, v24
    s_cbranch_vccnz A_lB16_ok
    s_cmp_ge_u32 s54, 22
    s_cbranch_scc1 A_lB16_22
    ds_read_b96 v[24:26], v17 offset:16
    s_waitcnt lgkmcnt(0)
    v_min3_u32 v24, v24, v25, v26
    v_cmp_lt_u32 vcc, 16, v24
    s_cbranch_vccnz A_lB16_ok
    s_waitcnt vmcnt(32)
    s_max_u32 s54, s54, 22
    v_mov_b32 v20, s54
    ds_write_b32 v17, v20
A_lB16_22:
    s_cmp_ge_u32 s54, 24
    s_cbranch_scc1 A_lB16_24
    ds_read_b96 v[24:26], v17 offset:16
    s_waitcnt lgkmcnt(0)
    v_min3_u32 v24, v24, v25, v26
    v_cmp_lt_u32 vcc, 16, v24
    s_cbranch_vccnz A_lB16_ok
    s_waitcnt vmcnt(16)
    s_max_u32 s54, s54, 24
    v_mov_b32 v20, s54
    ds_write_b32 v17, v20
A_lB16_24:
    s_cmp_ge_u32 s54, 25
    s_cbranch_scc1 A_lB16_25
    ds_read_b96 v[24:26], v17 offset:16
    s_waitcnt lgkmcnt(0)
    v_min3_u32 v24, v24, v25, v26
    v_cmp_lt_u32 vcc, 16, v24
    s_cbranch_vccnz A_lB16_ok
    s_waitcnt vmcnt(0)
    s_max_u32 s54, s54, 25
    v_mov_b32 v20, s54
    ds_write_b32 v17, v20
A_lB16_25:
A_lB16:
    s_sub_u32 s57, s57, 1
    s_cbranch_scc1 A_end
    ds_read_b96 v[24:26], v17 offset:16
    s_waitcnt lgkmcnt(0)
    v_min3_u32 v24, v24, v25, v26
    v_cmp_lt_u32 vcc, 16, v24
    s_cbranch_vccz A_lB16
A_lB16_ok:
    s_add_u32 m0, s84, 90112
    s_add_u32 s52, s88, 32768
    buffer_load_dwordx4 v36, s[32:35], s52 offen nt lds
    buffer_load_dwordx4 v37, s[32:35], s52 offen offset:1024 nt lds
    buffer_load_dwordx4 v38, s[32:35], s52 offen offset:2048 nt lds
    buffer_load_dwordx4 v39, s[32:35], s52 offen offset:3072 nt lds
    s_waitcnt vmcnt(36)
    s_max_u32 s54, s54, 22
    v_mov_b32 v20, s54
    ds_write_b32 v17, v20
    s_add_u32 m0, s85, 90112
    s_add_u32 s52, s89, 32768
    buffer_load_dwordx4 v36, s[32:35], s52 offen nt lds
    buffer_load_dwordx4 v37, s[32:35], s52 offen offset:1024 nt lds
    buffer_load_dwordx4 v38, s[32:35], s52 offen offset:2048 nt lds
    buffer_load_dwordx4 v39, s[32:35], s52 offen offset:3072 nt lds
    s_waitcnt vmcnt(36)
    s_add_u32 m0, s86, 90112
    s_add_u32 s52, s90, 32768
    buffer_load_dwordx4 v36, s[32:35], s52 offen nt lds
    buffer_load_dwordx4 v37, s[32:35], s52 offen offset:1024 nt lds
    buffer_load_dwordx4 v38, s[32:35], s52 offen offset:2048 nt lds
    buffer_load_dwordx4 v39, s[32:35], s52 offen offset:3072 nt lds
    s_waitcnt vmcnt(36)
    s_add_u32 m0, s87, 90112
    s_add_u32 s52, s91, 32768
    buffer_load_dwordx4 v36, s[32:35], s52 offen nt lds
    buffer_load_dwordx4 v37, s[32:35], s52 offen offset:1024 nt lds
    buffer_load_dwordx4 v38, s[32:35], s52 offen offset:2048 nt lds
    buffer_load_dwordx4 v39, s[32:35], s52 offen offset:3072 nt lds
    s_waitcnt vmcnt(36)
    v_cmp_lt_u32 vcc, 17, v24
    s_cbranch_vccnz A_lB17_ok
    s_cmp_ge_u32 s54, 24
    s_cbranch_scc1 A_lB17_24
    ds_read_b96 v[24:26], v17 offset:16
    s_waitcnt lgkmcnt(0)
    v_min3_u32 v24, v24, v25, v26
    v_cmp_lt_u32 vcc, 17, v24
    s_cbranch_vccnz A_lB17_ok
    s_waitcnt vmcnt(32)
    s_max_u32 s54, s54, 24
    v_mov_b32 v20, s54
    ds_write_b32 v17, v20
A_lB17_24:
    s_cmp_ge_u32 s54, 25
    s_cbranch_scc1 A_lB17_25
    ds_read_b96 v[24:26], v17 offset:16
    s_waitcnt lgkmcnt(0)
    v_min3_u32 v24, v24, v25, v26
    v_cmp_lt_u32 vcc, 17, v24
    s_cbranch_vccnz A_lB17_ok
    s_waitcnt vmcnt(16)
    s_max_u32 s54, s54, 25
    v_mov_b32 v20, s54
    ds_write_b32 v17, v20
A_lB17_25:
    s_cmp_ge_u32 s54, 26
    s_cbranch_scc1 A_lB17_26
    ds_read_b96 v[24:26], v17 offset:16
    s_waitcnt lgkmcnt(0)
    v_min3_u32 v24, v24, v25, v26
    v_cmp_lt_u32 vcc, 17, v24
    s_cbranch_vccnz A_lB17_ok
    s_waitcnt vmcnt(0)
    s_max_u32 s54, s54, 26
    v_mov_b32 v20, s54
    ds_write_b32 v17, v20
A_lB17_26:
A_lB17:
    s_sub_u32 s57, s57, 1
    s_cbranch_scc1 A_end
    ds_read_b96 v[24:26], v17 offset:16
    s_waitcnt lgkmcnt(0)
    v_min3_u32 v24, v24, v25, v26
    v_cmp_lt_u32 vcc, 17, v24
    s_cbranch_vccz A_lB17
A_lB17_ok:
    s_add_u32 m0, s84, 106496
    s_add_u32 s52, s88, 65536
    buffer_load_dwordx4 v36, s[32:35], s52 offen nt lds
    buffer_load_dwordx4 v37, s[32:35], s52 offen offset:1024 nt lds
    buffer_load_dwordx4 v38, s[32:35], s52 offen offset:2048 nt lds
    buffer_load_dwordx4 v39, s[32:35], s52 offen offset:3072 nt lds
    s_waitcnt vmcnt(36)
    s_max_u32 s54, s54, 24
    v_mov_b32 v20, s54
    ds_write_b32 v17, v20
    s_add_u32 m0, s85, 106496
    s_add_u32 s52, s89, 65536
    buffer_load_dwordx4 v36, s[32:35], s52 offen nt lds
    buffer_load_dwordx4 v37, s[32:35], s52 offen offset:1024 nt lds
    buffer_load_dwordx4 v38, s[32:35], s52 offen offset:2048 nt lds
    buffer_load_dwordx4 v39, s[32:35], s52 offen offset:3072 nt lds
    s_waitcnt vmcnt(36)
    s_add_u32 m0, s86, 106496
    s_add_u32 s52, s90, 65536
    buffer_load_dwordx4 v36, s[32:35], s52 offen nt lds
    buffer_load_dwordx4 v37, s[32:35], s52 offen offset:1024 nt lds
    buffer_load_dwordx4 v38, s[32:35], s52 offen offset:2048 nt lds
    buffer_load_dwordx4 v39, s[32:35], s52 offen offset:3072 nt lds
    s_waitcnt vmcnt(36)
    s_add_u32 m0, s87, 106496
    s_add_u32 s52, s91, 65536
    buffer_load_dwordx4 v36, s[32:35], s52 offen nt lds
    buffer_load_dwordx4 v37, s[32:35], s52 offen offset:1024 nt lds
    buffer_load_dwordx4 v38, s[32:35], s52 offen offset:2048 nt lds
    buffer_load_dwordx4 v39, s[32:35], s52 offen offset:3072 nt lds
    s_waitcnt vmcnt(36)
    v_cmp_lt_u32 vcc, 18, v24
    s_cbranch_vccnz A_lB18_ok
    s_cmp_ge_u32 s54, 25
    s_cbranch_scc1 A_lB18_25
    ds_read_b96 v[24:26], v17 offset:16
    s_waitcnt lgkmcnt(0)
    v_min3_u32 v24, v24, v25, v26
    v_cmp_lt_u32 vcc, 18, v24
    s_cbranch_vccnz A_lB18_ok
    s_waitcnt vmcnt(32)
    s_max_u32 s54, s54, 25
    v_mov_b32 v20, s54
    ds_write_b32 v17, v20
A_lB18_25:
    s_cmp_ge_u32 s54, 26
    s_cbranch_scc1 A_lB18_26
    ds_read_b96 v[24:26], v17 offset:16
    s_waitcnt lgkmcnt(0)
    v_min3_u32 v24, v24, v25, v26
    v_cmp_lt_u32 vcc, 18, v24
    s_cbranch_vccnz A_lB18_ok
    s_waitcnt vmcnt(16)
    s_max_u32 s54, s54, 26
    v_mov_b32 v20, s54
    ds_write_b32 v17, v20
A_lB18_26:
    s_cmp_ge_u32 s54, 27
    s_cbranch_scc1 A_lB18_27
    ds_read_b96 v[24:26], v17 offset:16
    s_waitcnt lgkmcnt(0)
    v_min3_u32 v24, v24, v25, v26
    v_cmp_lt_u32 vcc, 18, v24
    s_cbranch_vccnz A_lB18_ok
    s_waitcnt vmcnt(0)
    s_max_u32 s54, s54, 27
    v_mov_b32 v20, s54
    ds_write_b32 v17, v20
A_lB18_27:
A_lB18:
    s_sub_u32 s57, s57, 1
    s_cbranch_scc1 A_end
    ds_read_b96 v[24:26], v17 offset:16
    s_waitcnt lgkmcnt(0)
    v_min3_u32 v24, v24, v25, v26
    v_cmp_lt_u32 vcc, 18, v24
    s_cbranch_vccz A_lB18
A_lB18_ok:
    s_add_u32 m0, s84, 122880
    s_add_u32 s52, s88, 98304
    buffer_load_dwordx4 v36, s[32:35], s52 offen nt lds
    buffer_load_dwordx4 v37, s[32:35], s52 offen offset:1024 nt lds
    buffer_load_dwordx4 v38, s[32:35], s52 offen offset:2048 nt lds
    buffer_load_dwordx4 v39, s[32:35], s52 offen offset:3072 nt lds
    s_waitcnt vmcnt(36)
    s_max_u32 s54, s54, 25
    v_mov_b32 v20, s54
    ds_write_b32 v17, v20
    s_add_u32 m0, s85, 122880
    s_add_u32 s52, s89, 98304
    buffer_load_dwordx4 v36, s[32:35], s52 offen nt lds
    buffer_load_dwordx4 v37, s[32:35], s52 offen offset:1024 nt lds
    buffer_load_dwordx4 v38, s[32:35], s52 offen offset:2048 nt lds
    buffer_load_dwordx4 v39, s[32:35], s52 offen offset:3072 nt lds
    s_waitcnt vmcnt(36)
    s_add_u32 m0, s86, 122880
    s_add_u32 s52, s90, 98304
    buffer_load_dwordx4 v36, s[32:35], s52 offen nt lds
    buffer_load_dwordx4 v37, s[32:35], s52 offen offset:1024 nt lds
    buffer_load_dwordx4 v38, s[32:35], s52 offen offset:2048 nt lds
    buffer_load_dwordx4 v39, s[32:35], s52 offen offset:3072 nt lds
    s_waitcnt vmcnt(36)
    s_add_u32 m0, s87, 122880
    s_add_u32 s52, s91, 98304
    buffer_load_dwordx4 v36, s[32:35], s52 offen nt lds
    buffer_load_dwordx4 v37, s[32:35], s52 offen offset:1024 nt lds
    buffer_load_dwordx4 v38, s[32:35], s52 offen offset:2048 nt lds
    buffer_load_dwordx4 v39, s[32:35], s52 offen offset:3072 nt lds
    s_waitcnt vmcnt(36)
    v_cmp_lt_u32 vcc, 19, v24
    s_cbranch_vccnz A_lB19_ok
    s_cmp_ge_u32 s54, 26
    s_cbranch_scc1 A_lB19_26
    ds_read_b96 v[24:26], v17 offset:16
    s_waitcnt lgkmcnt(0)
    v_min3_u32 v24, v24, v25, v26
    v_cmp_lt_u32 vcc, 19, v24
    s_cbranch_vccnz A_lB19_ok
    s_waitcnt vmcnt(32)
    s_max_u32 s54, s54, 26
    v_mov_b32 v20, s54
    ds_write_b32 v17, v20
A_lB19_26:
    s_cmp_ge_u32 s54, 27
    s_cbranch_scc1 A_lB19_27
    ds_read_b96 v[24:26], v17 offset:16
    s_waitcnt lgkmcnt(0)
    v_min3_u32 v24, v24, v25, v26
    v_cmp_lt_u32 vcc, 19, v24
    s_cbranch_vccnz A_lB19_ok
    s_waitcnt vmcnt(16)
    s_max_u32 s54, s54, 27
    v_mov_b32 v20, s54
    ds_write_b32 v17, v20
A_lB19_27:
    s_cmp_ge_u32 s54, 28
    s_cbranch_scc1 A_lB19_28
    ds_read_b96 v[24:26], v17 offset:16
    s_waitcnt lgkmcnt(0)
    v_min3_u32 v24, v24, v25, v26
    v_cmp_lt_u32 vcc, 19, v24
    s_cbranch_vccnz A_lB19_ok
    s_waitcnt vmcnt(0)
    s_max_u32 s54, s54, 28
    v_mov_b32 v20, s54
    ds_write_b32 v17, v20
A_lB19_28:
A_lB19:
    s_sub_u32 s57, s57, 1
    s_cbranch_scc1 A_end
    ds_read_b96 v[24:26], v17 offset:16
    s_waitcnt lgkmcnt(0)
    v_min3_u32 v24, v24, v25, v26
    v_cmp_lt_u32 vcc, 19, v24
    s_cbranch_vccz A_lB19
A_lB19_ok:
    s_add_u32 m0, s84, 139264
    s_add_u32 s52, s88, 128
    buffer_load_dwordx4 v36, s[32:35], s52 offen nt lds
    buffer_load_dwordx4 v37, s[32:35], s52 offen offset:1024 nt lds
    buffer_load_dwordx4 v38, s[32:35], s52 offen offset:2048 nt lds
    buffer_load_dwordx4 v39, s[32:35], s52 offen offset:3072 nt lds
    s_waitcnt vmcnt(36)
    s_max_u32 s54, s54, 26
    v_mov_b32 v20, s54
    ds_write_b32 v17, v20
    s_add_u32 m0, s85, 139264
    s_add_u32 s52, s89, 128
    buffer_load_dwordx4 v36, s[32:35], s52 offen nt lds
    buffer_load_dwordx4 v37, s[32:35], s52 offen offset:1024 nt lds
    buffer_load_dwordx4 v38, s[32:35], s52 offen offset:2048 nt lds
    buffer_load_dwordx4 v39, s[32:35], s52 offen offset:3072 nt lds
    s_waitcnt vmcnt(36)
    s_add_u32 m0, s86, 139264
    s_add_u32 s52, s90, 128
    buffer_load_dwordx4 v36, s[32:35], s52 offen nt lds
    buffer_load_dwordx4 v37, s[32:35], s52 offen offset:1024 nt lds
    buffer_load_dwordx4 v38, s[32:35], s52 offen offset:2048 nt lds
    buffer_load_dwordx4 v39, s[32:35], s52 offen offset:3072 nt lds
    s_waitcnt vmcnt(36)
    s_add_u32 m0, s87, 139264
    s_add_u32 s52, s91, 128
    buffer_load_dwordx4 v36, s[32:35], s52 offen nt lds
    buffer_load_dwordx4 v37, s[32:35], s52 offen offset:1024 nt lds
    buffer_load_dwordx4 v38, s[32:35], s52 offen offset:2048 nt lds
    buffer_load_dwordx4 v39, s[32:35], s52 offen offset:3072 nt lds
    s_waitcnt vmcnt(36)
    v_cmp_lt_u32 vcc, 20, v24
    s_cbranch_vccnz A_lB20_ok
    s_cmp_ge_u32 s54, 27
    s_cbranch_scc1 A_lB20_27
    ds_read_b96 v[24:26], v17 offset:16
    s_waitcnt lgkmcnt(0)
    v_min3_u32 v24, v24, v25, v26
    v_cmp_lt_u32 vcc, 20, v24
    s_cbranch_vccnz A_lB20_ok
    s_waitcnt vmcnt(32)
    s_max_u32 s54, s54, 27
    v_mov_b32 v20, s54
    ds_write_b32 v17, v20
A_lB20_27:
    s_cmp_ge_u32 s54, 28
    s_cbranch_scc1 A_lB20_28
    ds_read_b96 v[24:26], v17 offset:16
    s_waitcnt lgkmcnt(0)
    v_min3_u32 v24, v24, v25, v26
    v_cmp_lt_u32 vcc, 20, v24
    s_cbranch_vccnz A_lB20_ok
    s_waitcnt vmcnt(16)
    s_max_u32 s54, s54, 28
    v_mov_b32 v20, s54
    ds_write_b32 v17, v20
A_lB20_28:
    s_cmp_ge_u32 s54, 29
    s_cbranch_scc1 A_lB20_29
    ds_read_b96 v[24:26], v17 offset:16
    s_waitcnt lgkmcnt(0)
    v_min3_u32 v24, v24, v25, v26
    v_cmp_lt_u32 vcc, 20, v24
    s_cbranch_vccnz A_lB20_ok
    s_waitcnt vmcnt(0)
    s_max_u32 s54, s54, 29
    v_mov_b32 v20, s54
    ds_write_b32 v17, v20
A_lB20_29:
A_lB20:
    s_sub_u32 s57, s57, 1
    s_cbranch_scc1 A_end
    ds_read_b96 v[24:26], v17 offset:16
    s_waitcnt lgkmcnt(0)
    v_min3_u32 v24, v24, v25, v26
    v_cmp_lt_u32 vcc, 20, v24
    s_cbranch_vccz A_lB20
A_lB20_ok:
    s_add_u32 m0, s84, 0
    s_add_u32 s52, s88, 32896
    buffer_load_dwordx4 v36, s[32:35], s52 offen nt lds
    buffer_load_dwordx4 v37, s[32:35], s52 offen offset:1024 nt lds
    buffer_load_dwordx4 v38, s[32:35], s52 offen offset:2048 nt lds
    buffer_load_dwordx4 v39, s[32:35], s52 offen offset:3072 nt lds
    s_waitcnt vmcnt(36)
    s_max_u32 s54, s54, 27
    v_mov_b32 v20, s54
    ds_write_b32 v17, v20
    s_add_u32 m0, s85, 0
    s_add_u32 s52, s89, 32896
    buffer_load_dwordx4 v36, s[32:35], s52 offen nt lds
    buffer_load_dwordx4 v37, s[32:35], s52 offen offset:1024 nt lds
    buffer_load_dwordx4 v38, s[32:35], s52 offen offset:2048 nt lds
    buffer_load_dwordx4 v39, s[32:35], s52 offen offset:3072 nt lds
    s_waitcnt vmcnt(36)
    s_add_u32 m0, s86, 0
    s_add_u32 s52, s90, 32896
    buffer_load_dwordx4 v36, s[32:35], s52 offen nt lds
    buffer_load_dwordx4 v37, s[32:35], s52 offen offset:1024 nt lds
    buffer_load_dwordx4 v38, s[32:35], s52 offen offset:2048 nt lds
    buffer_load_dwordx4 v39, s[32:35], s52 offen offset:3072 nt lds
    s_waitcnt vmcnt(36)
    s_add_u32 m0, s87, 0
    s_add_u32 s52, s91, 32896
    buffer_load_dwordx4 v36, s[32:35], s52 offen nt lds
    buffer_load_dwordx4 v37, s[32:35], s52 offen offset:1024 nt lds
    buffer_load_dwordx4 v38, s[32:35], s52 offen offset:2048 nt lds
    buffer_load_dwordx4 v39, s[32:35], s52 offen offset:3072 nt lds
    s_waitcnt vmcnt(36)
    v_cmp_lt_u32 vcc, 21, v24
    s_cbranch_vccnz A_lB21_ok
    s_cmp_ge_u32 s54, 28
    s_cbranch_scc1 A_lB21_28
    ds_read_b96 v[24:26], v17 offset:16
    s_waitcnt lgkmcnt(0)
    v_min3_u32 v24, v24, v25, v26
    v_cmp_lt_u32 vcc, 21, v24
    s_cbranch_vccnz A_lB21_ok
    s_waitcnt vmcnt(32)
    s_max_u32 s54, s54, 28
    v_mov_b32 v20, s54
    ds_write_b32 v17, v20
A_lB21_28:
    s_cmp_ge_u32 s54, 29
    s_cbranch_scc1 A_lB21_29
    ds_read_b96 v[24:26], v17 offset:16
    s_waitcnt lgkmcnt(0)
    v_min3_u32 v24, v24, v25, v26
    v_cmp_lt_u32 vcc, 21, v24
    s_cbranch_vccnz A_lB21_ok
    s_waitcnt vmcnt(16)
    s_max_u32 s54, s54, 29
    v_mov_b32 v20, s54
    ds_write_b32 v17, v20
A_lB21_29:
    s_cmp_ge_u32 s54, 30
    s_cbranch_scc1 A_lB21_30
    ds_read_b96 v[24:26], v17 offset:16
    s_waitcnt lgkmcnt(0)
    v_min3_u32 v24, v24, v25, v26
    v_cmp_lt_u32 vcc, 21, v24
    s_cbranch_vccnz A_lB21_ok
    s_waitcnt vmcnt(0)
    s_max_u32 s54, s54, 30
    v_mov_b32 v20, s54
    ds_write_b32 v17, v20
A_lB21_30:
A_lB21:
    s_sub_u32 s57, s57, 1
    s_cbranch_scc1 A_end
    ds_read_b96 v[24:26], v17 offset:16
    s_waitcnt lgkmcnt(0)
    v_min3_u32 v24, v24, v25, v26
    v_cmp_lt_u32 vcc, 21, v24
    s_cbranch_vccz A_lB21
A_lB21_ok:
    s_add_u32 m0, s84, 16384
    s_add_u32 s52, s88, 65664
    buffer_load_dwordx4 v36, s[32:35], s52 offen nt lds
    buffer_load_dwordx4 v37, s[32:35], s52 offen offset:1024 nt lds
    buffer_load_dwordx4 v38, s[32:35], s52 offen offset:2048 nt lds
    buffer_load_dwordx4 v39, s[32:35], s52 offen offset:3072 nt lds
    s_waitcnt vmcnt(36)
    s_max_u32 s54, s54, 28
    v_mov_b32 v20, s54
    ds_write_b32 v17, v20
    s_add_u32 m0, s85, 16384
    s_add_u32 s52, s89, 65664
    buffer_load_dwordx4 v36, s[32:35], s52 offen nt lds
    buffer_load_dwordx4 v37, s[32:35], s52 offen offset:1024 nt lds
    buffer_load_dwordx4 v38, s[32:35], s52 offen offset:2048 nt lds
    buffer_load_dwordx4 v39, s[32:35], s52 offen offset:3072 nt lds
    s_waitcnt vmcnt(36)
    s_add_u32 m0, s86, 16384
    s_add_u32 s52, s90, 65664
    buffer_load_dwordx4 v36, s[32:35], s52 offen nt lds
    buffer_load_dwordx4 v37, s[32:35], s52 offen offset:1024 nt lds
    buffer_load_dwordx4 v38, s[32:35], s52 offen offset:2048 nt lds
    buffer_load_dwordx4 v39, s[32:35], s52 offen offset:3072 nt lds
    s_waitcnt vmcnt(36)
    s_add_u32 m0, s87, 16384
    s_add_u32 s52, s91, 65664
    buffer_load_dwordx4 v36, s[32:35], s52 offen nt lds
    buffer_load_dwordx4 v37, s[32:35], s52 offen offset:1024 nt lds
    buffer_load_dwordx4 v38, s[32:35], s52 offen offset:2048 nt lds
    buffer_load_dwordx4 v39, s[32:35], s52 offen offset:3072 nt lds
    s_waitcnt vmcnt(36)
    v_cmp_lt_u32 vcc, 22, v24
    s_cbranch_vccnz A_lB22_ok
    s_cmp_ge_u32 s54, 29
    s_cbranch_scc1 A_lB22_29
    ds_read_b96 v[24:26], v17 offset:16
    s_waitcnt lgkmcnt(0)
    v_min3_u32 v24, v24, v25, v26
    v_cmp_lt_u32 vcc, 22, v24
    s_cbranch_vccnz A_lB22_ok
    s_waitcnt vmcnt(32)
    s_max_u32 s54, s54, 29
    v_mov_b32 v20, s54
    ds_write_b32 v17, v20
A_lB22_29:
    s_cmp_ge_u32 s54, 30
    s_cbranch_scc1 A_lB22_30
    ds_read_b96 v[24:26], v17 offset:16
    s_waitcnt lgkmcnt(0)
    v_min3_u32 v24, v24, v25, v26
    v_cmp_lt_u32 vcc, 22, v24
    s_cbranch_vccnz A_lB22_ok
    s_waitcnt vmcnt(16)
    s_max_u32 s54, s54, 30
    v_mov_b32 v20, s54
    ds_write_b32 v17, v20
A_lB22_30:
    s_cmp_ge_u32 s54, 31
    s_cbranch_scc1 A_lB22_31
    ds_read_b96 v[24:26], v17 offset:16
    s_waitcnt lgkmcnt(0)
    v_min3_u32 v24, v24, v25, v26
    v_cmp_lt_u32 vcc, 22, v24
    s_cbranch_vccnz A_lB22_ok
    s_waitcnt vmcnt(0)
    s_max_u32 s54, s54, 31
    v_mov_b32 v20, s54
    ds_write_b32 v17, v20
A_lB22_31:
A_lB22:
    s_sub_u32 s57, s57, 1
    s_cbranch_scc1 A_end
    ds_read_b96 v[24:26], v17 offset:16
    s_waitcnt lgkmcnt(0)
    v_min3_u32 v24, v24, v25, v26
    v_cmp_lt_u32 vcc, 22, v24
    s_cbranch_vccz A_lB22
A_lB22_ok:
    s_mov_b32 m0, 32768
    s_mov_b32 s52, 98432
    buffer_load_dwordx4 v36, s[32:35], s52 offen nt lds
    buffer_load_dwordx4 v37, s[32:35], s52 offen offset:1024 nt lds
    buffer_load_dwordx4 v38, s[32:35], s52 offen offset:2048 nt lds
    buffer_load_dwordx4 v39, s[32:35], s52 offen offset:3072 nt lds
    s_waitcnt vmcnt(36)
    s_max_u32 s54, s54, 29
    v_mov_b32 v20, s54
    ds_write_b32 v17, v20
    s_mov_b32 m0, 36864
    s_mov_b32 s52, 106624
    buffer_load_dwordx4 v36, s[32:35], s52 offen nt lds
    buffer_load_dwordx4 v37, s[32:35], s52 offen offset:1024 nt lds
    buffer_load_dwordx4 v38, s[32:35], s52 offen offset:2048 nt lds
    buffer_load_dwordx4 v39, s[32:35], s52 offen offset:3072 nt lds
    s_waitcnt vmcnt(36)
    s_mov_b32 m0, 40960
    s_mov_b32 s52, 114816
    buffer_load_dwordx4 v36, s[32:35], s52 offen nt lds
    buffer_load_dwordx4 v37, s[32:35], s52 offen offset:1024 nt lds
    buffer_load_dwordx4 v38, s[32:35], s52 offen offset:2048 nt lds
    buffer_load_dwordx4 v39, s[32:35], s52 offen offset:3072 nt lds
    s_waitcnt vmcnt(36)
    s_mov_b32 m0, 45056
    s_mov_b32 s52, 123008
    buffer_load_dwordx4 v36, s[32:35], s52 offen nt lds
    buffer_load_dwordx4 v37, s[32:35], s52 offen offset:1024 nt lds
    buffer_load_dwordx4 v38, s[32:35], s52 offen offset:2048 nt lds
    buffer_load_dwordx4 v39, s[32:35], s52 offen offset:3072 nt lds
    s_waitcnt vmcnt(36)
    s_waitcnt vmcnt(16)
    s_max_u32 s54, s54, 31
    v_mov_b32 v20, s54
    ds_write_b32 v17, v20
    v_cmp_lt_u32 vcc, 23, v24
    s_cbranch_vccnz A_lB23_ok
    s_cmp_ge_u32 s54, 32
    s_cbranch_scc1 A_lB23_32
    ds_read_b96 v[24:26], v17 offset:16
    s_waitcnt lgkmcnt(0)
    v_min3_u32 v24, v24, v25, v26
    v_cmp_lt_u32 vcc, 23, v24
    s_cbranch_vccnz A_lB23_ok
    s_waitcnt vmcnt(8)
    s_max_u32 s54, s54, 32
    v_mov_b32 v20, s54
    ds_write_b32 v17, v20
A_lB23_32:
    s_cmp_ge_u32 s54, 33
    s_cbranch_scc1 A_lB23_33
    ds_read_b96 v[24:26], v17 offset:16
    s_waitcnt lgkmcnt(0)
    v_min3_u32 v24, v24, v25, v26
    v_cmp_lt_u32 vcc, 23, v24
    s_cbranch_vccnz A_lB23_ok
    s_waitcnt vmcnt(0)
    s_max_u32 s54, s54, 33
    v_mov_b32 v20, s54
    ds_write_b32 v17, v20
A_lB23_33:
A_lB23:
    s_sub_u32 s57, s57, 1
    s_cbranch_scc1 A_end
    ds_read_b96 v[24:26], v17 offset:16
    s_waitcnt lgkmcnt(0)
    v_min3_u32 v24, v24, v25, v26
    v_cmp_lt_u32 vcc, 23, v24
    s_cbranch_vccz A_lB23
A_lB23_ok:
    s_mov_b32 m0, 49152
    s_add_u32 s55, s53, 0
    s_and_b32 s55, s55, 7
    s_lshl_b32 s55, s55, 17
    s_add_u32 s52, s55, 0
    buffer_load_dwordx4 v32, s[44:47], s52 offen sc1 lds
    buffer_load_dwordx4 v33, s[44:47], s52 offen offset:1024 sc1 lds
    buffer_load_dwordx4 v34, s[44:47], s52 offen offset:2048 sc1 lds
    buffer_load_dwordx4 v35, s[44:47], s52 offen offset:3072 sc1 lds
    s_mov_b32 m0, 53248
    s_add_u32 s52, s55, 32768
    buffer_load_dwordx4 v32, s[44:47], s52 offen sc1 lds
    buffer_load_dwordx4 v33, s[44:47], s52 offen offset:1024 sc1 lds
    buffer_load_dwordx4 v34, s[44:47], s52 offen offset:2048 sc1 lds
    buffer_load_dwordx4 v35, s[44:47], s52 offen offset:3072 sc1 lds
    s_waitcnt vmcnt(16)
    s_max_u32 s54, s54, 32
    v_mov_b32 v20, s54
    ds_write_b32 v17, v20
    s_mov_b32 m0, 57344
    s_add_u32 s55, s53, 1
    s_and_b32 s55, s55, 7
    s_lshl_b32 s55, s55, 17
    s_add_u32 s52, s55, 0
    buffer_load_dwordx4 v32, s[44:47], s52 offen sc1 lds
    buffer_load_dwordx4 v33, s[44:47], s52 offen offset:1024 sc1 lds
    buffer_load_dwordx4 v34, s[44:47], s52 offen offset:2048 sc1 lds
    buffer_load_dwordx4 v35, s[44:47], s52 offen offset:3072 sc1 lds
    s_mov_b32 m0, 61440
    s_add_u32 s52, s55, 32768
    buffer_load_dwordx4 v32, s[44:47], s52 offen sc1 lds
    buffer_load_dwordx4 v33, s[44:47], s52 offen offset:1024 sc1 lds
    buffer_load_dwordx4 v34, s[44:47], s52 offen offset:2048 sc1 lds
    buffer_load_dwordx4 v35, s[44:47], s52 offen offset:3072 sc1 lds
    s_waitcnt vmcnt(16)
    s_max_u32 s54, s54, 33
    v_mov_b32 v20, s54
    ds_write_b32 v17, v20
    v_cmp_lt_u32 vcc, 24, v24
    s_cbranch_vccnz A_lB24_ok
    s_cmp_ge_u32 s54, 34
    s_cbranch_scc1 A_lB24_34
    ds_read_b96 v[24:26], v17 offset:16
    s_waitcnt lgkmcnt(0)
    v_min3_u32 v24, v24, v25, v26
    v_cmp_lt_u32 vcc, 24, v24
    s_cbranch_vccnz A_lB24_ok
    s_waitcnt vmcnt(0)
    s_max_u32 s54, s54, 34
    v_mov_b32 v20, s54
    ds_write_b32 v17, v20
A_lB24_34:
A_lB24:
    s_sub_u32 s57, s57, 1
    s_cbranch_scc1 A_end
    ds_read_b96 v[24:26], v17 offset:16
    s_waitcnt lgkmcnt(0)
    v_min3_u32 v24, v24, v25, v26
    v_cmp_lt_u32 vcc, 24, v24
    s_cbranch_vccz A_lB24
A_lB24_ok:
    s_mov_b32 m0, 65536
    s_add_u32 s55, s53, 2
    s_and_b32 s55, s55, 7
    s_lshl_b32 s55, s55, 17
    s_add_u32 s52, s55, 0
    buffer_load_dwordx4 v32, s[44:47], s52 offen sc1 lds
    buffer_load_dwordx4 v33, s[44:47], s52 offen offset:1024 sc1 lds
    buffer_load_dwordx4 v34, s[44:47], s52 offen offset:2048 sc1 lds
    buffer_load_dwordx4 v35, s[44:47], s52 offen offset:3072 sc1 lds
    s_mov_b32 m0, 69632
    s_add_u32 s52, s55, 32768
    buffer_load_dwordx4 v32, s[44:47], s52 offen sc1 lds
    buffer_load_dwordx4 v33, s[44:47], s52 offen offset:1024 sc1 lds
    buffer_load_dwordx4 v34, s[44:47], s52 offen offset:2048 sc1 lds
    buffer_load_dwordx4 v35, s[44:47], s52 offen offset:3072 sc1 lds
    s_mov_b32 m0, 73728
    s_add_u32 s55, s53, 3
    s_and_b32 s55, s55, 7
    s_lshl_b32 s55, s55, 17
    s_add_u32 s52, s55, 0
    buffer_load_dwordx4 v32, s[44:47], s52 offen sc1 lds
    buffer_load_dwordx4 v33, s[44:47], s52 offen offset:1024 sc1 lds
    buffer_load_dwordx4 v34, s[44:47], s52 offen offset:2048 sc1 lds
    buffer_load_dwordx4 v35, s[44:47], s52 offen offset:3072 sc1 lds
    s_mov_b32 m0, 77824
    s_add_u32 s52, s55, 32768
    buffer_load_dwordx4 v32, s[44:47], s52 offen sc1 lds
    buffer_load_dwordx4 v33, s[44:47], s52 offen offset:1024 sc1 lds
    buffer_load_dwordx4 v34, s[44:47], s52 offen offset:2048 sc1 lds
    buffer_load_dwordx4 v35, s[44:47], s52 offen offset:3072 sc1 lds
    v_cmp_lt_u32 vcc, 25, v24
    s_cbranch_vccnz A_lB25_ok
    s_cmp_ge_u32 s54, 34
    s_cbranch_scc1 A_lB25_34
    ds_read_b96 v[24:26], v17 offset:16
    s_waitcnt lgkmcnt(0)
    v_min3_u32 v24, v24, v25, v26
    v_cmp_lt_u32 vcc, 25, v24
    s_cbranch_vccnz A_lB25_ok
    s_waitcnt vmcnt(16)
    s_max_u32 s54, s54, 34
    v_mov_b32 v20, s54
    ds_write_b32 v17, v20
A_lB25_34:
    s_cmp_ge_u32 s54, 35
    s_cbranch_scc1 A_lB25_35
    ds_read_b96 v[24:26], v17 offset:16
    s_waitcnt lgkmcnt(0)
    v_min3_u32 v24, v24, v25, v26
    v_cmp_lt_u32 vcc, 25, v24
    s_cbranch_vccnz A_lB25_ok
    s_waitcnt vmcnt(0)
    s_max_u32 s54, s54, 35
    v_mov_b32 v20, s54
    ds_write_b32 v17, v20
A_lB25_35:
A_lB25:
    s_sub_u32 s57, s57, 1
    s_cbranch_scc1 A_end
    ds_read_b96 v[24:26], v17 offset:16
    s_waitcnt lgkmcnt(0)
    v_min3_u32 v24, v24, v25, v26
    v_cmp_lt_u32 vcc, 25, v24
    s_cbranch_vccz A_lB25
A_lB25_ok:
    s_mov_b32 m0, 90112
    s_add_u32 s55, s53, 4
    s_and_b32 s55, s55, 7
    s_lshl_b32 s55, s55, 17
    s_add_u32 s52, s55, 0
    buffer_load_dwordx4 v32, s[44:47], s52 offen sc1 lds
    buffer_load_dwordx4 v33, s[44:47], s52 offen offset:1024 sc1 lds
    buffer_load_dwordx4 v34, s[44:47], s52 offen offset:2048 sc1 lds
    buffer_load_dwordx4 v35, s[44:47], s52 offen offset:3072 sc1 lds
    s_mov_b32 m0, 94208
    s_add_u32 s52, s55, 32768
    buffer_load_dwordx4 v32, s[44:47], s52 offen sc1 lds
    buffer_load_dwordx4 v33, s[44:47], s52 offen offset:1024 sc1 lds
    buffer_load_dwordx4 v34, s[44:47], s52 offen offset:2048 sc1 lds
    buffer_load_dwordx4 v35, s[44:47], s52 offen offset:3072 sc1 lds
    s_waitcnt vmcnt(36)
    s_mov_b32 m0, 98304
    s_add_u32 s55, s53, 5
    s_and_b32 s55, s55, 7
    s_lshl_b32 s55, s55, 17
    s_add_u32 s52, s55, 0
    buffer_load_dwordx4 v32, s[44:47], s52 offen sc1 lds
    buffer_load_dwordx4 v33, s[44:47], s52 offen offset:1024 sc1 lds
    buffer_load_dwordx4 v34, s[44:47], s52 offen offset:2048 sc1 lds
    buffer_load_dwordx4 v35, s[44:47], s52 offen offset:3072 sc1 lds
    s_waitcnt vmcnt(36)
    s_mov_b32 m0, 102400
    s_add_u32 s52, s55, 32768
    buffer_load_dwordx4 v32, s[44:47], s52 offen sc1 lds
    buffer_load_dwordx4 v33, s[44:47], s52 offen offset:1024 sc1 lds
    buffer_load_dwordx4 v34, s[44:47], s52 offen offset:2048 sc1 lds
    buffer_load_dwordx4 v35, s[44:47], s52 offen offset:3072 sc1 lds
    s_waitcnt vmcnt(36)
    v_cmp_lt_u32 vcc, 26, v24
    s_cbranch_vccnz A_lB26_ok
    s_cmp_ge_u32 s54, 34
    s_cbranch_scc1 A_lB26_34
    ds_read_b96 v[24:26], v17 offset:16
    s_waitcnt lgkmcnt(0)
    v_min3_u32 v24, v24, v25, v26
    v_cmp_lt_u32 vcc, 26, v24
    s_cbranch_vccnz A_lB26_ok
    s_waitcnt vmcnt(32)
    s_max_u32 s54, s54, 34
    v_mov_b32 v20, s54
    ds_write_b32 v17, v20
A_lB26_34:
    s_cmp_ge_u32 s54, 35
    s_cbranch_scc1 A_lB26_35
    ds_read_b96 v[24:26], v17 offset:16
    s_waitcnt lgkmcnt(0)
    v_min3_u32 v24, v24, v25, v26
    v_cmp_lt_u32 vcc, 26, v24
    s_cbranch_vccnz A_lB26_ok
    s_waitcnt vmcnt(16)
    s_max_u32 s54, s54, 35
    v_mov_b32 v20, s54
    ds_write_b32 v17, v20
A_lB26_35:
    s_cmp_ge_u32 s54, 36
    s_cbranch_scc1 A_lB26_36
    ds_read_b96 v[24:26], v17 offset:16
    s_waitcnt lgkmcnt(0)
    v_min3_u32 v24, v24, v25, v26
    v_cmp_lt_u32 vcc, 26, v24
    s_cbranch_vccnz A_lB26_ok
    s_waitcnt vmcnt(0)
    s_max_u32 s54, s54, 36
    v_mov_b32 v20, s54
    ds_write_b32 v17, v20
A_lB26_36:
A_lB26:
    s_sub_u32 s57, s57, 1
    s_cbranch_scc1 A_end
    ds_read_b96 v[24:26], v17 offset:16
    s_waitcnt lgkmcnt(0)
    v_min3_u32 v24, v24, v25, v26
    v_cmp_lt_u32 vcc, 26, v24
    s_cbranch_vccz A_lB26
A_lB26_ok:
    s_mov_b32 m0, 106496
    s_add_u32 s55, s53, 6
    s_and_b32 s55, s55, 7
    s_lshl_b32 s55, s55, 17
    s_add_u32 s52, s55, 0
    buffer_load_dwordx4 v32, s[44:47], s52 offen sc1 lds
    buffer_load_dwordx4 v33, s[44:47], s52 offen offset:1024 sc1 lds
    buffer_load_dwordx4 v34, s[44:47], s52 offen offset:2048 sc1 lds
    buffer_load_dwordx4 v35, s[44:47], s52 offen offset:3072 sc1 lds
    s_waitcnt vmcnt(36)
    s_max_u32 s54, s54, 34
    v_mov_b32 v20, s54
    ds_write_b32 v17, v20
    s_mov_b32 m0, 110592
    s_add_u32 s52, s55, 32768
    buffer_load_dwordx4 v32, s[44:47], s52 offen sc1 lds
    buffer_load_dwordx4 v33, s[44:47], s52 offen offset:1024 sc1 lds
    buffer_load_dwordx4 v34, s[44:47], s52 offen offset:2048 sc1 lds
    buffer_load_dwordx4 v35, s[44:47], s52 offen offset:3072 sc1 lds
    s_waitcnt vmcnt(36)
    s_mov_b32 m0, 114688
    s_add_u32 s55, s53, 7
    s_and_b32 s55, s55, 7
    s_lshl_b32 s55, s55, 17
    s_add_u32 s52, s55, 0
    buffer_load_dwordx4 v32, s[44:47], s52 offen sc1 lds
    buffer_load_dwordx4 v33, s[44:47], s52 offen offset:1024 sc1 lds
    buffer_load_dwordx4 v34, s[44:47], s52 offen offset:2048 sc1 lds
    buffer_load_dwordx4 v35, s[44:47], s52 offen offset:3072 sc1 lds
    s_waitcnt vmcnt(36)
    s_mov_b32 m0, 118784
    s_add_u32 s52, s55, 32768
    buffer_load_dwordx4 v32, s[44:47], s52 offen sc1 lds
    buffer_load_dwordx4 v33, s[44:47], s52 offen offset:1024 sc1 lds
    buffer_load_dwordx4 v34, s[44:47], s52 offen offset:2048 sc1 lds
    buffer_load_dwordx4 v35, s[44:47], s52 offen offset:3072 sc1 lds
    s_waitcnt vmcnt(36)
    v_cmp_lt_u32 vcc, 27, v24
    s_cbranch_vccnz A_lB27_ok
    s_cmp_ge_u32 s54, 35
    s_cbranch_scc1 A_lB27_35
    ds_read_b96 v[24:26], v17 offset:16
    s_waitcnt lgkmcnt(0)
    v_min3_u32 v24, v24, v25, v26
    v_cmp_lt_u32 vcc, 27, v24
    s_cbranch_vccnz A_lB27_ok
    s_waitcnt vmcnt(32)
    s_max_u32 s54, s54, 35
    v_mov_b32 v20, s54
    ds_write_b32 v17, v20
A_lB27_35:
    s_cmp_ge_u32 s54, 36
    s_cbranch_scc1 A_lB27_36
    ds_read_b96 v[24:26], v17 offset:16
    s_waitcnt lgkmcnt(0)
    v_min3_u32 v24, v24, v25, v26
    v_cmp_lt_u32 vcc, 27, v24
    s_cbranch_vccnz A_lB27_ok
    s_waitcnt vmcnt(16)
    s_max_u32 s54, s54, 36
    v_mov_b32 v20, s54
    ds_write_b32 v17, v20
A_lB27_36:
    s_cmp_ge_u32 s54, 37
    s_cbranch_scc1 A_lB27_37
    ds_read_b96 v[24:26], v17 offset:16
    s_waitcnt lgkmcnt(0)
    v_min3_u32 v24, v24, v25, v26
    v_cmp_lt_u32 vcc, 27, v24
    s_cbranch_vccnz A_lB27_ok
    s_waitcnt vmcnt(0)
    s_max_u32 s54, s54, 37
    v_mov_b32 v20, s54
    ds_write_b32 v17, v20
A_lB27_37:
A_lB27:
    s_sub_u32 s57, s57, 1
    s_cbranch_scc1 A_end
    ds_read_b96 v[24:26], v17 offset:16
    s_waitcnt lgkmcnt(0)
    v_min3_u32 v24, v24, v25, v26
    v_cmp_lt_u32 vcc, 27, v24
    s_cbranch_vccz A_lB27
A_lB27_ok:
    s_mov_b32 m0, 122880
    s_add_u32 s55, s53, 0
    s_and_b32 s55, s55, 7
    s_lshl_b32 s55, s55, 17
    s_add_u32 s52, s55, 65536
    buffer_load_dwordx4 v32, s[44:47], s52 offen sc1 lds
    buffer_load_dwordx4 v33, s[44:47], s52 offen offset:1024 sc1 lds
    buffer_load_dwordx4 v34, s[44:47], s52 offen offset:2048 sc1 lds
    buffer_load_dwordx4 v35, s[44:47], s52 offen offset:3072 sc1 lds
    s_waitcnt vmcnt(36)
    s_max_u32 s54, s54, 35
    v_mov_b32 v20, s54
    ds_write_b32 v17, v20
    s_mov_b32 m0, 126976
    s_add_u32 s52, s55, 98304
    buffer_load_dwordx4 v32, s[44:47], s52 offen sc1 lds
    buffer_load_dwordx4 v33, s[44:47], s52 offen offset:1024 sc1 lds
    buffer_load_dwordx4 v34, s[44:47], s52 offen offset:2048 sc1 lds
    buffer_load_dwordx4 v35, s[44:47], s52 offen offset:3072 sc1 lds
    s_waitcnt vmcnt(36)
    s_mov_b32 m0, 131072
    s_add_u32 s55, s53, 1
    s_and_b32 s55, s55, 7
    s_lshl_b32 s55, s55, 17
    s_add_u32 s52, s55, 65536
    buffer_load_dwordx4 v32, s[44:47], s52 offen sc1 lds
    buffer_load_dwordx4 v33, s[44:47], s52 offen offset:1024 sc1 lds
    buffer_load_dwordx4 v34, s[44:47], s52 offen offset:2048 sc1 lds
    buffer_load_dwordx4 v35, s[44:47], s52 offen offset:3072 sc1 lds
    s_waitcnt vmcnt(36)
    s_mov_b32 m0, 135168
    s_add_u32 s52, s55, 98304
    buffer_load_dwordx4 v32, s[44:47], s52 offen sc1 lds
    buffer_load_dwordx4 v33, s[44:47], s52 offen offset:1024 sc1 lds
    buffer_load_dwordx4 v34, s[44:47], s52 offen offset:2048 sc1 lds
    buffer_load_dwordx4 v35, s[44:47], s52 offen offset:3072 sc1 lds
    s_waitcnt vmcnt(36)
    v_cmp_lt_u32 vcc, 28, v24
    s_cbranch_vccnz A_lB28_ok
    s_cmp_ge_u32 s54, 36
    s_cbranch_scc1 A_lB28_36
    ds_read_b96 v[24:26], v17 offset:16
    s_waitcnt lgkmcnt(0)
    v_min3_u32 v24, v24, v25, v26
    v_cmp_lt_u32 vcc, 28, v24
    s_cbranch_vccnz A_lB28_ok
    s_waitcnt vmcnt(32)
    s_max_u32 s54, s54, 36
    v_mov_b32 v20, s54
    ds_write_b32 v17, v20
A_lB28_36:
    s_cmp_ge_u32 s54, 37
    s_cbranch_scc1 A_lB28_37
    ds_read_b96 v[24:26], v17 offset:16
    s_waitcnt lgkmcnt(0)
    v_min3_u32 v24, v24, v25, v26
    v_cmp_lt_u32 vcc, 28, v24
    s_cbranch_vccnz A_lB28_ok
    s_waitcnt vmcnt(16)
    s_max_u32 s54, s54, 37
    v_mov_b32 v20, s54
    ds_write_b32 v17, v20
A_lB28_37:
    s_cmp_ge_u32 s54, 38
    s_cbranch_scc1 A_lB28_38
    ds_read_b96 v[24:26], v17 offset:16
    s_waitcnt lgkmcnt(0)
    v_min3_u32 v24, v24, v25, v26
    v_cmp_lt_u32 vcc, 28, v24
    s_cbranch_vccnz A_lB28_ok
    s_waitcnt vmcnt(0)
    s_max_u32 s54, s54, 38
    v_mov_b32 v20, s54
    ds_write_b32 v17, v20
A_lB28_38:
A_lB28:
    s_sub_u32 s57, s57, 1
    s_cbranch_scc1 A_end
    ds_read_b96 v[24:26], v17 offset:16
    s_waitcnt lgkmcnt(0)
    v_min3_u32 v24, v24, v25, v26
    v_cmp_lt_u32 vcc, 28, v24
    s_cbranch_vccz A_lB28
A_lB28_ok:
    s_mov_b32 m0, 139264
    s_add_u32 s55, s53, 2
    s_and_b32 s55, s55, 7
    s_lshl_b32 s55, s55, 17
    s_add_u32 s52, s55, 65536
    buffer_load_dwordx4 v32, s[44:47], s52 offen sc1 lds
    buffer_load_dwordx4 v33, s[44:47], s52 offen offset:1024 sc1 lds
    buffer_load_dwordx4 v34, s[44:47], s52 offen offset:2048 sc1 lds
    buffer_load_dwordx4 v35, s[44:47], s52 offen offset:3072 sc1 lds
    s_waitcnt vmcnt(36)
    s_max_u32 s54, s54, 36
    v_mov_b32 v20, s54
    ds_write_b32 v17, v20
    s_mov_b32 m0, 143360
    s_add_u32 s52, s55, 98304
    buffer_load_dwordx4 v32, s[44:47], s52 offen sc1 lds
    buffer_load_dwordx4 v33, s[44:47], s52 offen offset:1024 sc1 lds
    buffer_load_dwordx4 v34, s[44:47], s52 offen offset:2048 sc1 lds
    buffer_load_dwordx4 v35, s[44:47], s52 offen offset:3072 sc1 lds
    s_waitcnt vmcnt(36)
    s_mov_b32 m0, 147456
    s_add_u32 s55, s53, 3
    s_and_b32 s55, s55, 7
    s_lshl_b32 s55, s55, 17
    s_add_u32 s52, s55, 65536
    buffer_load_dwordx4 v32, s[44:47], s52 offen sc1 lds
    buffer_load_dwordx4 v33, s[44:47], s52 offen offset:1024 sc1 lds
    buffer_load_dwordx4 v34, s[44:47], s52 offen offset:2048 sc1 lds
    buffer_load_dwordx4 v35, s[44:47], s52 offen offset:3072 sc1 lds
    s_waitcnt vmcnt(36)
    s_mov_b32 m0, 151552
    s_add_u32 s52, s55, 98304
    buffer_load_dwordx4 v32, s[44:47], s52 offen sc1 lds
    buffer_load_dwordx4 v33, s[44:47], s52 offen offset:1024 sc1 lds
    buffer_load_dwordx4 v34, s[44:47], s52 offen offset:2048 sc1 lds
    buffer_load_dwordx4 v35, s[44:47], s52 offen offset:3072 sc1 lds
    s_waitcnt vmcnt(36)
    v_cmp_lt_u32 vcc, 29, v24
    s_cbranch_vccnz A_lB29_ok
    s_cmp_ge_u32 s54, 37
    s_cbranch_scc1 A_lB29_37
    ds_read_b96 v[24:26], v17 offset:16
    s_waitcnt lgkmcnt(0)
    v_min3_u32 v24, v24, v25, v26
    v_cmp_lt_u32 vcc, 29, v24
    s_cbranch_vccnz A_lB29_ok
    s_waitcnt vmcnt(32)
    s_max_u32 s54, s54, 37
    v_mov_b32 v20, s54
    ds_write_b32 v17, v20
A_lB29_37:
    s_cmp_ge_u32 s54, 38
    s_cbranch_scc1 A_lB29_38
    ds_read_b96 v[24:26], v17 offset:16
    s_waitcnt lgkmcnt(0)
    v_min3_u32 v24, v24, v25, v26
    v_cmp_lt_u32 vcc, 29, v24
    s_cbranch_vccnz A_lB29_ok
    s_waitcnt vmcnt(16)
    s_max_u32 s54, s54, 38
    v_mov_b32 v20, s54
    ds_write_b32 v17, v20
A_lB29_38:
    s_cmp_ge_u32 s54, 39
    s_cbranch_scc1 A_lB29_39
    ds_read_b96 v[24:26], v17 offset:16
    s_waitcnt lgkmcnt(0)
    v_min3_u32 v24, v24, v25, v26
    v_cmp_lt_u32 vcc, 29, v24
    s_cbranch_vccnz A_lB29_ok
    s_waitcnt vmcnt(0)
    s_max_u32 s54, s54, 39
    v_mov_b32 v20, s54
    ds_write_b32 v17, v20
A_lB29_39:
A_lB29:
    s_sub_u32 s57, s57, 1
    s_cbranch_scc1 A_end
    ds_read_b96 v[24:26], v17 offset:16
    s_waitcnt lgkmcnt(0)
    v_min3_u32 v24, v24, v25, v26
    v_cmp_lt_u32 vcc, 29, v24
    s_cbranch_vccz A_lB29
A_lB29_ok:
    s_mov_b32 m0, 0
    s_add_u32 s55, s53, 4
    s_and_b32 s55, s55, 7
    s_lshl_b32 s55, s55, 17
    s_add_u32 s52, s55, 65536
    buffer_load_dwordx4 v32, s[44:47], s52 offen sc1 lds
    buffer_load_dwordx4 v33, s[44:47], s52 offen offset:1024 sc1 lds
    buffer_load_dwordx4 v34, s[44:47], s52 offen offset:2048 sc1 lds
    buffer_load_dwordx4 v35, s[44:47], s52 offen offset:3072 sc1 lds
    s_waitcnt vmcnt(36)
    v_mov_b32 v21, 1
    ds_write_b32 v17, v21 offset:4
    s_max_u32 s54, s54, 37
    v_mov_b32 v20, s54
    ds_write_b32 v17, v20
    s_mov_b32 m0, 4096
    s_add_u32 s52, s55, 98304
    buffer_load_dwordx4 v32, s[44:47], s52 offen sc1 lds
    buffer_load_dwordx4 v33, s[44:47], s52 offen offset:1024 sc1 lds
    buffer_load_dwordx4 v34, s[44:47], s52 offen offset:2048 sc1 lds
    buffer_load_dwordx4 v35, s[44:47], s52 offen offset:3072 sc1 lds
    s_waitcnt vmcnt(36)
    s_mov_b32 m0, 8192
    s_add_u32 s55, s53, 5
    s_and_b32 s55, s55, 7
    s_lshl_b32 s55, s55, 17
    s_add_u32 s52, s55, 65536
    buffer_load_dwordx4 v32, s[44:47], s52 offen sc1 lds
    buffer_load_dwordx4 v33, s[44:47], s52 offen offset:1024 sc1 lds
    buffer_load_dwordx4 v34, s[44:47], s52 offen offset:2048 sc1 lds
    buffer_load_dwordx4 v35, s[44:47], s52 offen offset:3072 sc1 lds
    s_waitcnt vmcnt(36)
    s_mov_b32 m0, 12288
    s_add_u32 s52, s55, 98304
    buffer_load_dwordx4 v32, s[44:47], s52 offen sc1 lds
    buffer_load_dwordx4 v33, s[44:47], s52 offen offset:1024 sc1 lds
    buffer_load_dwordx4 v34, s[44:47], s52 offen offset:2048 sc1 lds
    buffer_load_dwordx4 v35, s[44:47], s52 offen offset:3072 sc1 lds
    s_waitcnt vmcnt(36)
    v_cmp_lt_u32 vcc, 30, v24
    s_cbranch_vccnz A_lB30_ok
    s_cmp_ge_u32 s54, 38
    s_cbranch_scc1 A_lB30_38
    ds_read_b96 v[24:26], v17 offset:16
    s_waitcnt lgkmcnt(0)
    v_min3_u32 v24, v24, v25, v26
    v_cmp_lt_u32 vcc, 30, v24
    s_cbranch_vccnz A_lB30_ok
    s_waitcnt vmcnt(32)
    s_max_u32 s54, s54, 38
    v_mov_b32 v20, s54
    ds_write_b32 v17, v20
A_lB30_38:
    s_cmp_ge_u32 s54, 39
    s_cbranch_scc1 A_lB30_39
    ds_read_b96 v[24:26], v17 offset:16
    s_waitcnt lgkmcnt(0)
    v_min3_u32 v24, v24, v25, v26
    v_cmp_lt_u32 vcc, 30, v24
    s_cbranch_vccnz A_lB30_ok
    s_waitcnt vmcnt(16)
    s_max_u32 s54, s54, 39
    v_mov_b32 v20, s54
    ds_write_b32 v17, v20
A_lB30_39:
    s_cmp_ge_u32 s54, 40
    s_cbranch_scc1 A_lB30_40
    ds_read_b96 v[24:26], v17 offset:16
    s_waitcnt lgkmcnt(0)
    v_min3_u32 v24, v24, v25, v26
    v_cmp_lt_u32 vcc, 30, v24
    s_cbranch_vccnz A_lB30_ok
    s_waitcnt vmcnt(0)
    s_max_u32 s54, s54, 40
    v_mov_b32 v20, s54
    ds_write_b32 v17, v20
A_lB30_40:
A_lB30:
    s_sub_u32 s57, s57, 1
    s_cbranch_scc1 A_end
    ds_read_b96 v[24:26], v17 offset:16
    s_waitcnt lgkmcnt(0)
    v_min3_u32 v24, v24, v25, v26
    v_cmp_lt_u32 vcc, 30, v24
    s_cbranch_vccz A_lB30
A_lB30_ok:
    s_mov_b32 m0, 16384
    s_add_u32 s55, s53, 6
    s_and_b32 s55, s55, 7
    s_lshl_b32 s55, s55, 17
    s_add_u32 s52, s55, 65536
    buffer_load_dwordx4 v32, s[44:47], s52 offen sc1 lds
    buffer_load_dwordx4 v33, s[44:47], s52 offen offset:1024 sc1 lds
    buffer_load_dwordx4 v34, s[44:47], s52 offen offset:2048 sc1 lds
    buffer_load_dwordx4 v35, s[44:47], s52 offen offset:3072 sc1 lds
    s_waitcnt vmcnt(36)
    s_max_u32 s54, s54, 38
    v_mov_b32 v20, s54
    ds_write_b32 v17, v20
    s_mov_b32 m0, 20480
    s_add_u32 s52, s55, 98304
    buffer_load_dwordx4 v32, s[44:47], s52 offen sc1 lds
    buffer_load_dwordx4 v33, s[44:47], s52 offen offset:1024 sc1 lds
    buffer_load_dwordx4 v34, s[44:47], s52 offen offset:2048 sc1 lds
    buffer_load_dwordx4 v35, s[44:47], s52 offen offset:3072 sc1 lds
    s_waitcnt vmcnt(36)
    s_mov_b32 m0, 24576
    s_add_u32 s55, s53, 7
    s_and_b32 s55, s55, 7
    s_lshl_b32 s55, s55, 17
    s_add_u32 s52, s55, 65536
    buffer_load_dwordx4 v32, s[44:47], s52 offen sc1 lds
    buffer_load_dwordx4 v33, s[44:47], s52 offen offset:1024 sc1 lds
    buffer_load_dwordx4 v34, s[44:47], s52 offen offset:2048 sc1 lds
    buffer_load_dwordx4 v35, s[44:47], s52 offen offset:3072 sc1 lds
    s_waitcnt vmcnt(36)
    s_mov_b32 m0, 28672
    s_add_u32 s52, s55, 98304
    buffer_load_dwordx4 v32, s[44:47], s52 offen sc1 lds
    buffer_load_dwordx4 v33, s[44:47], s52 offen offset:1024 sc1 lds
    buffer_load_dwordx4 v34, s[44:47], s52 offen offset:2048 sc1 lds
    buffer_load_dwordx4 v35, s[44:47], s52 offen offset:3072 sc1 lds
    s_waitcnt vmcnt(32)
    s_max_u32 s54, s54, 39
    v_mov_b32 v20, s54
    ds_write_b32 v17, v20
    s_waitcnt vmcnt(16)
    s_max_u32 s54, s54, 40
    v_mov_b32 v20, s54
    ds_write_b32 v17, v20
    s_waitcnt vmcnt(0)
    s_max_u32 s54, s54, 41
    v_mov_b32 v20, s54
    ds_write_b32 v17, v20
    s_endpgm
A_raise:
    s_nop 15
    s_nop 7
    v_mov_b32 v25, v24
    v_mov_b32 v27, v24
    s_nop 1
    v_permlane32_swap_b32 v25, v27
    v_max_f32 v25, v25, v27
    v_add_f32 v25, 0x41800000, v25
    v_ceil_f32 v25, v25
    v_max_f32 v25, 0, v25
    s_mov_b64 s[22:23], 0
    v_sub_f32 v32, v32, v25
    v_sub_f32 v33, v33, v25
    v_sub_f32 v34, v34, v25
    v_sub_f32 v35, v35, v25
    v_sub_f32 v36, v36, v25
    v_sub_f32 v37, v37, v25
    v_sub_f32 v38, v38, v25
    v_sub_f32 v39, v39, v25
    v_sub_f32 v40, v40, v25
    v_sub_f32 v41, v41, v25
    v_sub_f32 v42, v42, v25
    v_sub_f32 v43, v43, v25
    v_sub_f32 v44, v44, v25
    v_sub_f32 v45, v45, v25
    v_sub_f32 v46, v46, v25
    v_sub_f32 v47, v47, v25
    v_sub_f32 v48, v48, v25
    v_sub_f32 v49, v49, v25
    v_sub_f32 v50, v50, v25
    v_sub_f32 v51, v51, v25
    v_sub_f32 v52, v52, v25
    v_sub_f32 v53, v53, v25
    v_sub_f32 v54, v54, v25
    v_sub_f32 v55, v55, v25
    v_sub_f32 v56, v56, v25
    v_sub_f32 v57, v57, v25
    v_sub_f32 v58, v58, v25
    v_sub_f32 v59, v59, v25
    v_sub_f32 v60, v60, v25
    v_sub_f32 v61, v61, v25
    v_sub_f32 v62, v62, v25
    v_sub_f32 v63, v63, v25
    v_sub_f32 v64, v64, v25
    v_sub_f32 v65, v65, v25
    v_sub_f32 v66, v66, v25
    v_sub_f32 v67, v67, v25
    v_sub_f32 v68, v68, v25
    v_sub_f32 v69, v69, v25
    v_sub_f32 v70, v70, v25
    v_sub_f32 v71, v71, v25
    v_sub_f32 v72, v72, v25
    v_sub_f32 v73, v73, v25
    v_sub_f32 v74, v74, v25
    v_sub_f32 v75, v75, v25
    v_sub_f32 v76, v76, v25
    v_sub_f32 v77, v77, v25
    v_sub_f32 v78, v78, v25
    v_sub_f32 v79, v79, v25
    v_sub_f32 v80, v80, v25
    v_sub_f32 v81, v81, v25
    v_sub_f32 v82, v82, v25
    v_sub_f32 v83, v83, v25
    v_sub_f32 v84, v84, v25
    v_sub_f32 v85, v85, v25
    v_sub_f32 v86, v86, v25
    v_sub_f32 v87, v87, v25
    v_sub_f32 v88, v88, v25
    v_sub_f32 v89, v89, v25
    v_sub_f32 v90, v90, v25
    v_sub_f32 v91, v91, v25
    v_sub_f32 v92, v92, v25
    v_sub_f32 v93, v93, v25
    v_sub_f32 v94, v94, v25
    v_sub_f32 v95, v95, v25
    v_sub_f32 v192, v192, v25
    v_sub_f32 v193, v193, v25
    v_sub_f32 v194, v194, v25
    v_sub_f32 v195, v195, v25
    v_sub_f32 v196, v196, v25
    v_sub_f32 v197, v197, v25
    v_sub_f32 v198, v198, v25
    v_sub_f32 v199, v199, v25
    v_sub_f32 v200, v200, v25
    v_sub_f32 v201, v201, v25
    v_sub_f32 v202, v202, v25
    v_sub_f32 v203, v203, v25
    v_sub_f32 v204, v204, v25
    v_sub_f32 v205, v205, v25
    v_sub_f32 v206, v206, v25
    v_sub_f32 v207, v207, v25
    v_sub_f32 v208, v208, v25
    v_sub_f32 v209, v209, v25
    v_sub_f32 v210, v210, v25
    v_sub_f32 v211, v211, v25
    v_sub_f32 v212, v212, v25
    v_sub_f32 v213, v213, v25
    v_sub_f32 v214, v214, v25
    v_sub_f32 v215, v215, v25
    v_sub_f32 v216, v216, v25
    v_sub_f32 v217, v217, v25
    v_sub_f32 v218, v218, v25
    v_sub_f32 v219, v219, v25
    v_sub_f32 v220, v220, v25
    v_sub_f32 v221, v221, v25
    v_sub_f32 v222, v222, v25
    v_sub_f32 v223, v223, v25
    v_sub_f32 v224, v224, v25
    v_sub_f32 v225, v225, v25
    v_sub_f32 v226, v226, v25
    v_sub_f32 v227, v227, v25
    v_sub_f32 v228, v228, v25
    v_sub_f32 v229, v229, v25
    v_sub_f32 v230, v230, v25
    v_sub_f32 v231, v231, v25
    v_sub_f32 v232, v232, v25
    v_sub_f32 v233, v233, v25
    v_sub_f32 v234, v234, v25
    v_sub_f32 v235, v235, v25
    v_sub_f32 v236, v236, v25
    v_sub_f32 v237, v237, v25
    v_sub_f32 v238, v238, v25
    v_sub_f32 v239, v239, v25
    v_sub_f32 v240, v240, v25
    v_sub_f32 v241, v241, v25
    v_sub_f32 v242, v242, v25
    v_sub_f32 v243, v243, v25
    v_sub_f32 v244, v244, v25
    v_sub_f32 v245, v245, v25
    v_sub_f32 v246, v246, v25
    v_sub_f32 v247, v247, v25
    v_sub_f32 v248, v248, v25
    v_sub_f32 v249, v249, v25
    v_sub_f32 v250, v250, v25
    v_sub_f32 v251, v251, v25
    v_sub_f32 v252, v252, v25
    v_sub_f32 v253, v253, v25
    v_sub_f32 v254, v254, v25
    v_sub_f32 v255, v255, v25
    v_cvt_u32_f32 v25, v25
    v_min_u32 v25, 255, v25
    v_mul_u32_u24 v25, 0x800080, v25
    v_pk_sub_u16 v96, v96, v25 clamp
    v_pk_sub_u16 v97, v97, v25 clamp
    v_pk_sub_u16 v98, v98, v25 clamp
    v_pk_sub_u16 v99, v99, v25 clamp
    v_pk_sub_u16 v100, v100, v25 clamp
    v_pk_sub_u16 v101, v101, v25 clamp
    v_pk_sub_u16 v102, v102, v25 clamp
    v_pk_sub_u16 v103, v103, v25 clamp
    v_pk_sub_u16 v104, v104, v25 clamp
    v_pk_sub_u16 v105, v105, v25 clamp
    v_pk_sub_u16 v106, v106, v25 clamp
    v_pk_sub_u16 v107, v107, v25 clamp
    v_pk_sub_u16 v108, v108, v25 clamp
    v_pk_sub_u16 v109, v109, v25 clamp
    v_pk_sub_u16 v110, v110, v25 clamp
    v_pk_sub_u16 v111, v111, v25 clamp
    v_pk_sub_u16 v112, v112, v25 clamp
    v_pk_sub_u16 v113, v113, v25 clamp
    v_pk_sub_u16 v114, v114, v25 clamp
    v_pk_sub_u16 v115, v115, v25 clamp
    v_pk_sub_u16 v116, v116, v25 clamp
    v_pk_sub_u16 v117, v117, v25 clamp
    v_pk_sub_u16 v118, v118, v25 clamp
    v_pk_sub_u16 v119, v119, v25 clamp
    v_pk_sub_u16 v120, v120, v25 clamp
    v_pk_sub_u16 v121, v121, v25 clamp
    v_pk_sub_u16 v122, v122, v25 clamp
    v_pk_sub_u16 v123, v123, v25 clamp
    v_pk_sub_u16 v124, v124, v25 clamp
    v_pk_sub_u16 v125, v125, v25 clamp
    v_pk_sub_u16 v126, v126, v25 clamp
    v_pk_sub_u16 v127, v127, v25 clamp
    v_pk_sub_u16 v128, v128, v25 clamp
    v_pk_sub_u16 v129, v129, v25 clamp
    v_pk_sub_u16 v130, v130, v25 clamp
    v_pk_sub_u16 v131, v131, v25 clamp
    v_pk_sub_u16 v132, v132, v25 clamp
    v_pk_sub_u16 v133, v133, v25 clamp
    v_pk_sub_u16 v134, v134, v25 clamp
    v_pk_sub_u16 v135, v135, v25 clamp
    v_pk_sub_u16 v136, v136, v25 clamp
    v_pk_sub_u16 v137, v137, v25 clamp
    v_pk_sub_u16 v138, v138, v25 clamp
    v_pk_sub_u16 v139, v139, v25 clamp
    v_pk_sub_u16 v140, v140, v25 clamp
    v_pk_sub_u16 v141, v141, v25 clamp
    v_pk_sub_u16 v142, v142, v25 clamp
    v_pk_sub_u16 v143, v143, v25 clamp
    v_pk_sub_u16 v144, v144, v25 clamp
    v_pk_sub_u16 v145, v145, v25 clamp
    v_pk_sub_u16 v146, v146, v25 clamp
    v_pk_sub_u16 v147, v147, v25 clamp
    v_pk_sub_u16 v148, v148, v25 clamp
    v_pk_sub_u16 v149, v149, v25 clamp
    v_pk_sub_u16 v150, v150, v25 clamp
    v_pk_sub_u16 v151, v151, v25 clamp
    v_pk_sub_u16 v152, v152, v25 clamp
    v_pk_sub_u16 v153, v153, v25 clamp
    v_pk_sub_u16 v154, v154, v25 clamp
    v_pk_sub_u16 v155, v155, v25 clamp
    v_pk_sub_u16 v156, v156, v25 clamp
    v_pk_sub_u16 v157, v157, v25 clamp
    v_pk_sub_u16 v158, v158, v25 clamp
    v_pk_sub_u16 v159, v159, v25 clamp
    v_pk_sub_u16 v160, v160, v25 clamp
    v_pk_sub_u16 v161, v161, v25 clamp
    v_pk_sub_u16 v162, v162, v25 clamp
    v_pk_sub_u16 v163, v163, v25 clamp
    v_pk_sub_u16 v164, v164, v25 clamp
    v_pk_sub_u16 v165, v165, v25 clamp
    v_pk_sub_u16 v166, v166, v25 clamp
    v_pk_sub_u16 v167, v167, v25 clamp
    v_pk_sub_u16 v168, v168, v25 clamp
    v_pk_sub_u16 v169, v169, v25 clamp
    v_pk_sub_u16 v170, v170, v25 clamp
    v_pk_sub_u16 v171, v171, v25 clamp
    v_pk_sub_u16 v172, v172, v25 clamp
    v_pk_sub_u16 v173, v173, v25 clamp
    v_pk_sub_u16 v174, v174, v25 clamp
    v_pk_sub_u16 v175, v175, v25 clamp
    v_pk_sub_u16 v176, v176, v25 clamp
    v_pk_sub_u16 v177, v177, v25 clamp
    v_pk_sub_u16 v178, v178, v25 clamp
    v_pk_sub_u16 v179, v179, v25 clamp
    v_pk_sub_u16 v180, v180, v25 clamp
    v_pk_sub_u16 v181, v181, v25 clamp
    v_pk_sub_u16 v182, v182, v25 clamp
    v_pk_sub_u16 v183, v183, v25 clamp
    v_pk_sub_u16 v184, v184, v25 clamp
    v_pk_sub_u16 v185, v185, v25 clamp
    v_pk_sub_u16 v186, v186, v25 clamp
    v_pk_sub_u16 v187, v187, v25 clamp
    v_pk_sub_u16 v188, v188, v25 clamp
    v_pk_sub_u16 v189, v189, v25 clamp
    v_pk_sub_u16 v190, v190, v25 clamp
    v_pk_sub_u16 v191, v191, v25 clamp
    s_nop 1
    s_setpc_b64 s[44:45]
A_selslow1:
    s_cmp_lg_u32 s12, 0
    s_cbranch_scc1 A_selslow
    s_waitcnt vmcnt(0)
    s_mov_b64 exec, 1
    buffer_store_dword v8, v5, s[24:27], 0 offen offset:32
    buffer_store_dword v8, v5, s[24:27], 0 offen offset:160 sc1
    s_mov_b64 exec, -1
    s_mov_b32 s12, 1
A_selslow:
    s_add_u32 s58, s58, 1
    s_and_b32 s23, s58, 15
    s_cselect_b32 s23, 0, 128
    buffer_load_dword v25, v4, s[24:27], s23 offen sc1
    s_sub_u32 s57, s57, 1
    s_cbranch_scc1 A_end
    s_waitcnt vmcnt(0)
    v_cmp_eq_u32 s[22:23], s56, v25
    s_nop 0
    s_or_b32 s53, s53, s22
    s_setpc_b64 s[44:45]
A_spin:
    s_sub_u32 s57, s57, 1
    s_cbranch_scc1 A_end
    ds_read_b32 v21, v22
    s_waitcnt lgkmcnt(0)
    v_cmp_ge_u32 vcc, s59, v21
    s_cbranch_vccnz A_spin
    s_setpc_b64 s[44:45]
A_compute:
    s_sub_u32 s3, s3, 1
    v_mov_b32 v22, 163584
    s_lshl_b32 s22, s3, 2
    s_add_u32 s22, s22, 163600
    v_mov_b32 v23, s22
    v_mov_b32 v26, 0
    ds_write_b32 v23, v26
    s_waitcnt lgkmcnt(0)
    s_mul_i32 s22, s21, 3
    s_add_u32 s22, s22, s3
    s_lshl_b32 s22, s22, 7
    s_add_u32 s22, s22, 17301504
    s_add_u32 s32, s18, s22
    s_addc_u32 s33, s19, 0
    global_load_dword v27, v26, s[32:33] sc1
    v_and_b32 v30, 31, v0
    v_lshrrev_b32 v31, 5, v0
    v_bfe_u32 v28, v30, 1, 3
    v_xor_b32 v28, v28, v31
    v_lshlrev_b32 v28, 4, v28
    v_lshl_add_u32 v28, v30, 7, v28
    s_lshl_b32 s22, s3, 12
    v_add_u32 v1, s22, v28
    v_xor_b32 v2, 32, v1
    v_xor_b32 v3, 64, v1
    v_xor_b32 v4, 96, v1
    v_and_b32 v28, 15, v30
    v_xor_b32 v28, v28, v31
    v_lshlrev_b32 v28, 4, v28
    v_lshl_add_u32 v28, v30, 8, v28
    v_add_u32 v9, 90112, v28
    v_xor_b32 v10, 32, v9
    v_xor_b32 v11, 64, v9
    v_xor_b32 v12, 96, v9
    v_xor_b32 v13, 128, v9
    v_xor_b32 v14, 160, v9
    v_xor_b32 v15, 192, v9
    v_xor_b32 v16, 224, v9
    v_lshrrev_b32 v28, 5, v0
    v_bfe_u32 v29, v0, 2, 2
    v_lshl_add_u32 v28, v28, 3, v29
    v_lshlrev_b32 v28, 8, v28
    v_lshl_add_u32 v28, v29, 6, v28
    v_bfe_u32 v29, v0, 4, 1
    v_lshl_add_u32 v28, v29, 5, v28
    v_and_b32 v29, 1, v0
    v_lshl_add_u32 v28, v29, 4, v28
    v_bfe_u32 v29, v0, 1, 1
    v_lshl_add_u32 v5, v29, 3, v28
    v_add_u32 v5, 24576, v5
    v_xor_b32 v6, 64, v5
    v_xor_b32 v7, 128, v5
    v_xor_b32 v8, 192, v5
    v_lshrrev_b32 v28, 5, v0
    v_bfe_u32 v29, v0, 2, 2
    v_lshl_add_u32 v28, v28, 2, v29
    v_lshlrev_b32 v28, 7, v28
    v_bfe_u32 v29, v0, 3, 1
    v_lshl_add_u32 v28, v29, 6, v28
    v_bfe_u32 v29, v0, 4, 1
    v_lshl_add_u32 v28, v29, 5, v28
    v_and_b32 v29, 1, v0
    v_lshl_add_u32 v28, v29, 4, v28
    v_bfe_u32 v29, v0, 1, 1
    v_lshl_add_u32 v17, v29, 3, v28
    v_add_u32 v17, 65536, v17
    v_xor_b32 v18, 64, v17
    v_lshrrev_b32 v28, 2, v0
    v_xor_b32 v28, v28, v0
    v_bfe_u32 v28, v28, 2, 1
    v_sub_u32 v28, 1, v28
    v_mul_u32_u24 v28, 0x3f80, v28
    v_lshl_or_b32 v28, v28, 16, v28
    v_accvgpr_write_b32 a128, v28
    v_accvgpr_write_b32 a129, v28
    v_accvgpr_write_b32 a130, v28
    v_accvgpr_write_b32 a131, v28
    s_mov_b32 s46, 0x3e0293ee
    s_mov_b32 s47, 0x3e0293ee
    v_lshlrev_b32 v28, 4, v0
    v_accvgpr_write_b32 a132, v28
    v_lshrrev_b32 v28, 5, v0
    v_bfe_u32 v29, v0, 2, 2
    v_lshl_add_u32 v28, v28, 3, v29
    v_lshlrev_b32 v28, 7, v28
    v_bfe_u32 v29, v0, 3, 1
    v_lshl_add_u32 v28, v29, 6, v28
    v_bfe_u32 v29, v0, 4, 1
    v_lshl_add_u32 v28, v29, 5, v28
    v_and_b32 v29, 1, v0
    v_lshl_add_u32 v28, v29, 4, v28
    v_bfe_u32 v29, v0, 1, 1
    v_lshl_add_u32 v28, v29, 3, v28
    v_accvgpr_write_b32 a133, v28
    v_xor_b32 v28, 64, v28
    v_accvgpr_write_b32 a134, v28
    v_add_u32 v28, s20, v0
    v_and_b32 v28, 7, v28
    v_and_b32 v29, 8, v0
    v_or_b32 v28, v28, v29
    v_lshlrev_b32 v28, 2, v28
    v_accvgpr_write_b32 a135, v28
    s_and_b32 s34, s20, 7
    s_lshl_b32 s22, s34, 2
    v_mov_b32 v28, s22
    v_accvgpr_write_b32 a136, v28
    v_bfe_u32 v28, v0, 3, 2
    v_mul_u32_u24 v28, 24576, v28
    v_lshl_add_u32 v28, v31, 7, v28
    v_and_b32 v29, 7, v0
    v_lshl_add_u32 v28, v29, 4, v28
    v_accvgpr_write_b32 a137, v28
    v_and_b32 v28, 0xff, v28
    s_lshl_b32 s22, s3, 11
    s_add_u32 s22, s22, 81920
    v_add_u32 v28, s22, v28
    v_accvgpr_write_b32 a139, v28
    v_lshl_add_u32 v28, v0, 4, s22
    v_accvgpr_write_b32 a140, v28
    s_lshr_b32 s23, s20, 3
    v_and_b32 v28, 3, v0
    v_min_u32 v28, 2, v28
    v_add3_u32 v28, v28, s23, 1
    v_and_b32 v28, 3, v28
    v_mul_u32_u24 v28, 6144, v28
    v_accvgpr_write_b32 a141, v28
    s_lshl_b32 s22, s23, 3
    s_lshl_b32 s13, 0xff, s22
    v_lshlrev_b32 v28, 10, v29
    v_lshl_add_u32 v28, v31, 5, v28
    v_bfe_u32 v29, v0, 3, 1
    v_lshl_add_u32 v28, v29, 4, v28
    v_bfe_u32 v29, v0, 4, 1
    v_lshl_add_u32 v28, v29, 3, v28
    v_accvgpr_write_b32 a138, v28
    s_and_b32 s23, s20, 24
    s_lshl_b32 s22, s21, 5
    s_add_u32 s22, s22, s23
    s_mul_i32 s22, s22, 24576
    s_lshl_b32 s23, s3, 13
    s_add_u32 s22, s22, s23
    s_add_u32 s40, s18, s22
    s_addc_u32 s41, s19, 0
    s_mov_b32 s42, 196608
    s_mov_b32 s43, 0x20000
    s_add_u32 s22, s22, 4096
    s_add_u32 s4, s18, s22
    s_addc_u32 s5, s19, 0
    s_mov_b32 s6, 196608
    s_mov_b32 s7, 0x20000
    s_lshl_b32 s22, s21, 2
    s_lshr_b32 s23, s20, 3
    s_add_u32 s22, s22, s23
    s_mul_i32 s22, s22, 3
    s_add_u32 s22, s22, s3
    s_lshl_b32 s22, s22, 8
    s_add_u32 s22, s22, 16777216
    s_add_u32 s24, s18, s22
    s_addc_u32 s25, s19, 0
    s_mov_b32 s26, 256
    s_mov_b32 s27, 0x20000
    s_mul_i32 s36, s23, 6144
    s_mul_i32 s37, s23, 24576
    s_add_u32 s22, s23, 1
    s_and_b32 s22, s22, 3
    s_mul_i32 s22, s22, 6144
    s_add_u32 s17, s22, s37
    s_add_u32 s22, s23, 2
    s_and_b32 s22, s22, 3
    s_mul_i32 s22, s22, 6144
    s_add_u32 s100, s22, s37
    s_add_u32 s22, s23, 3
    s_and_b32 s22, s22, 3
    s_mul_i32 s22, s22, 6144
    s_add_u32 s101, s22, s37
    s_lshl_b32 s22, s21, 3
    s_add_u32 s22, s22, s34
    s_mul_i32 s22, s22, 98304
    s_lshl_b32 s23, s3, 11
    s_add_u32 s22, s22, s23
    s_add_u32 s22, s22, 8388608
    s_add_u32 s28, s18, s22
    s_addc_u32 s29, s19, 0
    s_mov_b32 s30, 98304
    s_mov_b32 s31, 0x20000
    s_mul_i32 s22, s21, 96
    s_lshl_b32 s23, s3, 5
    s_add_u32 s22, s22, s23
    s_and_b32 s23, s20, 24
    s_add_u32 s22, s22, s23
    s_lshl_b32 s22, s22, 10
    s_lshl_b32 s23, s34, 7
    s_add_u32 s38, s22, s23
    s_mov_b32 s48, s14
    s_mov_b32 s49, s15
    s_mov_b32 s50, 786432
    s_mov_b32 s51, 0x20000
    s_mul_i32 s52, s34, 24576
    s_add_u32 s35, s52, 4096
    s_xor_b32 s22, s21, s20
    s_bitcmp1_b32 s22, 0
    s_mov_b32 s84, 0xc084844
    s_cmov_b32 s84, 0x24201c18
    s_mov_b32 s85, 0x302c1c18
    s_cmov_b32 s85, 0x3834302c
    s_mov_b32 s86, 0x400403c
    s_cmov_b32 s86, 0x4844403c
    s_mov_b32 s87, 0x24201410
    s_cmov_b32 s87, 0xc080400
    s_mov_b32 s89, 0x6000
    s_mov_b32 s90, 0x4000
    s_mov_b32 s91, 0x4000
    s_mov_b32 s92, 0xfffe2000
    s_cmov_b32 s92, 0x4000
    s_mov_b32 s93, 0x8000
    s_cmov_b32 s93, 0xfffde000
    s_mov_b32 s94, 0x8000
    s_cmov_b32 s94, 0x4000
    s_mov_b32 s95, 0xa000
    s_cmov_b32 s95, 0x4000
    s_and_b32 s16, s21, 0
    s_cselect_b32 s22, s85, s84
    s_cselect_b32 s85, s84, s85
    s_mov_b32 s84, s22
    s_cselect_b32 s22, s87, s86
    s_cselect_b32 s87, s86, s87
    s_mov_b32 s86, s22
    s_and_b32 s22, s84, 255
    s_lshl_b32 s96, s22, 11
    s_and_b32 s22, s86, 255
    s_lshl_b32 s97, s22, 11
    v_add_u32 v28, s20, v0
    v_and_b32 v28, 7, v28
    v_mul_u32_u24 v19, 24576, v28
    v_bfe_u32 v29, v0, 2, 2
    v_mov_b32 v20, s84
    v_mov_b32 v28, s85
    v_cmp_eq_u32 vcc, 1, v29
    s_nop 1
    v_cndmask_b32 v20, v20, v28, vcc
    v_mov_b32 v28, s86
    v_cmp_eq_u32 vcc, 2, v29
    s_nop 1
    v_cndmask_b32 v20, v20, v28, vcc
    v_mov_b32 v28, s87
    v_cmp_eq_u32 vcc, 3, v29
    s_nop 1
    v_cndmask_b32 v20, v20, v28, vcc
    v_and_b32 v28, 3, v0
    v_lshlrev_b32 v28, 3, v28
    v_lshrrev_b32 v20, v28, v20
    v_and_b32 v20, 255, v20
    v_lshlrev_b32 v20, 11, v20
    s_mov_b32 s84, s32
    s_mov_b32 s85, s33
    s_mov_b32 s86, 0
    s_mov_b32 s87, 0x20000
    s_cmp_eq_u32 s20, 0
    s_cselect_b32 s86, 4, 0
    s_mov_b32 s55, s34
    s_mov_b32 s54, 0xffffff01
    s_mov_b32 s53, 0
    s_mov_b32 s12, 0
    s_mov_b32 s58, 0
    s_barrier
    ds_read_b32 v21, v22
    s_waitcnt lgkmcnt(0)
    s_movk_i32 s59, 0
    v_cmp_ge_u32 vcc, s59, v21
    s_getpc_b64 s[44:45]
    s_cbranch_vccnz A_spin
    ds_read_b128 a[0:3], v1 offset:0
    ds_read_b64_tr_b16 a[12:13], v5 offset:57344
    ds_read_b64_tr_b16 a[14:15], v5 offset:58368
    ds_read_b64_tr_b16 a[16:17], v6 offset:57344
    ds_read_b64_tr_b16 a[18:19], v6 offset:58368
    ds_read_b64_tr_b16 a[20:21], v7 offset:57344
    ds_read_b64_tr_b16 a[22:23], v7 offset:58368
    ds_read_b64_tr_b16 a[24:25], v8 offset:57344
    ds_read_b64_tr_b16 a[26:27], v8 offset:58368
    s_waitcnt lgkmcnt(4)
    v_mfma_f32_32x32x16_bf16 v[32:47], a[12:15], a[0:3], 0
    ds_read_b128 a[4:7], v2 offset:0
    ds_read_b64_tr_b16 a[28:29], v5 offset:61440
    ds_read_b64_tr_b16 a[30:31], v5 offset:62464
    v_mfma_f32_32x32x16_bf16 v[48:63], a[16:19], a[0:3], 0
    ds_read_b32 v21, v22
    ds_read_b64_tr_b16 a[32:33], v6 offset:61440
    ds_read_b64_tr_b16 a[34:35], v6 offset:62464
    s_waitcnt lgkmcnt(6)
    v_mfma_f32_32x32x16_bf16 v[64:79], a[20:23], a[0:3], 0
    ds_read_b64_tr_b16 a[36:37], v7 offset:61440
    ds_read_b64_tr_b16 a[38:39], v7 offset:62464
    v_mfma_f32_32x32x16_bf16 v[80:95], a[24:27], a[0:3], 0
    s_waitcnt lgkmcnt(4)
    s_movk_i32 s59, 1
    v_cmp_ge_u32 vcc, s59, v21
    ds_read_b64_tr_b16 a[40:41], v8 offset:61440
    ds_read_b64_tr_b16 a[42:43], v8 offset:62464
    s_waitcnt lgkmcnt(4)
    v_mfma_f32_32x32x16_bf16 v[32:47], a[28:31], a[4:7], v[32:47]
    s_getpc_b64 s[44:45]
    s_cbranch_vccnz A_spin
    ds_read_b128 a[8:11], v3 offset:0
    ds_read_b64_tr_b16 a[44:45], v5 offset:0
    ds_read_b64_tr_b16 a[46:47], v5 offset:1024
    v_mfma_f32_32x32x16_bf16 v[48:63], a[32:35], a[4:7], v[48:63]
    ds_read_b64_tr_b16 a[48:49], v6 offset:0
    ds_read_b64_tr_b16 a[50:51], v6 offset:1024
    s_waitcnt lgkmcnt(5)
    v_mfma_f32_32x32x16_bf16 v[64:79], a[36:39], a[4:7], v[64:79]
    ds_read_b64_tr_b16 a[52:53], v7 offset:0
    ds_read_b64_tr_b16 a[54:55], v7 offset:1024
    v_mfma_f32_32x32x16_bf16 v[80:95], a[40:43], a[4:7], v[80:95]
    v_mov_b32 v26, 1
    ds_write_b32 v23, v26
    ds_read_b64_tr_b16 a[56:57], v8 offset:0
    ds_read_b64_tr_b16 a[58:59], v8 offset:1024
    s_waitcnt lgkmcnt(5)
    v_mfma_f32_32x32x16_bf16 v[32:47], a[44:47], a[8:11], v[32:47]
    ds_read_b128 a[0:3], v4 offset:0
    ds_read_b64_tr_b16 a[12:13], v5 offset:4096
    ds_read_b64_tr_b16 a[14:15], v5 offset:5120
    v_mfma_f32_32x32x16_bf16 v[48:63], a[48:51], a[8:11], v[48:63]
    ds_read_b32 v21, v22
    ds_read_b64_tr_b16 a[16:17], v6 offset:4096
    ds_read_b64_tr_b16 a[18:19], v6 offset:5120
    s_waitcnt lgkmcnt(6)
    v_mfma_f32_32x32x16_bf16 v[64:79], a[52:55], a[8:11], v[64:79]
    ds_read_b64_tr_b16 a[20:21], v7 offset:4096
    ds_read_b64_tr_b16 a[22:23], v7 offset:5120
    v_mfma_f32_32x32x16_bf16 v[80:95], a[56:59], a[8:11], v[80:95]
    s_waitcnt lgkmcnt(4)
    s_movk_i32 s59, 2
    v_cmp_ge_u32 vcc, s59, v21
    ds_read_b64_tr_b16 a[24:25], v8 offset:4096
    ds_read_b64_tr_b16 a[26:27], v8 offset:5120
    s_waitcnt lgkmcnt(4)
    v_mfma_f32_32x32x16_bf16 v[32:47], a[12:15], a[0:3], v[32:47]
    s_getpc_b64 s[44:45]
    s_cbranch_vccnz A_spin
    ds_read_b128 a[4:7], v1 offset:12288
    ds_read_b64_tr_b16 a[28:29], v5 offset:8192
    ds_read_b64_tr_b16 a[30:31], v5 offset:9216
    v_mfma_f32_32x32x16_bf16 v[48:63], a[16:19], a[0:3], v[48:63]
    ds_read_b64_tr_b16 a[32:33], v6 offset:8192
    ds_read_b64_tr_b16 a[34:35], v6 offset:9216
    s_waitcnt lgkmcnt(5)
    v_mfma_f32_32x32x16_bf16 v[64:79], a[20:23], a[0:3], v[64:79]
    ds_read_b64_tr_b16 a[36:37], v7 offset:8192
    ds_read_b64_tr_b16 a[38:39], v7 offset:9216
    v_mfma_f32_32x32x16_bf16 v[80:95], a[24:27], a[0:3], v[80:95]
    v_mov_b32 v26, 2
    ds_write_b32 v23, v26
    ds_read_b64_tr_b16 a[40:41], v8 offset:8192
    ds_read_b64_tr_b16 a[42:43], v8 offset:9216
    s_waitcnt lgkmcnt(5)
    v_mfma_f32_32x32x16_bf16 v[32:47], a[28:31], a[4:7], v[32:47]
    ds_read_b128 a[8:11], v2 offset:12288
    ds_read_b64_tr_b16 a[44:45], v5 offset:12288
    ds_read_b64_tr_b16 a[46:47], v5 offset:13312
    v_mfma_f32_32x32x16_bf16 v[48:63], a[32:35], a[4:7], v[48:63]
    ds_read_b32 v21, v22
    ds_read_b64_tr_b16 a[48:49], v6 offset:12288
    ds_read_b64_tr_b16 a[50:51], v6 offset:13312
    s_waitcnt lgkmcnt(6)
    v_mfma_f32_32x32x16_bf16 v[64:79], a[36:39], a[4:7], v[64:79]
    ds_read_b64_tr_b16 a[52:53], v7 offset:12288
    ds_read_b64_tr_b16 a[54:55], v7 offset:13312
    v_mfma_f32_32x32x16_bf16 v[80:95], a[40:43], a[4:7], v[80:95]
    s_waitcnt lgkmcnt(4)
    s_movk_i32 s59, 3
    v_cmp_ge_u32 vcc, s59, v21
    ds_read_b64_tr_b16 a[56:57], v8 offset:12288
    ds_read_b64_tr_b16 a[58:59], v8 offset:13312
    s_waitcnt lgkmcnt(4)
    v_mfma_f32_32x32x16_bf16 v[32:47], a[44:47], a[8:11], v[32:47]
    s_getpc_b64 s[44:45]
    s_cbranch_vccnz A_spin
    ds_read_b128 a[0:3], v3 offset:12288
    ds_read_b64_tr_b16 a[12:13], v5 offset:28672
    ds_read_b64_tr_b16 a[14:15], v5 offset:29696
    v_mfma_f32_32x32x16_bf16 v[48:63], a[48:51], a[8:11], v[48:63]
    ds_read_b64_tr_b16 a[16:17], v6 offset:28672
    ds_read_b64_tr_b16 a[18:19], v6 offset:29696
    s_waitcnt lgkmcnt(5)
    v_mfma_f32_32x32x16_bf16 v[64:79], a[52:55], a[8:11], v[64:79]
    ds_read_b64_tr_b16 a[20:21], v7 offset:28672
    ds_read_b64_tr_b16 a[22:23], v7 offset:29696
    v_mfma_f32_32x32x16_bf16 v[80:95], a[56:59], a[8:11], v[80:95]
    v_mov_b32 v26, 3
    ds_write_b32 v23, v26
    ds_read_b64_tr_b16 a[24:25], v8 offset:28672
    ds_read_b64_tr_b16 a[26:27], v8 offset:29696
    s_waitcnt lgkmcnt(5)
    v_mfma_f32_32x32x16_bf16 v[32:47], a[12:15], a[0:3], v[32:47]
    ds_read_b128 a[4:7], v4 offset:12288
    ds_read_b64_tr_b16 a[28:29], v5 offset:32768
    ds_read_b64_tr_b16 a[30:31], v5 offset:33792
    v_mfma_f32_32x32x16_bf16 v[48:63], a[16:19], a[0:3], v[48:63]
    ds_read_b32 v21, v22
    ds_read_b64_tr_b16 a[32:33], v6 offset:32768
    ds_read_b64_tr_b16 a[34:35], v6 offset:33792
    s_waitcnt lgkmcnt(6)
    v_mfma_f32_32x32x16_bf16 v[64:79], a[20:23], a[0:3], v[64:79]
    ds_read_b64_tr_b16 a[36:37], v7 offset:32768
    ds_read_b64_tr_b16 a[38:39], v7 offset:33792
    v_mfma_f32_32x32x16_bf16 v[80:95], a[24:27], a[0:3], v[80:95]
    s_waitcnt lgkmcnt(4)
    s_movk_i32 s59, 4
    v_cmp_ge_u32 vcc, s59, v21
    ds_read_b64_tr_b16 a[40:41], v8 offset:32768
    ds_read_b64_tr_b16 a[42:43], v8 offset:33792
    s_waitcnt lgkmcnt(4)
    v_mfma_f32_32x32x16_bf16 v[32:47], a[28:31], a[4:7], v[32:47]
    s_getpc_b64 s[44:45]
    s_cbranch_vccnz A_spin
    ds_read_b128 a[8:11], v1 offset:40960
    ds_read_b64_tr_b16 a[44:45], v5 offset:36864
    ds_read_b64_tr_b16 a[46:47], v5 offset:37888
    v_mfma_f32_32x32x16_bf16 v[48:63], a[32:35], a[4:7], v[48:63]
    ds_read_b64_tr_b16 a[48:49], v6 offset:36864
    ds_read_b64_tr_b16 a[50:51], v6 offset:37888
    s_waitcnt lgkmcnt(5)
    v_mfma_f32_32x32x16_bf16 v[64:79], a[36:39], a[4:7], v[64:79]
    ds_read_b64_tr_b16 a[52:53], v7 offset:36864
    ds_read_b64_tr_b16 a[54:55], v7 offset:37888
    v_mfma_f32_32x32x16_bf16 v[80:95], a[40:43], a[4:7], v[80:95]
    v_mov_b32 v26, 4
    ds_write_b32 v23, v26
    ds_read_b64_tr_b16 a[56:57], v8 offset:36864
    ds_read_b64_tr_b16 a[58:59], v8 offset:37888
    s_waitcnt lgkmcnt(5)
    v_mfma_f32_32x32x16_bf16 v[32:47], a[44:47], a[8:11], v[32:47]
    ds_read_b128 a[0:3], v2 offset:40960
    ds_read_b64_tr_b16 a[12:13], v5 offset:40960
    ds_read_b64_tr_b16 a[14:15], v5 offset:41984
    v_mfma_f32_32x32x16_bf16 v[48:63], a[48:51], a[8:11], v[48:63]
    ds_read_b32 v21, v22
    ds_read_b64_tr_b16 a[16:17], v6 offset:40960
    ds_read_b64_tr_b16 a[18:19], v6 offset:41984
    s_waitcnt lgkmcnt(6)
    v_mfma_f32_32x32x16_bf16 v[64:79], a[52:55], a[8:11], v[64:79]
    ds_read_b64_tr_b16 a[20:21], v7 offset:40960
    ds_read_b64_tr_b16 a[22:23], v7 offset:41984
    v_mfma_f32_32x32x16_bf16 v[80:95], a[56:59], a[8:11], v[80:95]
    s_waitcnt lgkmcnt(4)
    s_movk_i32 s59, 5
    v_cmp_ge_u32 vcc, s59, v21
    ds_read_b64_tr_b16 a[24:25], v8 offset:40960
    ds_read_b64_tr_b16 a[26:27], v8 offset:41984
    s_waitcnt lgkmcnt(4)
    v_mfma_f32_32x32x16_bf16 v[32:47], a[12:15], a[0:3], v[32:47]
    s_getpc_b64 s[44:45]
    s_cbranch_vccnz A_spin
    ds_read_b128 a[4:7], v3 offset:40960
    ds_read_b64_tr_b16 a[28:29], v5 offset:57344
    ds_read_b64_tr_b16 a[30:31], v5 offset:58368
    v_mfma_f32_32x32x16_bf16 v[48:63], a[16:19], a[0:3], v[48:63]
    ds_read_b64_tr_b16 a[32:33], v6 offset:57344
    ds_read_b64_tr_b16 a[34:35], v6 offset:58368
    s_waitcnt lgkmcnt(5)
    v_mfma_f32_32x32x16_bf16 v[64:79], a[20:23], a[0:3], v[64:79]
    ds_read_b64_tr_b16 a[36:37], v7 offset:57344
    ds_read_b64_tr_b16 a[38:39], v7 offset:58368
    v_mfma_f32_32x32x16_bf16 v[80:95], a[24:27], a[0:3], v[80:95]
    v_mov_b32 v26, 5
    ds_write_b32 v23, v26
    ds_read_b64_tr_b16 a[40:41], v8 offset:57344
    ds_read_b64_tr_b16 a[42:43], v8 offset:58368
    s_waitcnt lgkmcnt(5)
    v_mfma_f32_32x32x16_bf16 v[32:47], a[28:31], a[4:7], v[32:47]
    ds_read_b128 a[8:11], v4 offset:40960
    ds_read_b64_tr_b16 a[44:45], v5 offset:61440
    ds_read_b64_tr_b16 a[46:47], v5 offset:62464
    v_mfma_f32_32x32x16_bf16 v[48:63], a[32:35], a[4:7], v[48:63]
    ds_read_b32 v21, v22
    ds_read_b64_tr_b16 a[48:49], v6 offset:61440
    ds_read_b64_tr_b16 a[50:51], v6 offset:62464
    s_waitcnt lgkmcnt(6)
    v_mfma_f32_32x32x16_bf16 v[64:79], a[36:39], a[4:7], v[64:79]
    ds_read_b64_tr_b16 a[52:53], v7 offset:61440
    ds_read_b64_tr_b16 a[54:55], v7 offset:62464
    v_mfma_f32_32x32x16_bf16 v[80:95], a[40:43], a[4:7], v[80:95]
    s_waitcnt lgkmcnt(4)
    s_movk_i32 s59, 6
    v_cmp_ge_u32 vcc, s59, v21
    ds_read_b64_tr_b16 a[56:57], v8 offset:61440
    ds_read_b64_tr_b16 a[58:59], v8 offset:62464
    s_waitcnt lgkmcnt(4)
    v_mfma_f32_32x32x16_bf16 v[32:47], a[44:47], a[8:11], v[32:47]
    s_getpc_b64 s[44:45]
    s_cbranch_vccnz A_spin
    v_add_u32 v1, 0x11000, v1
    v_add_u32 v2, 0x11000, v2
    v_add_u32 v3, 0x11000, v3
    v_add_u32 v4, 0x11000, v4
    ds_read_b128 a[0:3], v1 offset:0
    ds_read_b64_tr_b16 a[12:13], v5 offset:0
    ds_read_b64_tr_b16 a[14:15], v5 offset:1024
    v_mfma_f32_32x32x16_bf16 v[48:63], a[48:51], a[8:11], v[48:63]
    ds_read_b64_tr_b16 a[16:17], v6 offset:0
    ds_read_b64_tr_b16 a[18:19], v6 offset:1024
    s_waitcnt lgkmcnt(5)
    v_mfma_f32_32x32x16_bf16 v[64:79], a[52:55], a[8:11], v[64:79]
    ds_read_b64_tr_b16 a[20:21], v7 offset:0
    ds_read_b64_tr_b16 a[22:23], v7 offset:1024
    v_mfma_f32_32x32x16_bf16 v[80:95], a[56:59], a[8:11], v[80:95]
    v_mov_b32 v26, 6
    ds_write_b32 v23, v26
    ds_read_b64_tr_b16 a[24:25], v8 offset:0
    ds_read_b64_tr_b16 a[26:27], v8 offset:1024
    s_waitcnt lgkmcnt(5)
    v_mfma_f32_32x32x16_bf16 v[32:47], a[12:15], a[0:3], v[32:47]
    ds_read_b128 a[4:7], v2 offset:0
    ds_read_b64_tr_b16 a[28:29], v5 offset:4096
    ds_read_b64_tr_b16 a[30:31], v5 offset:5120
    v_mfma_f32_32x32x16_bf16 v[48:63], a[16:19], a[0:3], v[48:63]
    ds_read_b32 v21, v22
    ds_read_b64_tr_b16 a[32:33], v6 offset:4096
    ds_read_b64_tr_b16 a[34:35], v6 offset:5120
    s_waitcnt lgkmcnt(6)
    v_mfma_f32_32x32x16_bf16 v[64:79], a[20:23], a[0:3], v[64:79]
    ds_read_b64_tr_b16 a[36:37], v7 offset:4096
    ds_read_b64_tr_b16 a[38:39], v7 offset:5120
    v_mfma_f32_32x32x16_bf16 v[80:95], a[24:27], a[0:3], v[80:95]
    s_waitcnt lgkmcnt(4)
    s_movk_i32 s59, 7
    v_cmp_ge_u32 vcc, s59, v21
    ds_read_b64_tr_b16 a[40:41], v8 offset:4096
    ds_read_b64_tr_b16 a[42:43], v8 offset:5120
    s_waitcnt lgkmcnt(4)
    v_mfma_f32_32x32x16_bf16 v[32:47], a[28:31], a[4:7], v[32:47]
    s_getpc_b64 s[44:45]
    s_cbranch_vccnz A_spin
    ds_read_b128 a[8:11], v3 offset:0
    ds_read_b64_tr_b16 a[44:45], v5 offset:8192
    ds_read_b64_tr_b16 a[46:47], v5 offset:9216
    v_mfma_f32_32x32x16_bf16 v[48:63], a[32:35], a[4:7], v[48:63]
    ds_read_b64_tr_b16 a[48:49], v6 offset:8192
    ds_read_b64_tr_b16 a[50:51], v6 offset:9216
    s_waitcnt lgkmcnt(5)
    v_mfma_f32_32x32x16_bf16 v[64:79], a[36:39], a[4:7], v[64:79]
    ds_read_b64_tr_b16 a[52:53], v7 offset:8192
    ds_read_b64_tr_b16 a[54:55], v7 offset:9216
    v_mfma_f32_32x32x16_bf16 v[80:95], a[40:43], a[4:7], v[80:95]
    v_mov_b32 v26, 7
    ds_write_b32 v23, v26
    ds_read_b64_tr_b16 a[56:57], v8 offset:8192
    ds_read_b64_tr_b16 a[58:59], v8 offset:9216
    s_waitcnt lgkmcnt(5)
    v_mfma_f32_32x32x16_bf16 v[32:47], a[44:47], a[8:11], v[32:47]
    ds_read_b128 a[0:3], v4 offset:0
    ds_read_b64_tr_b16 a[12:13], v5 offset:12288
    ds_read_b64_tr_b16 a[14:15], v5 offset:13312
    v_mfma_f32_32x32x16_bf16 v[48:63], a[48:51], a[8:11], v[48:63]
    ds_read_b32 v21, v22
    ds_read_b64_tr_b16 a[16:17], v6 offset:12288
    ds_read_b64_tr_b16 a[18:19], v6 offset:13312
    s_waitcnt lgkmcnt(6)
    v_mfma_f32_32x32x16_bf16 v[64:79], a[52:55], a[8:11], v[64:79]
    ds_read_b64_tr_b16 a[20:21], v7 offset:12288
    ds_read_b64_tr_b16 a[22:23], v7 offset:13312
    v_mfma_f32_32x32x16_bf16 v[80:95], a[56:59], a[8:11], v[80:95]
    s_waitcnt lgkmcnt(4)
    s_movk_i32 s59, 8
    v_cmp_ge_u32 vcc, s59, v21
    ds_read_b64_tr_b16 a[24:25], v8 offset:12288
    ds_read_b64_tr_b16 a[26:27], v8 offset:13312
    s_waitcnt lgkmcnt(4)
    v_mfma_f32_32x32x16_bf16 v[32:47], a[12:15], a[0:3], v[32:47]
    s_getpc_b64 s[44:45]
    s_cbranch_vccnz A_spin
    v_add_u32 v1, 0xfffef000, v1
    v_add_u32 v2, 0xfffef000, v2
    v_add_u32 v3, 0xfffef000, v3
    v_add_u32 v4, 0xfffef000, v4
    ds_read_b128 a[4:7], v1 offset:0
    ds_read_b64_tr_b16 a[28:29], v5 offset:28672
    ds_read_b64_tr_b16 a[30:31], v5 offset:29696
    v_mfma_f32_32x32x16_bf16 v[48:63], a[16:19], a[0:3], v[48:63]
    ds_read_b64_tr_b16 a[32:33], v6 offset:28672
    ds_read_b64_tr_b16 a[34:35], v6 offset:29696
    s_waitcnt lgkmcnt(5)
    v_mfma_f32_32x32x16_bf16 v[64:79], a[20:23], a[0:3], v[64:79]
    ds_read_b64_tr_b16 a[36:37], v7 offset:28672
    ds_read_b64_tr_b16 a[38:39], v7 offset:29696
    v_mfma_f32_32x32x16_bf16 v[80:95], a[24:27], a[0:3], v[80:95]
    v_mov_b32 v26, 8
    ds_write_b32 v23, v26
    ds_read_b64_tr_b16 a[40:41], v8 offset:28672
    ds_read_b64_tr_b16 a[42:43], v8 offset:29696
    s_waitcnt lgkmcnt(5)
    v_mfma_f32_32x32x16_bf16 v[32:47], a[28:31], a[4:7], v[32:47]
    ds_read_b128 a[8:11], v2 offset:0
    ds_read_b64_tr_b16 a[44:45], v5 offset:32768
    ds_read_b64_tr_b16 a[46:47], v5 offset:33792
    v_mfma_f32_32x32x16_bf16 v[48:63], a[32:35], a[4:7], v[48:63]
    ds_read_b32 v21, v22
    ds_read_b64_tr_b16 a[48:49], v6 offset:32768
    ds_read_b64_tr_b16 a[50:51], v6 offset:33792
    s_waitcnt lgkmcnt(6)
    v_mfma_f32_32x32x16_bf16 v[64:79], a[36:39], a[4:7], v[64:79]
    ds_read_b64_tr_b16 a[52:53], v7 offset:32768
    ds_read_b64_tr_b16 a[54:55], v7 offset:33792
    v_mfma_f32_32x32x16_bf16 v[80:95], a[40:43], a[4:7], v[80:95]
    s_waitcnt lgkmcnt(4)
    s_movk_i32 s59, 9
    v_cmp_ge_u32 vcc, s59, v21
    ds_read_b64_tr_b16 a[56:57], v8 offset:32768
    ds_read_b64_tr_b16 a[58:59], v8 offset:33792
    s_waitcnt lgkmcnt(4)
    v_mfma_f32_32x32x16_bf16 v[32:47], a[44:47], a[8:11], v[32:47]
    s_getpc_b64 s[44:45]
    s_cbranch_vccnz A_spin
    ds_read_b128 a[0:3], v3 offset:0
    ds_read_b64_tr_b16 a[12:13], v5 offset:36864
    ds_read_b64_tr_b16 a[14:15], v5 offset:37888
    v_mfma_f32_32x32x16_bf16 v[48:63], a[48:51], a[8:11], v[48:63]
    ds_read_b64_tr_b16 a[16:17], v6 offset:36864
    ds_read_b64_tr_b16 a[18:19], v6 offset:37888
    s_waitcnt lgkmcnt(5)
    v_mfma_f32_32x32x16_bf16 v[64:79], a[52:55], a[8:11], v[64:79]
    ds_read_b64_tr_b16 a[20:21], v7 offset:36864
    ds_read_b64_tr_b16 a[22:23], v7 offset:37888
    v_mfma_f32_32x32x16_bf16 v[80:95], a[56:59], a[8:11], v[80:95]
    v_mov_b32 v26, 9
    ds_write_b32 v23, v26
    ds_read_b64_tr_b16 a[24:25], v8 offset:36864
    ds_read_b64_tr_b16 a[26:27], v8 offset:37888
    s_waitcnt lgkmcnt(5)
    v_mfma_f32_32x32x16_bf16 v[32:47], a[12:15], a[0:3], v[32:47]
    ds_read_b128 a[4:7], v4 offset:0
    ds_read_b64_tr_b16 a[28:29], v5 offset:40960
    ds_read_b64_tr_b16 a[30:31], v5 offset:41984
    v_mfma_f32_32x32x16_bf16 v[48:63], a[16:19], a[0:3], v[48:63]
    ds_read_b32 v21, v22
    ds_read_b64_tr_b16 a[32:33], v6 offset:40960
    ds_read_b64_tr_b16 a[34:35], v6 offset:41984
    s_waitcnt lgkmcnt(6)
    v_mfma_f32_32x32x16_bf16 v[64:79], a[20:23], a[0:3], v[64:79]
    ds_read_b64_tr_b16 a[36:37], v7 offset:40960
    ds_read_b64_tr_b16 a[38:39], v7 offset:41984
    v_mfma_f32_32x32x16_bf16 v[80:95], a[24:27], a[0:3], v[80:95]
    s_waitcnt lgkmcnt(4)
    s_movk_i32 s59, 10
    v_cmp_ge_u32 vcc, s59, v21
    ds_read_b64_tr_b16 a[40:41], v8 offset:40960
    ds_read_b64_tr_b16 a[42:43], v8 offset:41984
    s_waitcnt lgkmcnt(4)
    v_mfma_f32_32x32x16_bf16 v[32:47], a[28:31], a[4:7], v[32:47]
    s_getpc_b64 s[44:45]
    s_cbranch_vccnz A_spin
    ds_read_b128 a[8:11], v1 offset:12288
    ds_read_b64_tr_b16 a[44:45], v5 offset:57344
    ds_read_b64_tr_b16 a[46:47], v5 offset:58368
    v_mfma_f32_32x32x16_bf16 v[48:63], a[32:35], a[4:7], v[48:63]
    ds_read_b64_tr_b16 a[48:49], v6 offset:57344
    ds_read_b64_tr_b16 a[50:51], v6 offset:58368
    s_waitcnt lgkmcnt(5)
    v_mfma_f32_32x32x16_bf16 v[64:79], a[36:39], a[4:7], v[64:79]
    ds_read_b64_tr_b16 a[52:53], v7 offset:57344
    ds_read_b64_tr_b16 a[54:55], v7 offset:58368
    v_mfma_f32_32x32x16_bf16 v[80:95], a[40:43], a[4:7], v[80:95]
    v_mov_b32 v26, 10
    ds_write_b32 v23, v26
    ds_read_b64_tr_b16 a[56:57], v8 offset:57344
    ds_read_b64_tr_b16 a[58:59], v8 offset:58368
    s_waitcnt lgkmcnt(5)
    v_mfma_f32_32x32x16_bf16 v[32:47], a[44:47], a[8:11], v[32:47]
    ds_read_b128 a[0:3], v2 offset:12288
    ds_read_b64_tr_b16 a[12:13], v5 offset:61440
    ds_read_b64_tr_b16 a[14:15], v5 offset:62464
    v_mfma_f32_32x32x16_bf16 v[48:63], a[48:51], a[8:11], v[48:63]
    ds_read_b32 v21, v22
    ds_read_b64_tr_b16 a[16:17], v6 offset:61440
    ds_read_b64_tr_b16 a[18:19], v6 offset:62464
    s_waitcnt lgkmcnt(6)
    v_mfma_f32_32x32x16_bf16 v[64:79], a[52:55], a[8:11], v[64:79]
    ds_read_b64_tr_b16 a[20:21], v7 offset:61440
    ds_read_b64_tr_b16 a[22:23], v7 offset:62464
    v_mfma_f32_32x32x16_bf16 v[80:95], a[56:59], a[8:11], v[80:95]
    s_waitcnt lgkmcnt(4)
    s_movk_i32 s59, 11
    v_cmp_ge_u32 vcc, s59, v21
    ds_read_b64_tr_b16 a[24:25], v8 offset:61440
    ds_read_b64_tr_b16 a[26:27], v8 offset:62464
    s_waitcnt lgkmcnt(4)
    v_mfma_f32_32x32x16_bf16 v[32:47], a[12:15], a[0:3], v[32:47]
    s_getpc_b64 s[44:45]
    s_cbranch_vccnz A_spin
    ds_read_b128 a[4:7], v3 offset:12288
    ds_read_b64_tr_b16 a[28:29], v5 offset:0
    ds_read_b64_tr_b16 a[30:31], v5 offset:1024
    v_mfma_f32_32x32x16_bf16 v[48:63], a[16:19], a[0:3], v[48:63]
    ds_read_b64_tr_b16 a[32:33], v6 offset:0
    ds_read_b64_tr_b16 a[34:35], v6 offset:1024
    s_waitcnt lgkmcnt(5)
    v_mfma_f32_32x32x16_bf16 v[64:79], a[20:23], a[0:3], v[64:79]
    ds_read_b64_tr_b16 a[36:37], v7 offset:0
    ds_read_b64_tr_b16 a[38:39], v7 offset:1024
    v_mfma_f32_32x32x16_bf16 v[80:95], a[24:27], a[0:3], v[80:95]
    v_mov_b32 v26, 11
    ds_write_b32 v23, v26
    ds_read_b64_tr_b16 a[40:41], v8 offset:0
    ds_read_b64_tr_b16 a[42:43], v8 offset:1024
    s_waitcnt lgkmcnt(5)
    v_mfma_f32_32x32x16_bf16 v[32:47], a[28:31], a[4:7], v[32:47]
    ds_read_b128 a[8:11], v4 offset:12288
    ds_read_b64_tr_b16 a[44:45], v5 offset:4096
    ds_read_b64_tr_b16 a[46:47], v5 offset:5120
    v_mfma_f32_32x32x16_bf16 v[48:63], a[32:35], a[4:7], v[48:63]
    ds_read_b32 v21, v22
    ds_read_b64_tr_b16 a[48:49], v6 offset:4096
    ds_read_b64_tr_b16 a[50:51], v6 offset:5120
    s_waitcnt lgkmcnt(6)
    v_mfma_f32_32x32x16_bf16 v[64:79], a[36:39], a[4:7], v[64:79]
    ds_read_b64_tr_b16 a[52:53], v7 offset:4096
    ds_read_b64_tr_b16 a[54:55], v7 offset:5120
    v_mfma_f32_32x32x16_bf16 v[80:95], a[40:43], a[4:7], v[80:95]
    s_waitcnt lgkmcnt(4)
    s_movk_i32 s59, 12
    v_cmp_ge_u32 vcc, s59, v21
    ds_read_b64_tr_b16 a[56:57], v8 offset:4096
    ds_read_b64_tr_b16 a[58:59], v8 offset:5120
    s_waitcnt lgkmcnt(4)
    v_mfma_f32_32x32x16_bf16 v[32:47], a[44:47], a[8:11], v[32:47]
    s_getpc_b64 s[44:45]
    s_cbranch_vccnz A_spin
    ds_read_b128 a[0:3], v1 offset:40960
    ds_read_b64_tr_b16 a[12:13], v5 offset:8192
    ds_read_b64_tr_b16 a[14:15], v5 offset:9216
    v_mfma_f32_32x32x16_bf16 v[48:63], a[48:51], a[8:11], v[48:63]
    ds_read_b64_tr_b16 a[16:17], v6 offset:8192
    ds_read_b64_tr_b16 a[18:19], v6 offset:9216
    s_waitcnt lgkmcnt(5)
    v_mfma_f32_32x32x16_bf16 v[64:79], a[52:55], a[8:11], v[64:79]
    ds_read_b64_tr_b16 a[20:21], v7 offset:8192
    ds_read_b64_tr_b16 a[22:23], v7 offset:9216
    v_mfma_f32_32x32x16_bf16 v[80:95], a[56:59], a[8:11], v[80:95]
    v_mov_b32 v26, 12
    ds_write_b32 v23, v26
    ds_read_b64_tr_b16 a[24:25], v8 offset:8192
    ds_read_b64_tr_b16 a[26:27], v8 offset:9216
    s_waitcnt lgkmcnt(5)
    v_mfma_f32_32x32x16_bf16 v[32:47], a[12:15], a[0:3], v[32:47]
    ds_read_b128 a[4:7], v2 offset:40960
    ds_read_b64_tr_b16 a[28:29], v5 offset:12288
    ds_read_b64_tr_b16 a[30:31], v5 offset:13312
    v_mfma_f32_32x32x16_bf16 v[48:63], a[16:19], a[0:3], v[48:63]
    ds_read_b32 v21, v22
    ds_read_b64_tr_b16 a[32:33], v6 offset:12288
    ds_read_b64_tr_b16 a[34:35], v6 offset:13312
    s_waitcnt lgkmcnt(6)
    v_mfma_f32_32x32x16_bf16 v[64:79], a[20:23], a[0:3], v[64:79]
    ds_read_b64_tr_b16 a[36:37], v7 offset:12288
    ds_read_b64_tr_b16 a[38:39], v7 offset:13312
    v_mfma_f32_32x32x16_bf16 v[80:95], a[24:27], a[0:3], v[80:95]
    s_waitcnt lgkmcnt(4)
    s_movk_i32 s59, 13
    v_cmp_ge_u32 vcc, s59, v21
    ds_read_b64_tr_b16 a[40:41], v8 offset:12288
    ds_read_b64_tr_b16 a[42:43], v8 offset:13312
    s_waitcnt lgkmcnt(4)
    v_mfma_f32_32x32x16_bf16 v[32:47], a[28:31], a[4:7], v[32:47]
    s_getpc_b64 s[44:45]
    s_cbranch_vccnz A_spin
    ds_read_b128 a[8:11], v3 offset:40960
    ds_read_b64_tr_b16 a[44:45], v5 offset:28672
    ds_read_b64_tr_b16 a[46:47], v5 offset:29696
    v_mfma_f32_32x32x16_bf16 v[48:63], a[32:35], a[4:7], v[48:63]
    ds_read_b64_tr_b16 a[48:49], v6 offset:28672
    ds_read_b64_tr_b16 a[50:51], v6 offset:29696
    s_waitcnt lgkmcnt(5)
    v_mfma_f32_32x32x16_bf16 v[64:79], a[36:39], a[4:7], v[64:79]
    ds_read_b64_tr_b16 a[52:53], v7 offset:28672
    ds_read_b64_tr_b16 a[54:55], v7 offset:29696
    v_mfma_f32_32x32x16_bf16 v[80:95], a[40:43], a[4:7], v[80:95]
    v_mov_b32 v26, 13
    ds_write_b32 v23, v26
    ds_read_b64_tr_b16 a[56:57], v8 offset:28672
    ds_read_b64_tr_b16 a[58:59], v8 offset:29696
    s_waitcnt lgkmcnt(5)
    v_mfma_f32_32x32x16_bf16 v[32:47], a[44:47], a[8:11], v[32:47]
    ds_read_b128 a[0:3], v4 offset:40960
    ds_read_b64_tr_b16 a[12:13], v5 offset:32768
    ds_read_b64_tr_b16 a[14:15], v5 offset:33792
    v_mfma_f32_32x32x16_bf16 v[48:63], a[48:51], a[8:11], v[48:63]
    ds_read_b32 v21, v22
    ds_read_b64_tr_b16 a[16:17], v6 offset:32768
    ds_read_b64_tr_b16 a[18:19], v6 offset:33792
    s_waitcnt lgkmcnt(6)
    v_mfma_f32_32x32x16_bf16 v[64:79], a[52:55], a[8:11], v[64:79]
    ds_read_b64_tr_b16 a[20:21], v7 offset:32768
    ds_read_b64_tr_b16 a[22:23], v7 offset:33792
    v_mfma_f32_32x32x16_bf16 v[80:95], a[56:59], a[8:11], v[80:95]
    s_waitcnt lgkmcnt(4)
    s_movk_i32 s59, 14
    v_cmp_ge_u32 vcc, s59, v21
    ds_read_b64_tr_b16 a[24:25], v8 offset:32768
    ds_read_b64_tr_b16 a[26:27], v8 offset:33792
    s_waitcnt lgkmcnt(4)
    v_mfma_f32_32x32x16_bf16 v[32:47], a[12:15], a[0:3], v[32:47]
    s_getpc_b64 s[44:45]
    s_cbranch_vccnz A_spin
    v_add_u32 v1, 0x11000, v1
    v_add_u32 v2, 0x11000, v2
    v_add_u32 v3, 0x11000, v3
    v_add_u32 v4, 0x11000, v4
    ds_read_b128 a[4:7], v1 offset:0
    ds_read_b64_tr_b16 a[28:29], v5 offset:36864
    ds_read_b64_tr_b16 a[30:31], v5 offset:37888
    v_mfma_f32_32x32x16_bf16 v[48:63], a[16:19], a[0:3], v[48:63]
    ds_read_b64_tr_b16 a[32:33], v6 offset:36864
    ds_read_b64_tr_b16 a[34:35], v6 offset:37888
    s_waitcnt lgkmcnt(5)
    v_mfma_f32_32x32x16_bf16 v[64:79], a[20:23], a[0:3], v[64:79]
    ds_read_b64_tr_b16 a[36:37], v7 offset:36864
    ds_read_b64_tr_b16 a[38:39], v7 offset:37888
    v_mfma_f32_32x32x16_bf16 v[80:95], a[24:27], a[0:3], v[80:95]
    v_mov_b32 v26, 14
    ds_write_b32 v23, v26
    ds_read_b64_tr_b16 a[40:41], v8 offset:36864
    ds_read_b64_tr_b16 a[42:43], v8 offset:37888
    s_waitcnt lgkmcnt(5)
    v_mfma_f32_32x32x16_bf16 v[32:47], a[28:31], a[4:7], v[32:47]
    ds_read_b128 a[8:11], v2 offset:0
    ds_read_b64_tr_b16 a[44:45], v5 offset:40960
    ds_read_b64_tr_b16 a[46:47], v5 offset:41984
    v_mfma_f32_32x32x16_bf16 v[48:63], a[32:35], a[4:7], v[48:63]
    ds_read_b32 v21, v22
    ds_read_b64_tr_b16 a[48:49], v6 offset:40960
    ds_read_b64_tr_b16 a[50:51], v6 offset:41984
    s_waitcnt lgkmcnt(6)
    v_mfma_f32_32x32x16_bf16 v[64:79], a[36:39], a[4:7], v[64:79]
    ds_read_b64_tr_b16 a[52:53], v7 offset:40960
    ds_read_b64_tr_b16 a[54:55], v7 offset:41984
    v_mfma_f32_32x32x16_bf16 v[80:95], a[40:43], a[4:7], v[80:95]
    s_waitcnt lgkmcnt(4)
    s_movk_i32 s59, 15
    v_cmp_ge_u32 vcc, s59, v21
    ds_read_b64_tr_b16 a[56:57], v8 offset:40960
    ds_read_b64_tr_b16 a[58:59], v8 offset:41984
    s_waitcnt lgkmcnt(4)
    v_mfma_f32_32x32x16_bf16 v[32:47], a[44:47], a[8:11], v[32:47]
    s_getpc_b64 s[44:45]
    s_cbranch_vccnz A_spin
    ds_read_b128 a[0:3], v3 offset:0
    ds_read_b64_tr_b16 a[12:13], v5 offset:57344
    ds_read_b64_tr_b16 a[14:15], v5 offset:58368
    v_mfma_f32_32x32x16_bf16 v[48:63], a[48:51], a[8:11], v[48:63]
    ds_read_b64_tr_b16 a[16:17], v6 offset:57344
    ds_read_b64_tr_b16 a[18:19], v6 offset:58368
    s_waitcnt lgkmcnt(5)
    v_mfma_f32_32x32x16_bf16 v[64:79], a[52:55], a[8:11], v[64:79]
    ds_read_b64_tr_b16 a[20:21], v7 offset:57344
    ds_read_b64_tr_b16 a[22:23], v7 offset:58368
    v_mfma_f32_32x32x16_bf16 v[80:95], a[56:59], a[8:11], v[80:95]
    v_mov_b32 v26, 15
    ds_write_b32 v23, v26
    ds_read_b64_tr_b16 a[24:25], v8 offset:57344
    ds_read_b64_tr_b16 a[26:27], v8 offset:58368
    s_waitcnt lgkmcnt(5)
    v_mfma_f32_32x32x16_bf16 v[32:47], a[12:15], a[0:3], v[32:47]
    ds_read_b128 a[4:7], v4 offset:0
    ds_read_b64_tr_b16 a[28:29], v5 offset:61440
    ds_read_b64_tr_b16 a[30:31], v5 offset:62464
    v_mfma_f32_32x32x16_bf16 v[48:63], a[16:19], a[0:3], v[48:63]
    ds_read_b64_tr_b16 a[32:33], v6 offset:61440
    ds_read_b64_tr_b16 a[34:35], v6 offset:62464
    s_waitcnt lgkmcnt(5)
    v_mfma_f32_32x32x16_bf16 v[64:79], a[20:23], a[0:3], v[64:79]
    ds_read_b64_tr_b16 a[36:37], v7 offset:61440
    ds_read_b64_tr_b16 a[38:39], v7 offset:62464
    v_mfma_f32_32x32x16_bf16 v[80:95], a[24:27], a[0:3], v[80:95]
    ds_read_b64_tr_b16 a[40:41], v8 offset:61440
    ds_read_b64_tr_b16 a[42:43], v8 offset:62464
    s_waitcnt lgkmcnt(4)
    v_mfma_f32_32x32x16_bf16 v[32:47], a[28:31], a[4:7], v[32:47]
    v_mfma_f32_32x32x16_bf16 v[48:63], a[32:35], a[4:7], v[48:63]
    s_waitcnt lgkmcnt(0)
    v_mfma_f32_32x32x16_bf16 v[64:79], a[36:39], a[4:7], v[64:79]
    v_mfma_f32_32x32x16_bf16 v[80:95], a[40:43], a[4:7], v[80:95]
    v_mov_b32 v26, 16
    ds_write_b32 v23, v26
    s_nop 5
    v_pk_mul_f32 v[32:33], v[32:33], s[46:47]
    v_pk_mul_f32 v[34:35], v[34:35], s[46:47]
    v_pk_mul_f32 v[36:37], v[36:37], s[46:47]
    v_pk_mul_f32 v[38:39], v[38:39], s[46:47]
    v_pk_mul_f32 v[40:41], v[40:41], s[46:47]
    v_pk_mul_f32 v[42:43], v[42:43], s[46:47]
    v_pk_mul_f32 v[44:45], v[44:45], s[46:47]
    v_pk_mul_f32 v[46:47], v[46:47], s[46:47]
    v_cvt_pk_bf16_f32 v32, v32, v33
    v_cvt_pk_bf16_f32 v33, v34, v35
    v_cvt_pk_bf16_f32 v34, v36, v37
    v_cvt_pk_bf16_f32 v35, v38, v39
    v_cvt_pk_bf16_f32 v36, v40, v41
    v_cvt_pk_bf16_f32 v37, v42, v43
    v_cvt_pk_bf16_f32 v38, v44, v45
    v_cvt_pk_bf16_f32 v39, v46, v47
    v_accvgpr_write_b32 a60, v32
    v_accvgpr_write_b32 a61, v33
    v_accvgpr_write_b32 a62, v34
    v_accvgpr_write_b32 a63, v35
    v_accvgpr_write_b32 a64, v36
    v_accvgpr_write_b32 a65, v37
    v_accvgpr_write_b32 a66, v38
    v_accvgpr_write_b32 a67, v39
    ds_read_b32 v21, v22
    s_waitcnt lgkmcnt(0)
    s_movk_i32 s59, 16
    v_cmp_ge_u32 vcc, s59, v21
    s_getpc_b64 s[44:45]
    s_cbranch_vccnz A_spin
    ds_read_b128 a[92:95], v9 offset:0
    ds_read_b128 a[96:99], v10 offset:0
    ds_read_b128 a[100:103], v11 offset:0
    ds_read_b128 a[104:107], v12 offset:0
    ds_read_b128 a[108:111], v13 offset:0
    ds_read_b128 a[112:115], v14 offset:0
    s_waitcnt lgkmcnt(4)
    v_mfma_f32_32x32x16_bf16 v[32:47], a[92:95], a[60:63], 0
    ds_read_b128 a[116:119], v15 offset:0
    v_pk_mul_f32 v[48:49], v[48:49], s[46:47]
    v_pk_mul_f32 v[50:51], v[50:51], s[46:47]
    v_pk_mul_f32 v[52:53], v[52:53], s[46:47]
    v_pk_mul_f32 v[54:55], v[54:55], s[46:47]
    v_pk_mul_f32 v[56:57], v[56:57], s[46:47]
    v_pk_mul_f32 v[58:59], v[58:59], s[46:47]
    v_pk_mul_f32 v[60:61], v[60:61], s[46:47]
    v_pk_mul_f32 v[62:63], v[62:63], s[46:47]
    v_mfma_f32_32x32x16_bf16 v[32:47], a[96:99], a[64:67], v[32:47]
    ds_read_b128 a[120:123], v16 offset:0
    v_cvt_pk_bf16_f32 v48, v48, v49
    v_cvt_pk_bf16_f32 v49, v50, v51
    v_cvt_pk_bf16_f32 v50, v52, v53
    v_cvt_pk_bf16_f32 v51, v54, v55
    v_cvt_pk_bf16_f32 v52, v56, v57
    v_cvt_pk_bf16_f32 v53, v58, v59
    v_cvt_pk_bf16_f32 v54, v60, v61
    v_cvt_pk_bf16_f32 v55, v62, v63
    v_accvgpr_write_b32 a68, v48
    v_accvgpr_write_b32 a69, v49
    v_accvgpr_write_b32 a70, v50
    v_accvgpr_write_b32 a71, v51
    v_accvgpr_write_b32 a72, v52
    v_accvgpr_write_b32 a73, v53
    v_accvgpr_write_b32 a74, v54
    v_accvgpr_write_b32 a75, v55
    s_waitcnt lgkmcnt(4)
    v_mfma_f32_32x32x16_bf16 v[32:47], a[100:103], a[68:71], v[32:47]
    ds_read_b128 a[92:95], v9 offset:8192
    v_pk_mul_f32 v[64:65], v[64:65], s[46:47]
    v_pk_mul_f32 v[66:67], v[66:67], s[46:47]
    v_pk_mul_f32 v[68:69], v[68:69], s[46:47]
    v_pk_mul_f32 v[70:71], v[70:71], s[46:47]
    v_pk_mul_f32 v[72:73], v[72:73], s[46:47]
    v_pk_mul_f32 v[74:75], v[74:75], s[46:47]
    v_pk_mul_f32 v[76:77], v[76:77], s[46:47]
    v_pk_mul_f32 v[78:79], v[78:79], s[46:47]
    v_mfma_f32_32x32x16_bf16 v[32:47], a[104:107], a[72:75], v[32:47]
    ds_read_b128 a[96:99], v10 offset:8192
    v_cvt_pk_bf16_f32 v64, v64, v65
    v_cvt_pk_bf16_f32 v65, v66, v67
    v_cvt_pk_bf16_f32 v66, v68, v69
    v_cvt_pk_bf16_f32 v67, v70, v71
    v_cvt_pk_bf16_f32 v68, v72, v73
    v_cvt_pk_bf16_f32 v69, v74, v75
    v_cvt_pk_bf16_f32 v70, v76, v77
    v_cvt_pk_bf16_f32 v71, v78, v79
    v_accvgpr_write_b32 a76, v64
    v_accvgpr_write_b32 a77, v65
    v_accvgpr_write_b32 a78, v66
    v_accvgpr_write_b32 a79, v67
    v_accvgpr_write_b32 a80, v68
    v_accvgpr_write_b32 a81, v69
    v_accvgpr_write_b32 a82, v70
    v_accvgpr_write_b32 a83, v71
    s_waitcnt lgkmcnt(4)
    v_mfma_f32_32x32x16_bf16 v[32:47], a[108:111], a[76:79], v[32:47]
    ds_read_b128 a[100:103], v11 offset:8192
    v_pk_mul_f32 v[80:81], v[80:81], s[46:47]
    v_pk_mul_f32 v[82:83], v[82:83], s[46:47]
    v_pk_mul_f32 v[84:85], v[84:85], s[46:47]
    v_pk_mul_f32 v[86:87], v[86:87], s[46:47]
    v_pk_mul_f32 v[88:89], v[88:89], s[46:47]
    v_pk_mul_f32 v[90:91], v[90:91], s[46:47]
    v_pk_mul_f32 v[92:93], v[92:93], s[46:47]
    v_pk_mul_f32 v[94:95], v[94:95], s[46:47]
    v_mfma_f32_32x32x16_bf16 v[32:47], a[112:115], a[80:83], v[32:47]
    ds_read_b128 a[104:107], v12 offset:8192
    v_cvt_pk_bf16_f32 v80, v80, v81
    v_cvt_pk_bf16_f32 v81, v82, v83
    v_cvt_pk_bf16_f32 v82, v84, v85
    v_cvt_pk_bf16_f32 v83, v86, v87
    v_cvt_pk_bf16_f32 v84, v88, v89
    v_cvt_pk_bf16_f32 v85, v90, v91
    v_cvt_pk_bf16_f32 v86, v92, v93
    v_cvt_pk_bf16_f32 v87, v94, v95
    v_accvgpr_write_b32 a84, v80
    v_accvgpr_write_b32 a85, v81
    v_accvgpr_write_b32 a86, v82
    v_accvgpr_write_b32 a87, v83
    v_accvgpr_write_b32 a88, v84
    v_accvgpr_write_b32 a89, v85
    v_accvgpr_write_b32 a90, v86
    v_accvgpr_write_b32 a91, v87
    s_waitcnt lgkmcnt(4)
    v_mfma_f32_32x32x16_bf16 v[32:47], a[116:119], a[84:87], v[32:47]
    ds_read_b128 a[108:111], v13 offset:8192
    s_waitcnt vmcnt(0)
    v_readfirstlane_b32 s56, v27
    s_nop 0
    s_mul_i32 s56, s56, 0x9e3779b1
    s_add_u32 s56, s56, 0x7f4a7c15
    v_accvgpr_read_b32 v1, a132
    v_accvgpr_read_b32 v2, a133
    v_mfma_f32_32x32x16_bf16 v[32:47], a[120:123], a[88:91], v[32:47]
    ds_read_b32 v21, v22
    ds_read_b128 a[112:115], v14 offset:8192
    v_accvgpr_read_b32 v3, a134
    v_accvgpr_read_b32 v4, a135
    v_accvgpr_read_b32 v5, a136
    v_accvgpr_read_b32 v6, a137
    v_accvgpr_read_b32 v7, a138
    v_mov_b32 v8, s56
    s_waitcnt lgkmcnt(5)
    v_mfma_f32_32x32x16_bf16 v[48:63], a[92:95], a[60:63], 0
    ds_read_b128 a[116:119], v15 offset:8192
    v_mfma_f32_32x32x16_bf16 v[48:63], a[96:99], a[64:67], v[48:63]
    s_waitcnt lgkmcnt(2)
    s_movk_i32 s59, 17
    v_cmp_ge_u32 vcc, s59, v21
    ds_read_b128 a[120:123], v16 offset:8192
    v_mfma_f32_32x32x16_bf16 v[48:63], a[100:103], a[68:71], v[48:63]
    s_getpc_b64 s[44:45]
    s_cbranch_vccnz A_spin
    ds_read_b128 a[92:95], v9 offset:16384
    v_max3_f32 v24, v32, v33, v34
    v_max3_f32 v24, v24, v35, v36
    v_max3_f32 v24, v24, v37, v38
    v_mfma_f32_32x32x16_bf16 v[48:63], a[104:107], a[72:75], v[48:63]
    ds_read_b128 a[96:99], v10 offset:16384
    v_max3_f32 v24, v24, v39, v40
    v_max3_f32 v24, v24, v41, v42
    v_max3_f32 v24, v24, v43, v44
    v_max3_f32 v24, v24, v45, v46
    v_max_f32 v24, v24, v47
    v_mov_b32 v25, v24
    s_waitcnt lgkmcnt(4)
    v_mfma_f32_32x32x16_bf16 v[48:63], a[108:111], a[76:79], v[48:63]
    ds_read_b128 a[100:103], v11 offset:16384
    s_nop 1
    v_permlane32_swap_b32 v24, v25
    v_max_f32 v24, v24, v25
    v_sub_f32 v80, 0xc1800000, v24
    v_mov_b32 v81, v80
    v_mov_b32 v82, v80
    v_mov_b32 v83, v80
    v_mov_b32 v84, v80
    v_mfma_f32_32x32x16_bf16 v[48:63], a[112:115], a[80:83], v[48:63]
    ds_read_b128 a[104:107], v12 offset:16384
    v_mov_b32 v85, v80
    v_mov_b32 v86, v80
    v_mov_b32 v87, v80
    v_mov_b32 v88, v80
    v_mov_b32 v89, v80
    v_mov_b32 v90, v80
    v_mov_b32 v91, v80
    s_waitcnt lgkmcnt(4)
    v_mfma_f32_32x32x16_bf16 v[48:63], a[116:119], a[84:87], v[48:63]
    ds_read_b128 a[108:111], v13 offset:16384
    v_mov_b32 v92, v80
    v_mov_b32 v93, v80
    v_mov_b32 v94, v80
    v_mov_b32 v95, v80
    v_add_f32 v32, v80, v32
    v_add_f32 v33, v80, v33
    v_add_f32 v34, v80, v34
    v_add_f32 v35, v80, v35
    v_mfma_f32_32x32x16_bf16 v[48:63], a[120:123], a[88:91], v[48:63]
    v_mov_b32 v26, 17
    ds_write_b32 v23, v26
    ds_read_b128 a[112:115], v14 offset:16384
    v_add_f32 v36, v80, v36
    v_add_f32 v37, v80, v37
    v_add_f32 v38, v80, v38
    v_add_f32 v39, v80, v39
    v_add_f32 v40, v80, v40
    s_waitcnt lgkmcnt(5)
    v_mfma_f32_32x32x16_bf16 v[64:79], a[92:95], a[60:63], v[80:95]
    ds_read_b128 a[116:119], v15 offset:16384
    v_add_f32 v41, v80, v41
    v_add_f32 v42, v80, v42
    v_add_f32 v43, v80, v43
    v_add_f32 v44, v80, v44
    v_add_f32 v45, v80, v45
    v_add_f32 v46, v80, v46
    v_add_f32 v47, v80, v47
    v_mfma_f32_32x32x16_bf16 v[64:79], a[96:99], a[64:67], v[64:79]
    ds_read_b128 a[120:123], v16 offset:16384
    v_exp_f32 v28, v32
    v_exp_f32 v29, v33
    v_exp_f32 v30, v34
    v_cvt_pk_bf16_f32 v96, v28, v29
    s_waitcnt lgkmcnt(5)
    v_mfma_f32_32x32x16_bf16 v[64:79], a[100:103], a[68:71], v[64:79]
    ds_read_b128 a[92:95], v9 offset:24576
    v_exp_f32 v31, v35
    v_exp_f32 v28, v36
    v_cvt_pk_bf16_f32 v97, v30, v31
    v_exp_f32 v29, v37
    v_mfma_f32_32x32x16_bf16 v[64:79], a[104:107], a[72:75], v[64:79]
    ds_read_b128 a[96:99], v10 offset:24576
    v_exp_f32 v30, v38
    v_cvt_pk_bf16_f32 v98, v28, v29
    v_exp_f32 v31, v39
    v_exp_f32 v28, v40
    s_waitcnt lgkmcnt(4)
    v_mfma_f32_32x32x16_bf16 v[64:79], a[108:111], a[76:79], v[64:79]
    ds_read_b128 a[100:103], v11 offset:24576
    v_cvt_pk_bf16_f32 v99, v30, v31
    v_exp_f32 v29, v41
    v_exp_f32 v30, v42
    v_cvt_pk_bf16_f32 v100, v28, v29
    v_exp_f32 v31, v43
    v_mfma_f32_32x32x16_bf16 v[64:79], a[112:115], a[80:83], v[64:79]
    ds_read_b128 a[104:107], v12 offset:24576
    v_exp_f32 v28, v44
    v_cvt_pk_bf16_f32 v101, v30, v31
    v_exp_f32 v29, v45
    v_exp_f32 v30, v46
    s_waitcnt lgkmcnt(4)
    v_mfma_f32_32x32x16_bf16 v[64:79], a[116:119], a[84:87], v[64:79]
    ds_read_b128 a[108:111], v13 offset:24576
    v_cvt_pk_bf16_f32 v102, v28, v29
    v_exp_f32 v31, v47
    s_nop 0
    v_cvt_pk_bf16_f32 v103, v30, v31
    v_add_f32 v48, v80, v48
    v_add_f32 v49, v80, v49
    v_add_f32 v50, v80, v50
    v_add_f32 v51, v80, v51
    v_mfma_f32_32x32x16_bf16 v[64:79], a[120:123], a[88:91], v[64:79]
    ds_read_b32 v21, v22
    ds_read_b128 a[112:115], v14 offset:24576
    v_add_f32 v52, v80, v52
    v_add_f32 v53, v80, v53
    v_add_f32 v54, v80, v54
    v_add_f32 v55, v80, v55
    v_add_f32 v56, v80, v56
    v_add_f32 v57, v80, v57
    s_waitcnt lgkmcnt(5)
    v_mfma_f32_32x32x16_bf16 v[32:47], a[92:95], a[60:63], v[80:95]
    ds_read_b128 a[116:119], v15 offset:24576
    v_add_f32 v58, v80, v58
    v_add_f32 v59, v80, v59
    v_add_f32 v60, v80, v60
    v_add_f32 v61, v80, v61
    v_add_f32 v62, v80, v62
    v_add_f32 v63, v80, v63
    v_max3_f32 v24, v48, v49, v50
    v_max3_f32 v24, v24, v51, v52
    v_mfma_f32_32x32x16_bf16 v[32:47], a[96:99], a[64:67], v[32:47]
    s_waitcnt lgkmcnt(2)
    s_movk_i32 s59, 18
    v_cmp_ge_u32 vcc, s59, v21
    ds_read_b128 a[120:123], v16 offset:24576
    v_max3_f32 v24, v24, v53, v54
    v_max3_f32 v24, v24, v55, v56
    v_max3_f32 v24, v24, v57, v58
    v_max3_f32 v24, v24, v59, v60
    v_mfma_f32_32x32x16_bf16 v[32:47], a[100:103], a[68:71], v[32:47]
    s_getpc_b64 s[44:45]
    s_cbranch_vccnz A_spin
    ds_read_b128 a[92:95], v9 offset:32768
    v_max3_f32 v24, v24, v61, v62
    v_max_f32 v24, v24, v63
    v_cmp_lt_f32 s[22:23], 0, v24
    v_mfma_f32_32x32x16_bf16 v[32:47], a[104:107], a[72:75], v[32:47]
    ds_read_b128 a[96:99], v10 offset:32768
    s_getpc_b64 s[44:45]
    s_cmp_lg_u64 s[22:23], 0
    s_cbranch_scc1 A_raise
    s_waitcnt lgkmcnt(4)
    v_mfma_f32_32x32x16_bf16 v[32:47], a[108:111], a[76:79], v[32:47]
    ds_read_b128 a[100:103], v11 offset:32768
    v_exp_f32 v28, v48
    v_exp_f32 v29, v49
    v_exp_f32 v30, v50
    v_cvt_pk_bf16_f32 v104, v28, v29
    v_mfma_f32_32x32x16_bf16 v[32:47], a[112:115], a[80:83], v[32:47]
    ds_read_b128 a[104:107], v12 offset:32768
    v_exp_f32 v31, v51
    v_exp_f32 v28, v52
    v_cvt_pk_bf16_f32 v105, v30, v31
    v_exp_f32 v29, v53
    s_waitcnt lgkmcnt(4)
    v_mfma_f32_32x32x16_bf16 v[32:47], a[116:119], a[84:87], v[32:47]
    ds_read_b128 a[108:111], v13 offset:32768
    v_exp_f32 v30, v54
    v_cvt_pk_bf16_f32 v106, v28, v29
    v_exp_f32 v31, v55
    v_exp_f32 v28, v56
    v_cvt_pk_bf16_f32 v107, v30, v31
    v_mfma_f32_32x32x16_bf16 v[32:47], a[120:123], a[88:91], v[32:47]
    v_mov_b32 v26, 18
    ds_write_b32 v23, v26
    ds_read_b128 a[112:115], v14 offset:32768
    v_exp_f32 v29, v57
    v_exp_f32 v30, v58
    v_cvt_pk_bf16_f32 v108, v28, v29
    v_exp_f32 v31, v59
    v_exp_f32 v28, v60
    v_cvt_pk_bf16_f32 v109, v30, v31
    v_exp_f32 v29, v61
    v_exp_f32 v30, v62
    v_cvt_pk_bf16_f32 v110, v28, v29
    v_exp_f32 v31, v63
    s_nop 0
    v_cvt_pk_bf16_f32 v111, v30, v31
    s_waitcnt lgkmcnt(5)
    v_mfma_f32_32x32x16_bf16 v[48:63], a[92:95], a[60:63], v[80:95]
    ds_read_b128 a[116:119], v15 offset:32768
    v_max3_f32 v24, v64, v65, v66
    v_max3_f32 v24, v24, v67, v68
    v_max3_f32 v24, v24, v69, v70
    v_max3_f32 v24, v24, v71, v72
    v_max3_f32 v24, v24, v73, v74
    v_max3_f32 v24, v24, v75, v76
    v_max3_f32 v24, v24, v77, v78
    v_max_f32 v24, v24, v79
    v_mfma_f32_32x32x16_bf16 v[48:63], a[96:99], a[64:67], v[48:63]
    ds_read_b128 a[120:123], v16 offset:32768
    v_cmp_lt_f32 s[22:23], 0, v24
    s_waitcnt lgkmcnt(5)
    v_mfma_f32_32x32x16_bf16 v[48:63], a[100:103], a[68:71], v[48:63]
    ds_read_b128 a[92:95], v9 offset:40960
    s_getpc_b64 s[44:45]
    s_cmp_lg_u64 s[22:23], 0
    s_cbranch_scc1 A_raise
    v_exp_f32 v28, v64
    v_mfma_f32_32x32x16_bf16 v[48:63], a[104:107], a[72:75], v[48:63]
    ds_read_b128 a[96:99], v10 offset:40960
    v_exp_f32 v29, v65
    v_exp_f32 v30, v66
    v_cvt_pk_bf16_f32 v112, v28, v29
    v_exp_f32 v31, v67
    s_waitcnt lgkmcnt(4)
    v_mfma_f32_32x32x16_bf16 v[48:63], a[108:111], a[76:79], v[48:63]
    ds_read_b128 a[100:103], v11 offset:40960
    v_exp_f32 v28, v68
    v_cvt_pk_bf16_f32 v113, v30, v31
    v_exp_f32 v29, v69
    v_exp_f32 v30, v70
    v_cvt_pk_bf16_f32 v114, v28, v29
    v_mfma_f32_32x32x16_bf16 v[48:63], a[112:115], a[80:83], v[48:63]
    ds_read_b128 a[104:107], v12 offset:40960
    v_exp_f32 v31, v71
    v_exp_f32 v28, v72
    v_cvt_pk_bf16_f32 v115, v30, v31
    v_exp_f32 v29, v73
    s_waitcnt lgkmcnt(4)
    v_mfma_f32_32x32x16_bf16 v[48:63], a[116:119], a[84:87], v[48:63]
    ds_read_b128 a[108:111], v13 offset:40960
    v_exp_f32 v30, v74
    v_cvt_pk_bf16_f32 v116, v28, v29
    v_exp_f32 v31, v75
    v_exp_f32 v28, v76
    v_cvt_pk_bf16_f32 v117, v30, v31
    v_mfma_f32_32x32x16_bf16 v[48:63], a[120:123], a[88:91], v[48:63]
    ds_read_b32 v21, v22
    ds_read_b128 a[112:115], v14 offset:40960
    v_exp_f32 v29, v77
    v_exp_f32 v30, v78
    v_cvt_pk_bf16_f32 v118, v28, v29
    s_waitcnt lgkmcnt(5)
    v_mfma_f32_32x32x16_bf16 v[192:207], a[92:95], a[60:63], v[80:95]
    ds_read_b128 a[116:119], v15 offset:40960
    v_exp_f32 v31, v79
    s_nop 0
    v_cvt_pk_bf16_f32 v119, v30, v31
    v_max3_f32 v24, v32, v33, v34
    v_max3_f32 v24, v24, v35, v36
    v_max3_f32 v24, v24, v37, v38
    v_max3_f32 v24, v24, v39, v40
    v_max3_f32 v24, v24, v41, v42
    v_mfma_f32_32x32x16_bf16 v[192:207], a[96:99], a[64:67], v[192:207]
    s_waitcnt lgkmcnt(2)
    s_movk_i32 s59, 19
    v_cmp_ge_u32 vcc, s59, v21
    ds_read_b128 a[120:123], v16 offset:40960
    v_max3_f32 v24, v24, v43, v44
    v_max3_f32 v24, v24, v45, v46
    v_max_f32 v24, v24, v47
    v_cmp_lt_f32 s[22:23], 0, v24
    v_mfma_f32_32x32x16_bf16 v[192:207], a[100:103], a[68:71], v[192:207]
    s_getpc_b64 s[44:45]
    s_cbranch_vccnz A_spin
    ds_read_b128 a[92:95], v9 offset:49152
    v_mfma_f32_32x32x16_bf16 v[192:207], a[104:107], a[72:75], v[192:207]
    ds_read_b128 a[96:99], v10 offset:49152
    s_getpc_b64 s[44:45]
    s_cmp_lg_u64 s[22:23], 0
    s_cbranch_scc1 A_raise
    s_waitcnt lgkmcnt(4)
    v_mfma_f32_32x32x16_bf16 v[192:207], a[108:111], a[76:79], v[192:207]
    ds_read_b128 a[100:103], v11 offset:49152
    v_exp_f32 v28, v32
    v_exp_f32 v29, v33
    v_exp_f32 v30, v34
    v_cvt_pk_bf16_f32 v120, v28, v29
    v_mfma_f32_32x32x16_bf16 v[192:207], a[112:115], a[80:83], v[192:207]
    ds_read_b128 a[104:107], v12 offset:49152
    v_exp_f32 v31, v35
    v_exp_f32 v28, v36
    v_cvt_pk_bf16_f32 v121, v30, v31
    v_exp_f32 v29, v37
    s_waitcnt lgkmcnt(4)
    v_mfma_f32_32x32x16_bf16 v[192:207], a[116:119], a[84:87], v[192:207]
    ds_read_b128 a[108:111], v13 offset:49152
    v_exp_f32 v30, v38
    v_cvt_pk_bf16_f32 v122, v28, v29
    v_exp_f32 v31, v39
    v_exp_f32 v28, v40
    v_cvt_pk_bf16_f32 v123, v30, v31
    v_mfma_f32_32x32x16_bf16 v[192:207], a[120:123], a[88:91], v[192:207]
    v_mov_b32 v26, 19
    ds_write_b32 v23, v26
    ds_read_b128 a[112:115], v14 offset:49152
    v_exp_f32 v29, v41
    v_exp_f32 v30, v42
    v_cvt_pk_bf16_f32 v124, v28, v29
    s_waitcnt lgkmcnt(5)
    v_mfma_f32_32x32x16_bf16 v[64:79], a[92:95], a[60:63], v[80:95]
    ds_read_b128 a[116:119], v15 offset:49152
    v_exp_f32 v31, v43
    v_exp_f32 v28, v44
    v_cvt_pk_bf16_f32 v125, v30, v31
    v_exp_f32 v29, v45
    v_mfma_f32_32x32x16_bf16 v[64:79], a[96:99], a[64:67], v[64:79]
    ds_read_b128 a[120:123], v16 offset:49152
    v_exp_f32 v30, v46
    v_cvt_pk_bf16_f32 v126, v28, v29
    v_exp_f32 v31, v47
    s_nop 0
    v_cvt_pk_bf16_f32 v127, v30, v31
    v_max3_f32 v24, v48, v49, v50
    s_waitcnt lgkmcnt(5)
    v_mfma_f32_32x32x16_bf16 v[64:79], a[100:103], a[68:71], v[64:79]
    ds_read_b128 a[92:95], v9 offset:57344
    v_max3_f32 v24, v24, v51, v52
    v_max3_f32 v24, v24, v53, v54
    v_max3_f32 v24, v24, v55, v56
    v_max3_f32 v24, v24, v57, v58
    v_max3_f32 v24, v24, v59, v60
    v_max3_f32 v24, v24, v61, v62
    v_max_f32 v24, v24, v63
    v_cmp_lt_f32 s[22:23], 0, v24
    v_mfma_f32_32x32x16_bf16 v[64:79], a[104:107], a[72:75], v[64:79]
    ds_read_b128 a[96:99], v10 offset:57344
    s_getpc_b64 s[44:45]
    s_cmp_lg_u64 s[22:23], 0
    s_cbranch_scc1 A_raise
    s_waitcnt lgkmcnt(4)
    v_mfma_f32_32x32x16_bf16 v[64:79], a[108:111], a[76:79], v[64:79]
    ds_read_b128 a[100:103], v11 offset:57344
    v_exp_f32 v28, v48
    v_exp_f32 v29, v49
    v_exp_f32 v30, v50
    v_cvt_pk_bf16_f32 v128, v28, v29
    v_mfma_f32_32x32x16_bf16 v[64:79], a[112:115], a[80:83], v[64:79]
    ds_read_b128 a[104:107], v12 offset:57344
    v_exp_f32 v31, v51
    v_exp_f32 v28, v52
    v_cvt_pk_bf16_f32 v129, v30, v31
    v_exp_f32 v29, v53
    s_waitcnt lgkmcnt(4)
    v_mfma_f32_32x32x16_bf16 v[64:79], a[116:119], a[84:87], v[64:79]
    ds_read_b128 a[108:111], v13 offset:57344
    v_exp_f32 v30, v54
    v_cvt_pk_bf16_f32 v130, v28, v29
    v_exp_f32 v31, v55
    v_exp_f32 v28, v56
    v_cvt_pk_bf16_f32 v131, v30, v31
    v_mfma_f32_32x32x16_bf16 v[64:79], a[120:123], a[88:91], v[64:79]
    ds_read_b32 v21, v22
    ds_read_b128 a[112:115], v14 offset:57344
    v_exp_f32 v29, v57
    v_exp_f32 v30, v58
    v_cvt_pk_bf16_f32 v132, v28, v29
    s_waitcnt lgkmcnt(5)
    v_mfma_f32_32x32x16_bf16 v[32:47], a[92:95], a[60:63], v[80:95]
    ds_read_b128 a[116:119], v15 offset:57344
    v_exp_f32 v31, v59
    v_exp_f32 v28, v60
    v_cvt_pk_bf16_f32 v133, v30, v31
    v_exp_f32 v29, v61
    v_mfma_f32_32x32x16_bf16 v[32:47], a[96:99], a[64:67], v[32:47]
    s_waitcnt lgkmcnt(2)
    s_movk_i32 s59, 20
    v_cmp_ge_u32 vcc, s59, v21
    ds_read_b128 a[120:123], v16 offset:57344
    v_exp_f32 v30, v62
    v_cvt_pk_bf16_f32 v134, v28, v29
    v_mfma_f32_32x32x16_bf16 v[32:47], a[100:103], a[68:71], v[32:47]
    s_getpc_b64 s[44:45]
    s_cbranch_vccnz A_spin
    v_add_u32 v9, 0xfffea000, v9
    v_add_u32 v10, 0xfffea000, v10
    v_add_u32 v11, 0xfffea000, v11
    v_add_u32 v12, 0xfffea000, v12
    v_add_u32 v13, 0xfffea000, v13
    v_add_u32 v14, 0xfffea000, v14
    v_add_u32 v15, 0xfffea000, v15
    v_add_u32 v16, 0xfffea000, v16
    ds_read_b128 a[92:95], v9 offset:0
    v_exp_f32 v31, v63
    s_nop 0
    v_cvt_pk_bf16_f32 v135, v30, v31
    v_mfma_f32_32x32x16_bf16 v[32:47], a[104:107], a[72:75], v[32:47]
    ds_read_b128 a[96:99], v10 offset:0
    v_max3_f32 v24, v192, v193, v194
    v_max3_f32 v24, v24, v195, v196
    v_max3_f32 v24, v24, v197, v198
    v_max3_f32 v24, v24, v199, v200
    v_max3_f32 v24, v24, v201, v202
    v_max3_f32 v24, v24, v203, v204
    v_max3_f32 v24, v24, v205, v206
    s_waitcnt lgkmcnt(4)
    v_mfma_f32_32x32x16_bf16 v[32:47], a[108:111], a[76:79], v[32:47]
    ds_read_b128 a[100:103], v11 offset:0
    v_max_f32 v24, v24, v207
    v_cmp_lt_f32 s[22:23], 0, v24
    v_mfma_f32_32x32x16_bf16 v[32:47], a[112:115], a[80:83], v[32:47]
    ds_read_b128 a[104:107], v12 offset:0
    s_getpc_b64 s[44:45]
    s_cmp_lg_u64 s[22:23], 0
    s_cbranch_scc1 A_raise
    v_max3_f32 v24, v64, v65, v66
    s_waitcnt lgkmcnt(4)
    v_mfma_f32_32x32x16_bf16 v[32:47], a[116:119], a[84:87], v[32:47]
    ds_read_b128 a[108:111], v13 offset:0
    v_max3_f32 v24, v24, v67, v68
    v_max3_f32 v24, v24, v69, v70
    v_max3_f32 v24, v24, v71, v72
    v_max3_f32 v24, v24, v73, v74
    v_max3_f32 v24, v24, v75, v76
    v_max3_f32 v24, v24, v77, v78
    v_max_f32 v24, v24, v79
    v_cmp_lt_f32 s[22:23], 0, v24
    v_mfma_f32_32x32x16_bf16 v[32:47], a[120:123], a[88:91], v[32:47]
    v_mov_b32 v26, 20
    ds_write_b32 v23, v26
    ds_read_b128 a[112:115], v14 offset:0
    s_waitcnt lgkmcnt(5)
    v_mfma_f32_32x32x16_bf16 v[48:63], a[92:95], a[60:63], v[80:95]
    ds_read_b128 a[116:119], v15 offset:0
    s_getpc_b64 s[44:45]
    s_cmp_lg_u64 s[22:23], 0
    s_cbranch_scc1 A_raise
    v_exp_f32 v28, v64
    v_mfma_f32_32x32x16_bf16 v[48:63], a[96:99], a[64:67], v[48:63]
    ds_read_b128 a[120:123], v16 offset:0
    v_exp_f32 v29, v65
    v_exp_f32 v30, v66
    v_cvt_pk_bf16_f32 v136, v28, v29
    v_exp_f32 v31, v67
    s_waitcnt lgkmcnt(5)
    v_mfma_f32_32x32x16_bf16 v[48:63], a[100:103], a[68:71], v[48:63]
    ds_read_b128 a[92:95], v9 offset:8192
    v_exp_f32 v28, v68
    v_cvt_pk_bf16_f32 v137, v30, v31
    v_exp_f32 v29, v69
    v_exp_f32 v30, v70
    v_cvt_pk_bf16_f32 v138, v28, v29
    v_mfma_f32_32x32x16_bf16 v[48:63], a[104:107], a[72:75], v[48:63]
    ds_read_b128 a[96:99], v10 offset:8192
    v_exp_f32 v31, v71
    v_exp_f32 v28, v72
    v_cvt_pk_bf16_f32 v139, v30, v31
    v_exp_f32 v29, v73
    s_waitcnt lgkmcnt(4)
    v_mfma_f32_32x32x16_bf16 v[48:63], a[108:111], a[76:79], v[48:63]
    ds_read_b128 a[100:103], v11 offset:8192
    v_exp_f32 v30, v74
    v_cvt_pk_bf16_f32 v140, v28, v29
    v_exp_f32 v31, v75
    v_exp_f32 v28, v76
    v_cvt_pk_bf16_f32 v141, v30, v31
    v_mfma_f32_32x32x16_bf16 v[48:63], a[112:115], a[80:83], v[48:63]
    ds_read_b128 a[104:107], v12 offset:8192
    v_exp_f32 v29, v77
    v_exp_f32 v30, v78
    v_cvt_pk_bf16_f32 v142, v28, v29
    v_exp_f32 v31, v79
    s_waitcnt lgkmcnt(4)
    v_mfma_f32_32x32x16_bf16 v[48:63], a[116:119], a[84:87], v[48:63]
    ds_read_b128 a[108:111], v13 offset:8192
    v_cvt_pk_bf16_f32 v143, v30, v31
    v_max3_f32 v24, v32, v33, v34
    v_max3_f32 v24, v24, v35, v36
    v_max3_f32 v24, v24, v37, v38
    v_max3_f32 v24, v24, v39, v40
    v_max3_f32 v24, v24, v41, v42
    v_max3_f32 v24, v24, v43, v44
    v_max3_f32 v24, v24, v45, v46
    v_mfma_f32_32x32x16_bf16 v[48:63], a[120:123], a[88:91], v[48:63]
    ds_read_b32 v21, v22
    ds_read_b128 a[112:115], v14 offset:8192
    v_max_f32 v24, v24, v47
    v_cmp_lt_f32 s[22:23], 0, v24
    s_waitcnt lgkmcnt(5)
    v_mfma_f32_32x32x16_bf16 v[64:79], a[92:95], a[60:63], v[80:95]
    ds_read_b128 a[116:119], v15 offset:8192
    s_getpc_b64 s[44:45]
    s_cmp_lg_u64 s[22:23], 0
    s_cbranch_scc1 A_raise
    v_exp_f32 v28, v32
    v_mfma_f32_32x32x16_bf16 v[64:79], a[96:99], a[64:67], v[64:79]
    s_waitcnt lgkmcnt(2)
    s_movk_i32 s59, 21
    v_cmp_ge_u32 vcc, s59, v21
    ds_read_b128 a[120:123], v16 offset:8192
    v_exp_f32 v29, v33
    v_exp_f32 v30, v34
    v_mfma_f32_32x32x16_bf16 v[64:79], a[100:103], a[68:71], v[64:79]
    s_getpc_b64 s[44:45]
    s_cbranch_vccnz A_spin
    ds_read_b128 a[92:95], v9 offset:16384
    v_cvt_pk_bf16_f32 v144, v28, v29
    v_exp_f32 v31, v35
    v_mfma_f32_32x32x16_bf16 v[64:79], a[104:107], a[72:75], v[64:79]
    ds_read_b128 a[96:99], v10 offset:16384
    v_exp_f32 v28, v36
    v_cvt_pk_bf16_f32 v145, v30, v31
    v_exp_f32 v29, v37
    v_exp_f32 v30, v38
    s_waitcnt lgkmcnt(4)
    v_mfma_f32_32x32x16_bf16 v[64:79], a[108:111], a[76:79], v[64:79]
    ds_read_b128 a[100:103], v11 offset:16384
    v_cvt_pk_bf16_f32 v146, v28, v29
    v_exp_f32 v31, v39
    v_exp_f32 v28, v40
    v_cvt_pk_bf16_f32 v147, v30, v31
    v_exp_f32 v29, v41
    v_mfma_f32_32x32x16_bf16 v[64:79], a[112:115], a[80:83], v[64:79]
    ds_read_b128 a[104:107], v12 offset:16384
    v_exp_f32 v30, v42
    v_cvt_pk_bf16_f32 v148, v28, v29
    v_exp_f32 v31, v43
    v_exp_f32 v28, v44
    s_waitcnt lgkmcnt(4)
    v_mfma_f32_32x32x16_bf16 v[64:79], a[116:119], a[84:87], v[64:79]
    ds_read_b128 a[108:111], v13 offset:16384
    v_cvt_pk_bf16_f32 v149, v30, v31
    v_exp_f32 v29, v45
    v_exp_f32 v30, v46
    v_cvt_pk_bf16_f32 v150, v28, v29
    v_exp_f32 v31, v47
    v_mfma_f32_32x32x16_bf16 v[64:79], a[120:123], a[88:91], v[64:79]
    v_mov_b32 v26, 21
    ds_write_b32 v23, v26
    ds_read_b128 a[112:115], v14 offset:16384
    v_cvt_pk_bf16_f32 v151, v30, v31
    v_max3_f32 v24, v48, v49, v50
    v_max3_f32 v24, v24, v51, v52
    v_max3_f32 v24, v24, v53, v54
    v_max3_f32 v24, v24, v55, v56
    s_waitcnt lgkmcnt(5)
    v_mfma_f32_32x32x16_bf16 v[208:223], a[92:95], a[60:63], v[80:95]
    ds_read_b128 a[116:119], v15 offset:16384
    v_max3_f32 v24, v24, v57, v58
    v_max3_f32 v24, v24, v59, v60
    v_max3_f32 v24, v24, v61, v62
    v_max_f32 v24, v24, v63
    v_cmp_lt_f32 s[22:23], 0, v24
    v_mfma_f32_32x32x16_bf16 v[208:223], a[96:99], a[64:67], v[208:223]
    ds_read_b128 a[120:123], v16 offset:16384
    s_getpc_b64 s[44:45]
    s_cmp_lg_u64 s[22:23], 0
    s_cbranch_scc1 A_raise
    s_waitcnt lgkmcnt(5)
    v_mfma_f32_32x32x16_bf16 v[208:223], a[100:103], a[68:71], v[208:223]
    ds_read_b128 a[92:95], v9 offset:24576
    v_exp_f32 v28, v48
    v_exp_f32 v29, v49
    v_exp_f32 v30, v50
    v_cvt_pk_bf16_f32 v152, v28, v29
    v_mfma_f32_32x32x16_bf16 v[208:223], a[104:107], a[72:75], v[208:223]
    ds_read_b128 a[96:99], v10 offset:24576
    v_exp_f32 v31, v51
    v_exp_f32 v28, v52
    v_cvt_pk_bf16_f32 v153, v30, v31
    v_exp_f32 v29, v53
    s_waitcnt lgkmcnt(4)
    v_mfma_f32_32x32x16_bf16 v[208:223], a[108:111], a[76:79], v[208:223]
    ds_read_b128 a[100:103], v11 offset:24576
    v_exp_f32 v30, v54
    v_cvt_pk_bf16_f32 v154, v28, v29
    v_exp_f32 v31, v55
    v_exp_f32 v28, v56
    v_cvt_pk_bf16_f32 v155, v30, v31
    v_mfma_f32_32x32x16_bf16 v[208:223], a[112:115], a[80:83], v[208:223]
    ds_read_b128 a[104:107], v12 offset:24576
    v_exp_f32 v29, v57
    v_exp_f32 v30, v58
    v_cvt_pk_bf16_f32 v156, v28, v29
    v_exp_f32 v31, v59
    s_waitcnt lgkmcnt(4)
    v_mfma_f32_32x32x16_bf16 v[208:223], a[116:119], a[84:87], v[208:223]
    ds_read_b128 a[108:111], v13 offset:24576
    v_exp_f32 v28, v60
    v_cvt_pk_bf16_f32 v157, v30, v31
    v_exp_f32 v29, v61
    v_exp_f32 v30, v62
    v_cvt_pk_bf16_f32 v158, v28, v29
    v_mfma_f32_32x32x16_bf16 v[208:223], a[120:123], a[88:91], v[208:223]
    ds_read_b32 v21, v22
    ds_read_b128 a[112:115], v14 offset:24576
    v_exp_f32 v31, v63
    s_nop 0
    v_cvt_pk_bf16_f32 v159, v30, v31
    v_max3_f32 v24, v64, v65, v66
    v_max3_f32 v24, v24, v67, v68
    v_max3_f32 v24, v24, v69, v70
    s_waitcnt lgkmcnt(5)
    v_mfma_f32_32x32x16_bf16 v[32:47], a[92:95], a[60:63], v[80:95]
    ds_read_b128 a[116:119], v15 offset:24576
    v_max3_f32 v24, v24, v71, v72
    v_max3_f32 v24, v24, v73, v74
    v_max3_f32 v24, v24, v75, v76
    v_max3_f32 v24, v24, v77, v78
    v_max_f32 v24, v24, v79
    v_cmp_lt_f32 s[22:23], 0, v24
    v_mfma_f32_32x32x16_bf16 v[32:47], a[96:99], a[64:67], v[32:47]
    s_waitcnt lgkmcnt(2)
    s_movk_i32 s59, 22
    v_cmp_ge_u32 vcc, s59, v21
    ds_read_b128 a[120:123], v16 offset:24576
    v_mfma_f32_32x32x16_bf16 v[32:47], a[100:103], a[68:71], v[32:47]
    s_getpc_b64 s[44:45]
    s_cbranch_vccnz A_spin
    ds_read_b128 a[92:95], v9 offset:32768
    v_mfma_f32_32x32x16_bf16 v[32:47], a[104:107], a[72:75], v[32:47]
    ds_read_b128 a[96:99], v10 offset:32768
    s_getpc_b64 s[44:45]
    s_cmp_lg_u64 s[22:23], 0
    s_cbranch_scc1 A_raise
    s_waitcnt lgkmcnt(4)
    v_mfma_f32_32x32x16_bf16 v[32:47], a[108:111], a[76:79], v[32:47]
    ds_read_b128 a[100:103], v11 offset:32768
    v_exp_f32 v28, v64
    v_exp_f32 v29, v65
    v_exp_f32 v30, v66
    v_cvt_pk_bf16_f32 v160, v28, v29
    v_mfma_f32_32x32x16_bf16 v[32:47], a[112:115], a[80:83], v[32:47]
    ds_read_b128 a[104:107], v12 offset:32768
    v_exp_f32 v31, v67
    v_exp_f32 v28, v68
    v_cvt_pk_bf16_f32 v161, v30, v31
    v_exp_f32 v29, v69
    s_waitcnt lgkmcnt(4)
    v_mfma_f32_32x32x16_bf16 v[32:47], a[116:119], a[84:87], v[32:47]
    ds_read_b128 a[108:111], v13 offset:32768
    v_exp_f32 v30, v70
    v_cvt_pk_bf16_f32 v162, v28, v29
    v_exp_f32 v31, v71
    v_exp_f32 v28, v72
    v_cvt_pk_bf16_f32 v163, v30, v31
    v_mfma_f32_32x32x16_bf16 v[32:47], a[120:123], a[88:91], v[32:47]
    v_mov_b32 v26, 22
    ds_write_b32 v23, v26
    ds_read_b128 a[112:115], v14 offset:32768
    v_exp_f32 v29, v73
    v_exp_f32 v30, v74
    v_cvt_pk_bf16_f32 v164, v28, v29
    s_waitcnt lgkmcnt(5)
    v_mfma_f32_32x32x16_bf16 v[48:63], a[92:95], a[60:63], v[80:95]
    ds_read_b128 a[116:119], v15 offset:32768
    v_exp_f32 v31, v75
    v_exp_f32 v28, v76
    v_cvt_pk_bf16_f32 v165, v30, v31
    v_exp_f32 v29, v77
    v_mfma_f32_32x32x16_bf16 v[48:63], a[96:99], a[64:67], v[48:63]
    ds_read_b128 a[120:123], v16 offset:32768
    v_exp_f32 v30, v78
    v_cvt_pk_bf16_f32 v166, v28, v29
    v_exp_f32 v31, v79
    s_nop 0
    v_cvt_pk_bf16_f32 v167, v30, v31
    v_max3_f32 v24, v208, v209, v210
    s_waitcnt lgkmcnt(5)
    v_mfma_f32_32x32x16_bf16 v[48:63], a[100:103], a[68:71], v[48:63]
    ds_read_b128 a[92:95], v9 offset:40960
    v_max3_f32 v24, v24, v211, v212
    v_max3_f32 v24, v24, v213, v214
    v_max3_f32 v24, v24, v215, v216
    v_max3_f32 v24, v24, v217, v218
    v_max3_f32 v24, v24, v219, v220
    v_max3_f32 v24, v24, v221, v222
    v_max_f32 v24, v24, v223
    v_cmp_lt_f32 s[22:23], 0, v24
    v_mfma_f32_32x32x16_bf16 v[48:63], a[104:107], a[72:75], v[48:63]
    ds_read_b128 a[96:99], v10 offset:40960
    s_getpc_b64 s[44:45]
    s_cmp_lg_u64 s[22:23], 0
    s_cbranch_scc1 A_raise
    v_max3_f32 v24, v32, v33, v34
    s_waitcnt lgkmcnt(4)
    v_mfma_f32_32x32x16_bf16 v[48:63], a[108:111], a[76:79], v[48:63]
    ds_read_b128 a[100:103], v11 offset:40960
    v_max3_f32 v24, v24, v35, v36
    v_max3_f32 v24, v24, v37, v38
    v_max3_f32 v24, v24, v39, v40
    v_max3_f32 v24, v24, v41, v42
    v_max3_f32 v24, v24, v43, v44
    v_max3_f32 v24, v24, v45, v46
    v_max_f32 v24, v24, v47
    v_cmp_lt_f32 s[22:23], 0, v24
    v_mfma_f32_32x32x16_bf16 v[48:63], a[112:115], a[80:83], v[48:63]
    ds_read_b128 a[104:107], v12 offset:40960
    s_getpc_b64 s[44:45]
    s_cmp_lg_u64 s[22:23], 0
    s_cbranch_scc1 A_raise
    s_waitcnt lgkmcnt(4)
    v_mfma_f32_32x32x16_bf16 v[48:63], a[116:119], a[84:87], v[48:63]
    ds_read_b128 a[108:111], v13 offset:40960
    v_exp_f32 v28, v32
    v_exp_f32 v29, v33
    v_exp_f32 v30, v34
    v_cvt_pk_bf16_f32 v168, v28, v29
    v_mfma_f32_32x32x16_bf16 v[48:63], a[120:123], a[88:91], v[48:63]
    ds_read_b32 v21, v22
    ds_read_b128 a[112:115], v14 offset:40960
    v_exp_f32 v31, v35
    v_exp_f32 v28, v36
    v_cvt_pk_bf16_f32 v169, v30, v31
    s_waitcnt lgkmcnt(5)
    v_mfma_f32_32x32x16_bf16 v[64:79], a[92:95], a[60:63], v[80:95]
    ds_read_b128 a[116:119], v15 offset:40960
    v_exp_f32 v29, v37
    v_exp_f32 v30, v38
    v_cvt_pk_bf16_f32 v170, v28, v29
    v_exp_f32 v31, v39
    v_mfma_f32_32x32x16_bf16 v[64:79], a[96:99], a[64:67], v[64:79]
    s_waitcnt lgkmcnt(2)
    s_movk_i32 s59, 23
    v_cmp_ge_u32 vcc, s59, v21
    ds_read_b128 a[120:123], v16 offset:40960
    v_exp_f32 v28, v40
    v_cvt_pk_bf16_f32 v171, v30, v31
    v_mfma_f32_32x32x16_bf16 v[64:79], a[100:103], a[68:71], v[64:79]
    s_getpc_b64 s[44:45]
    s_cbranch_vccnz A_spin
    ds_read_b128 a[92:95], v9 offset:49152
    v_exp_f32 v29, v41
    v_mfma_f32_32x32x16_bf16 v[64:79], a[104:107], a[72:75], v[64:79]
    ds_read_b128 a[96:99], v10 offset:49152
    v_exp_f32 v30, v42
    v_cvt_pk_bf16_f32 v172, v28, v29
    v_exp_f32 v31, v43
    v_exp_f32 v28, v44
    s_waitcnt lgkmcnt(4)
    v_mfma_f32_32x32x16_bf16 v[64:79], a[108:111], a[76:79], v[64:79]
    ds_read_b128 a[100:103], v11 offset:49152
    v_cvt_pk_bf16_f32 v173, v30, v31
    v_exp_f32 v29, v45
    v_exp_f32 v30, v46
    v_cvt_pk_bf16_f32 v174, v28, v29
    v_exp_f32 v31, v47
    v_mfma_f32_32x32x16_bf16 v[64:79], a[112:115], a[80:83], v[64:79]
    ds_read_b128 a[104:107], v12 offset:49152
    v_cvt_pk_bf16_f32 v175, v30, v31
    v_max3_f32 v24, v48, v49, v50
    v_max3_f32 v24, v24, v51, v52
    v_max3_f32 v24, v24, v53, v54
    v_max3_f32 v24, v24, v55, v56
    v_max3_f32 v24, v24, v57, v58
    v_max3_f32 v24, v24, v59, v60
    s_waitcnt lgkmcnt(4)
    v_mfma_f32_32x32x16_bf16 v[64:79], a[116:119], a[84:87], v[64:79]
    ds_read_b128 a[108:111], v13 offset:49152
    v_max3_f32 v24, v24, v61, v62
    v_max_f32 v24, v24, v63
    v_cmp_lt_f32 s[22:23], 0, v24
    v_mfma_f32_32x32x16_bf16 v[64:79], a[120:123], a[88:91], v[64:79]
    v_mov_b32 v26, 23
    ds_write_b32 v23, v26
    ds_read_b128 a[112:115], v14 offset:49152
    s_waitcnt lgkmcnt(5)
    v_mfma_f32_32x32x16_bf16 v[224:239], a[92:95], a[60:63], v[80:95]
    ds_read_b128 a[116:119], v15 offset:49152
    s_getpc_b64 s[44:45]
    s_cmp_lg_u64 s[22:23], 0
    s_cbranch_scc1 A_raise
    v_exp_f32 v28, v48
    v_mfma_f32_32x32x16_bf16 v[224:239], a[96:99], a[64:67], v[224:239]
    ds_read_b128 a[120:123], v16 offset:49152
    v_exp_f32 v29, v49
    v_exp_f32 v30, v50
    v_cvt_pk_bf16_f32 v176, v28, v29
    v_exp_f32 v31, v51
    s_waitcnt lgkmcnt(5)
    v_mfma_f32_32x32x16_bf16 v[224:239], a[100:103], a[68:71], v[224:239]
    ds_read_b128 a[92:95], v9 offset:57344
    v_exp_f32 v28, v52
    v_cvt_pk_bf16_f32 v177, v30, v31
    v_exp_f32 v29, v53
    v_exp_f32 v30, v54
    v_cvt_pk_bf16_f32 v178, v28, v29
    v_mfma_f32_32x32x16_bf16 v[224:239], a[104:107], a[72:75], v[224:239]
    ds_read_b128 a[96:99], v10 offset:57344
    v_exp_f32 v31, v55
    v_exp_f32 v28, v56
    v_cvt_pk_bf16_f32 v179, v30, v31
    v_exp_f32 v29, v57
    s_waitcnt lgkmcnt(4)
    v_mfma_f32_32x32x16_bf16 v[224:239], a[108:111], a[76:79], v[224:239]
    ds_read_b128 a[100:103], v11 offset:57344
    v_exp_f32 v30, v58
    v_cvt_pk_bf16_f32 v180, v28, v29
    v_exp_f32 v31, v59
    v_exp_f32 v28, v60
    v_cvt_pk_bf16_f32 v181, v30, v31
    v_mfma_f32_32x32x16_bf16 v[224:239], a[112:115], a[80:83], v[224:239]
    ds_read_b128 a[104:107], v12 offset:57344
    v_exp_f32 v29, v61
    v_exp_f32 v30, v62
    v_cvt_pk_bf16_f32 v182, v28, v29
    v_exp_f32 v31, v63
    s_waitcnt lgkmcnt(4)
    v_mfma_f32_32x32x16_bf16 v[224:239], a[116:119], a[84:87], v[224:239]
    ds_read_b128 a[108:111], v13 offset:57344
    v_cvt_pk_bf16_f32 v183, v30, v31
    v_max3_f32 v24, v64, v65, v66
    v_max3_f32 v24, v24, v67, v68
    v_max3_f32 v24, v24, v69, v70
    v_max3_f32 v24, v24, v71, v72
    v_max3_f32 v24, v24, v73, v74
    v_max3_f32 v24, v24, v75, v76
    v_max3_f32 v24, v24, v77, v78
    v_mfma_f32_32x32x16_bf16 v[224:239], a[120:123], a[88:91], v[224:239]
    ds_read_b128 a[112:115], v14 offset:57344
    v_max_f32 v24, v24, v79
    v_cmp_lt_f32 s[22:23], 0, v24
    s_waitcnt lgkmcnt(4)
    v_mfma_f32_32x32x16_bf16 v[240:255], a[92:95], a[60:63], v[80:95]
    ds_read_b128 a[116:119], v15 offset:57344
    s_getpc_b64 s[44:45]
    s_cmp_lg_u64 s[22:23], 0
    s_cbranch_scc1 A_raise
    v_exp_f32 v28, v64
    v_mfma_f32_32x32x16_bf16 v[240:255], a[96:99], a[64:67], v[240:255]
    ds_read_b128 a[120:123], v16 offset:57344
    v_exp_f32 v29, v65
    v_exp_f32 v30, v66
    v_cvt_pk_bf16_f32 v184, v28, v29
    v_exp_f32 v31, v67
    s_waitcnt lgkmcnt(4)
    v_mfma_f32_32x32x16_bf16 v[240:255], a[100:103], a[68:71], v[240:255]
    v_exp_f32 v28, v68
    v_cvt_pk_bf16_f32 v185, v30, v31
    v_exp_f32 v29, v69
    v_exp_f32 v30, v70
    v_cvt_pk_bf16_f32 v186, v28, v29
    v_mfma_f32_32x32x16_bf16 v[240:255], a[104:107], a[72:75], v[240:255]
    v_exp_f32 v31, v71
    v_exp_f32 v28, v72
    v_cvt_pk_bf16_f32 v187, v30, v31
    v_exp_f32 v29, v73
    s_waitcnt lgkmcnt(2)
    v_mfma_f32_32x32x16_bf16 v[240:255], a[108:111], a[76:79], v[240:255]
    v_exp_f32 v30, v74
    v_cvt_pk_bf16_f32 v188, v28, v29
    v_exp_f32 v31, v75
    v_exp_f32 v28, v76
    v_cvt_pk_bf16_f32 v189, v30, v31
    v_mfma_f32_32x32x16_bf16 v[240:255], a[112:115], a[80:83], v[240:255]
    v_exp_f32 v29, v77
    v_exp_f32 v30, v78
    v_cvt_pk_bf16_f32 v190, v28, v29
    v_exp_f32 v31, v79
    s_nop 0
    v_cvt_pk_bf16_f32 v191, v30, v31
    s_waitcnt lgkmcnt(0)
    v_mfma_f32_32x32x16_bf16 v[240:255], a[116:119], a[84:87], v[240:255]
    v_max3_f32 v24, v224, v225, v226
    v_max3_f32 v24, v24, v227, v228
    v_max3_f32 v24, v24, v229, v230
    v_max3_f32 v24, v24, v231, v232
    v_max3_f32 v24, v24, v233, v234
    v_max3_f32 v24, v24, v235, v236
    v_max3_f32 v24, v24, v237, v238
    v_max_f32 v24, v24, v239
    v_cmp_lt_f32 s[22:23], 0, v24
    v_mfma_f32_32x32x16_bf16 v[240:255], a[120:123], a[88:91], v[240:255]
    v_mov_b32 v26, 24
    ds_write_b32 v23, v26
    s_getpc_b64 s[44:45]
    s_cmp_lg_u64 s[22:23], 0
    s_cbranch_scc1 A_raise
    s_nop 6
    v_max3_f32 v24, v240, v241, v242
    v_max3_f32 v24, v24, v243, v244
    v_max3_f32 v24, v24, v245, v246
    v_max3_f32 v24, v24, v247, v248
    v_max3_f32 v24, v24, v249, v250
    v_max3_f32 v24, v24, v251, v252
    v_max3_f32 v24, v24, v253, v254
    v_max_f32 v24, v24, v255
    v_cmp_lt_f32 s[22:23], 0, v24
    s_getpc_b64 s[44:45]
    s_cmp_lg_u64 s[22:23], 0
    s_cbranch_scc1 A_raise
    s_and_b32 s39, s56, 255
    ds_read_b32 v21, v22
    s_waitcnt lgkmcnt(0)
    s_movk_i32 s59, 24
    v_cmp_ge_u32 vcc, s59, v21
    s_getpc_b64 s[44:45]
    s_cbranch_vccnz A_spin
    ds_read_b64_tr_b16 a[0:1], v17 offset:0
    ds_read_b64_tr_b16 a[2:3], v17 offset:1024
    ds_read_b64_tr_b16 a[4:5], v18 offset:0
    ds_read_b64_tr_b16 a[6:7], v18 offset:1024
    ds_read_b64_tr_b16 a[8:9], v17 offset:2048
    ds_read_b64_tr_b16 a[10:11], v17 offset:3072
    ds_read_b64_tr_b16 a[12:13], v18 offset:2048
    ds_read_b64_tr_b16 a[14:15], v18 offset:3072
    v_mfma_f32_16x16x32_bf16 a[124:127], a[128:131], v[96:99], 0
    s_waitcnt lgkmcnt(4)
    v_mfma_f32_32x32x16_bf16 v[32:47], a[0:3], v[96:99], 0
    ds_read_b64_tr_b16 a[16:17], v17 offset:4096
    ds_read_b64_tr_b16 a[18:19], v17 offset:5120
    v_exp_f32 v192, v192
    v_exp_f32 v193, v193
    v_mfma_f32_32x32x16_bf16 v[48:63], a[4:7], v[96:99], 0
    ds_read_b64_tr_b16 a[20:21], v18 offset:4096
    ds_read_b64_tr_b16 a[22:23], v18 offset:5120
    v_exp_f32 v194, v194
    v_cvt_pk_bf16_f32 v192, v192, v193
    v_mfma_f32_16x16x32_bf16 a[124:127], a[128:131], v[100:103], a[124:127]
    s_waitcnt lgkmcnt(4)
    v_mfma_f32_32x32x16_bf16 v[32:47], a[8:11], v[100:103], v[32:47]
    ds_read_b64_tr_b16 a[24:25], v17 offset:6144
    ds_read_b64_tr_b16 a[26:27], v17 offset:7168
    v_exp_f32 v195, v195
    v_exp_f32 v196, v196
    v_mfma_f32_32x32x16_bf16 v[48:63], a[12:15], v[100:103], v[48:63]
    ds_read_b64_tr_b16 a[28:29], v18 offset:6144
    ds_read_b64_tr_b16 a[30:31], v18 offset:7168
    v_cvt_pk_bf16_f32 v193, v194, v195
    v_exp_f32 v197, v197
    v_mfma_f32_16x16x32_bf16 a[124:127], a[128:131], v[104:107], a[124:127]
    s_waitcnt lgkmcnt(4)
    v_mfma_f32_32x32x16_bf16 v[32:47], a[16:19], v[104:107], v[32:47]
    ds_read_b64_tr_b16 a[0:1], v17 offset:8192
    ds_read_b64_tr_b16 a[2:3], v17 offset:9216
    v_exp_f32 v198, v198
    v_cvt_pk_bf16_f32 v194, v196, v197
    v_mfma_f32_32x32x16_bf16 v[48:63], a[20:23], v[104:107], v[48:63]
    ds_read_b64_tr_b16 a[4:5], v18 offset:8192
    ds_read_b64_tr_b16 a[6:7], v18 offset:9216
    v_exp_f32 v199, v199
    v_exp_f32 v200, v200
    v_mfma_f32_16x16x32_bf16 a[124:127], a[128:131], v[108:111], a[124:127]
    v_cvt_pk_bf16_f32 v195, v198, v199
    s_waitcnt lgkmcnt(4)
    v_mfma_f32_32x32x16_bf16 v[32:47], a[24:27], v[108:111], v[32:47]
    ds_read_b64_tr_b16 a[8:9], v17 offset:10240
    ds_read_b64_tr_b16 a[10:11], v17 offset:11264
    v_exp_f32 v201, v201
    v_exp_f32 v202, v202
    v_mfma_f32_32x32x16_bf16 v[48:63], a[28:31], v[108:111], v[48:63]
    ds_read_b64_tr_b16 a[12:13], v18 offset:10240
    ds_read_b64_tr_b16 a[14:15], v18 offset:11264
    v_cvt_pk_bf16_f32 v196, v200, v201
    v_exp_f32 v203, v203
    v_mfma_f32_16x16x32_bf16 a[124:127], a[128:131], v[112:115], a[124:127]
    s_waitcnt lgkmcnt(4)
    v_mfma_f32_32x32x16_bf16 v[32:47], a[0:3], v[112:115], v[32:47]
    ds_read_b64_tr_b16 a[16:17], v17 offset:12288
    ds_read_b64_tr_b16 a[18:19], v17 offset:13312
    v_exp_f32 v204, v204
    v_cvt_pk_bf16_f32 v197, v202, v203
    v_mfma_f32_32x32x16_bf16 v[48:63], a[4:7], v[112:115], v[48:63]
    ds_read_b64_tr_b16 a[20:21], v18 offset:12288
    ds_read_b64_tr_b16 a[22:23], v18 offset:13312
    v_exp_f32 v205, v205
    v_exp_f32 v206, v206
    v_mfma_f32_16x16x32_bf16 a[124:127], a[128:131], v[116:119], a[124:127]
    v_cvt_pk_bf16_f32 v198, v204, v205
    s_waitcnt lgkmcnt(4)
    v_mfma_f32_32x32x16_bf16 v[32:47], a[8:11], v[116:119], v[32:47]
    ds_read_b32 v21, v22
    ds_read_b64_tr_b16 a[24:25], v17 offset:14336
    ds_read_b64_tr_b16 a[26:27], v17 offset:15360
    v_exp_f32 v207, v207
    s_nop 0
    v_cvt_pk_bf16_f32 v199, v206, v207
    v_mfma_f32_32x32x16_bf16 v[48:63], a[12:15], v[116:119], v[48:63]
    ds_read_b64_tr_b16 a[28:29], v18 offset:14336
    ds_read_b64_tr_b16 a[30:31], v18 offset:15360
    v_exp_f32 v208, v208
    v_exp_f32 v209, v209
    v_mfma_f32_16x16x32_bf16 a[124:127], a[128:131], v[120:123], a[124:127]
    s_waitcnt lgkmcnt(4)
    s_movk_i32 s59, 25
    v_cmp_ge_u32 vcc, s59, v21
    v_mfma_f32_32x32x16_bf16 v[32:47], a[16:19], v[120:123], v[32:47]
    s_getpc_b64 s[44:45]
    s_cbranch_vccnz A_spin
    v_add_u32 v17, s89, v17
    ds_read_b64_tr_b16 a[0:1], v17 offset:0
    ds_read_b64_tr_b16 a[2:3], v17 offset:1024
    v_mfma_f32_32x32x16_bf16 v[48:63], a[20:23], v[120:123], v[48:63]
    v_add_u32 v18, s89, v18
    ds_read_b64_tr_b16 a[4:5], v18 offset:0
    ds_read_b64_tr_b16 a[6:7], v18 offset:1024
    v_exp_f32 v210, v210
    v_cvt_pk_bf16_f32 v208, v208, v209
    v_mfma_f32_16x16x32_bf16 a[124:127], a[128:131], v[124:127], a[124:127]
    s_waitcnt lgkmcnt(4)
    v_mfma_f32_32x32x16_bf16 v[32:47], a[24:27], v[124:127], v[32:47]
    ds_read_b64_tr_b16 a[8:9], v17 offset:2048
    ds_read_b64_tr_b16 a[10:11], v17 offset:3072
    v_exp_f32 v211, v211
    v_exp_f32 v212, v212
    v_mfma_f32_32x32x16_bf16 v[48:63], a[28:31], v[124:127], v[48:63]
    v_mov_b32 v26, 25
    ds_write_b32 v23, v26
    ds_read_b64_tr_b16 a[12:13], v18 offset:2048
    ds_read_b64_tr_b16 a[14:15], v18 offset:3072
    v_cvt_pk_bf16_f32 v209, v210, v211
    v_mfma_f32_16x16x32_bf16 a[124:127], a[128:131], v[128:131], a[124:127]
    s_waitcnt lgkmcnt(5)
    v_mfma_f32_32x32x16_bf16 v[32:47], a[0:3], v[128:131], v[32:47]
    ds_read_b64_tr_b16 a[16:17], v17 offset:4096
    ds_read_b64_tr_b16 a[18:19], v17 offset:5120
    v_exp_f32 v213, v213
    v_exp_f32 v214, v214
    v_mfma_f32_32x32x16_bf16 v[48:63], a[4:7], v[128:131], v[48:63]
    ds_read_b64_tr_b16 a[20:21], v18 offset:4096
    ds_read_b64_tr_b16 a[22:23], v18 offset:5120
    v_cvt_pk_bf16_f32 v210, v212, v213
    v_exp_f32 v215, v215
    v_mfma_f32_16x16x32_bf16 a[124:127], a[128:131], v[132:135], a[124:127]
    s_waitcnt lgkmcnt(4)
    v_mfma_f32_32x32x16_bf16 v[32:47], a[8:11], v[132:135], v[32:47]
    ds_read_b64_tr_b16 a[24:25], v17 offset:6144
    ds_read_b64_tr_b16 a[26:27], v17 offset:7168
    v_exp_f32 v216, v216
    v_cvt_pk_bf16_f32 v211, v214, v215
    v_mfma_f32_32x32x16_bf16 v[48:63], a[12:15], v[132:135], v[48:63]
    ds_read_b64_tr_b16 a[28:29], v18 offset:6144
    ds_read_b64_tr_b16 a[30:31], v18 offset:7168
    v_exp_f32 v217, v217
    v_exp_f32 v218, v218
    v_mfma_f32_16x16x32_bf16 a[124:127], a[128:131], v[192:195], a[124:127]
    v_cvt_pk_bf16_f32 v212, v216, v217
    s_waitcnt lgkmcnt(4)
    v_mfma_f32_32x32x16_bf16 v[32:47], a[16:19], v[192:195], v[32:47]
    ds_read_b64_tr_b16 a[0:1], v17 offset:8192
    ds_read_b64_tr_b16 a[2:3], v17 offset:9216
    v_exp_f32 v219, v219
    v_exp_f32 v220, v220
    v_mfma_f32_32x32x16_bf16 v[48:63], a[20:23], v[192:195], v[48:63]
    ds_read_b64_tr_b16 a[4:5], v18 offset:8192
    ds_read_b64_tr_b16 a[6:7], v18 offset:9216
    v_cvt_pk_bf16_f32 v213, v218, v219
    v_exp_f32 v221, v221
    v_mfma_f32_16x16x32_bf16 a[124:127], a[128:131], v[196:199], a[124:127]
    s_waitcnt lgkmcnt(4)
    v_mfma_f32_32x32x16_bf16 v[32:47], a[24:27], v[196:199], v[32:47]
    ds_read_b64_tr_b16 a[8:9], v17 offset:10240
    ds_read_b64_tr_b16 a[10:11], v17 offset:11264
    v_exp_f32 v222, v222
    v_cvt_pk_bf16_f32 v214, v220, v221
    v_mfma_f32_32x32x16_bf16 v[48:63], a[28:31], v[196:199], v[48:63]
    ds_read_b64_tr_b16 a[12:13], v18 offset:10240
    ds_read_b64_tr_b16 a[14:15], v18 offset:11264
    v_exp_f32 v223, v223
    s_nop 0
    v_cvt_pk_bf16_f32 v215, v222, v223
    v_mfma_f32_16x16x32_bf16 a[124:127], a[128:131], v[136:139], a[124:127]
    s_waitcnt lgkmcnt(4)
    v_mfma_f32_32x32x16_bf16 v[32:47], a[0:3], v[136:139], v[32:47]
    ds_read_b64_tr_b16 a[16:17], v17 offset:12288
    ds_read_b64_tr_b16 a[18:19], v17 offset:13312
    v_exp_f32 v224, v224
    v_exp_f32 v225, v225
    v_mfma_f32_32x32x16_bf16 v[48:63], a[4:7], v[136:139], v[48:63]
    ds_read_b64_tr_b16 a[20:21], v18 offset:12288
    ds_read_b64_tr_b16 a[22:23], v18 offset:13312
    v_exp_f32 v226, v226
    v_cvt_pk_bf16_f32 v224, v224, v225
    v_mfma_f32_16x16x32_bf16 a[124:127], a[128:131], v[140:143], a[124:127]
    s_waitcnt lgkmcnt(4)
    v_mfma_f32_32x32x16_bf16 v[32:47], a[8:11], v[140:143], v[32:47]
    ds_read_b32 v21, v22
    ds_read_b64_tr_b16 a[24:25], v17 offset:14336
    ds_read_b64_tr_b16 a[26:27], v17 offset:15360
    v_exp_f32 v227, v227
    v_mfma_f32_32x32x16_bf16 v[48:63], a[12:15], v[140:143], v[48:63]
    ds_read_b64_tr_b16 a[28:29], v18 offset:14336
    ds_read_b64_tr_b16 a[30:31], v18 offset:15360
    v_exp_f32 v228, v228
    v_cvt_pk_bf16_f32 v225, v226, v227
    v_mfma_f32_16x16x32_bf16 a[124:127], a[128:131], v[144:147], a[124:127]
    s_waitcnt lgkmcnt(4)
    s_movk_i32 s59, 26
    v_cmp_ge_u32 vcc, s59, v21
    v_mfma_f32_32x32x16_bf16 v[32:47], a[16:19], v[144:147], v[32:47]
    s_getpc_b64 s[44:45]
    s_cbranch_vccnz A_spin
    v_add_u32 v17, s90, v17
    ds_read_b64_tr_b16 a[0:1], v17 offset:0
    ds_read_b64_tr_b16 a[2:3], v17 offset:1024
    v_mfma_f32_32x32x16_bf16 v[48:63], a[20:23], v[144:147], v[48:63]
    v_add_u32 v18, s90, v18
    ds_read_b64_tr_b16 a[4:5], v18 offset:0
    ds_read_b64_tr_b16 a[6:7], v18 offset:1024
    v_exp_f32 v229, v229
    v_exp_f32 v230, v230
    v_mfma_f32_16x16x32_bf16 a[124:127], a[128:131], v[148:151], a[124:127]
    v_cvt_pk_bf16_f32 v226, v228, v229
    s_waitcnt lgkmcnt(4)
    v_mfma_f32_32x32x16_bf16 v[32:47], a[24:27], v[148:151], v[32:47]
    ds_read_b64_tr_b16 a[8:9], v17 offset:2048
    ds_read_b64_tr_b16 a[10:11], v17 offset:3072
    v_exp_f32 v231, v231
    v_exp_f32 v232, v232
    v_mfma_f32_32x32x16_bf16 v[48:63], a[28:31], v[148:151], v[48:63]
    v_mov_b32 v26, 26
    ds_write_b32 v23, v26
    ds_read_b64_tr_b16 a[12:13], v18 offset:2048
    ds_read_b64_tr_b16 a[14:15], v18 offset:3072
    v_cvt_pk_bf16_f32 v227, v230, v231
    v_mfma_f32_16x16x32_bf16 a[124:127], a[128:131], v[152:155], a[124:127]
    s_waitcnt lgkmcnt(5)
    v_mfma_f32_32x32x16_bf16 v[32:47], a[0:3], v[152:155], v[32:47]
    ds_read_b64_tr_b16 a[16:17], v17 offset:4096
    ds_read_b64_tr_b16 a[18:19], v17 offset:5120
    v_exp_f32 v233, v233
    v_exp_f32 v234, v234
    v_mfma_f32_32x32x16_bf16 v[48:63], a[4:7], v[152:155], v[48:63]
    ds_read_b64_tr_b16 a[20:21], v18 offset:4096
    ds_read_b64_tr_b16 a[22:23], v18 offset:5120
    v_cvt_pk_bf16_f32 v228, v232, v233
    v_exp_f32 v235, v235
    v_mfma_f32_16x16x32_bf16 a[124:127], a[128:131], v[156:159], a[124:127]
    s_waitcnt lgkmcnt(4)
    v_mfma_f32_32x32x16_bf16 v[32:47], a[8:11], v[156:159], v[32:47]
    ds_read_b64_tr_b16 a[24:25], v17 offset:6144
    ds_read_b64_tr_b16 a[26:27], v17 offset:7168
    v_exp_f32 v236, v236
    v_cvt_pk_bf16_f32 v229, v234, v235
    v_mfma_f32_32x32x16_bf16 v[48:63], a[12:15], v[156:159], v[48:63]
    ds_read_b64_tr_b16 a[28:29], v18 offset:6144
    ds_read_b64_tr_b16 a[30:31], v18 offset:7168
    v_exp_f32 v237, v237
    v_exp_f32 v238, v238
    v_mfma_f32_16x16x32_bf16 a[124:127], a[128:131], v[160:163], a[124:127]
    v_cvt_pk_bf16_f32 v230, v236, v237
    s_waitcnt lgkmcnt(4)
    v_mfma_f32_32x32x16_bf16 v[32:47], a[16:19], v[160:163], v[32:47]
    ds_read_b64_tr_b16 a[0:1], v17 offset:8192
    ds_read_b64_tr_b16 a[2:3], v17 offset:9216
    v_exp_f32 v239, v239
    s_nop 0
    v_cvt_pk_bf16_f32 v231, v238, v239
    v_mfma_f32_32x32x16_bf16 v[48:63], a[20:23], v[160:163], v[48:63]
    ds_read_b64_tr_b16 a[4:5], v18 offset:8192
    ds_read_b64_tr_b16 a[6:7], v18 offset:9216
    v_exp_f32 v240, v240
    v_exp_f32 v241, v241
    v_mfma_f32_16x16x32_bf16 a[124:127], a[128:131], v[164:167], a[124:127]
    s_waitcnt lgkmcnt(4)
    v_mfma_f32_32x32x16_bf16 v[32:47], a[24:27], v[164:167], v[32:47]
    ds_read_b64_tr_b16 a[8:9], v17 offset:10240
    ds_read_b64_tr_b16 a[10:11], v17 offset:11264
    v_exp_f32 v242, v242
    v_cvt_pk_bf16_f32 v240, v240, v241
    v_mfma_f32_32x32x16_bf16 v[48:63], a[28:31], v[164:167], v[48:63]
    ds_read_b64_tr_b16 a[12:13], v18 offset:10240
    ds_read_b64_tr_b16 a[14:15], v18 offset:11264
    v_exp_f32 v243, v243
    v_exp_f32 v244, v244
    v_mfma_f32_16x16x32_bf16 a[124:127], a[128:131], v[208:211], a[124:127]
    v_cvt_pk_bf16_f32 v241, v242, v243
    s_waitcnt lgkmcnt(4)
    v_mfma_f32_32x32x16_bf16 v[32:47], a[0:3], v[208:211], v[32:47]
    ds_read_b64_tr_b16 a[16:17], v17 offset:12288
    ds_read_b64_tr_b16 a[18:19], v17 offset:13312
    v_exp_f32 v245, v245
    v_exp_f32 v246, v246
    v_mfma_f32_32x32x16_bf16 v[48:63], a[4:7], v[208:211], v[48:63]
    ds_read_b64_tr_b16 a[20:21], v18 offset:12288
    ds_read_b64_tr_b16 a[22:23], v18 offset:13312
    v_cvt_pk_bf16_f32 v242, v244, v245
    v_exp_f32 v247, v247
    v_mfma_f32_16x16x32_bf16 a[124:127], a[128:131], v[212:215], a[124:127]
    s_waitcnt lgkmcnt(4)
    v_mfma_f32_32x32x16_bf16 v[32:47], a[8:11], v[212:215], v[32:47]
    ds_read_b32 v21, v22
    ds_read_b64_tr_b16 a[24:25], v17 offset:14336
    ds_read_b64_tr_b16 a[26:27], v17 offset:15360
    v_exp_f32 v248, v248
    v_cvt_pk_bf16_f32 v243, v246, v247
    v_mfma_f32_32x32x16_bf16 v[48:63], a[12:15], v[212:215], v[48:63]
    ds_read_b64_tr_b16 a[28:29], v18 offset:14336
    ds_read_b64_tr_b16 a[30:31], v18 offset:15360
    v_exp_f32 v249, v249
    v_exp_f32 v250, v250
    v_mfma_f32_16x16x32_bf16 a[124:127], a[128:131], v[168:171], a[124:127]
    s_waitcnt lgkmcnt(4)
    s_movk_i32 s59, 27
    v_cmp_ge_u32 vcc, s59, v21
    v_mfma_f32_32x32x16_bf16 v[32:47], a[16:19], v[168:171], v[32:47]
    s_getpc_b64 s[44:45]
    s_cbranch_vccnz A_spin
    v_add_u32 v17, s91, v17
    ds_read_b64_tr_b16 a[0:1], v17 offset:0
    ds_read_b64_tr_b16 a[2:3], v17 offset:1024
    v_mfma_f32_32x32x16_bf16 v[48:63], a[20:23], v[168:171], v[48:63]
    v_add_u32 v18, s91, v18
    ds_read_b64_tr_b16 a[4:5], v18 offset:0
    ds_read_b64_tr_b16 a[6:7], v18 offset:1024
    v_cvt_pk_bf16_f32 v244, v248, v249
    v_exp_f32 v251, v251
    v_mfma_f32_16x16x32_bf16 a[124:127], a[128:131], v[172:175], a[124:127]
    s_waitcnt lgkmcnt(4)
    v_mfma_f32_32x32x16_bf16 v[32:47], a[24:27], v[172:175], v[32:47]
    ds_read_b64_tr_b16 a[8:9], v17 offset:2048
    ds_read_b64_tr_b16 a[10:11], v17 offset:3072
    v_exp_f32 v252, v252
    v_cvt_pk_bf16_f32 v245, v250, v251
    v_mfma_f32_32x32x16_bf16 v[48:63], a[28:31], v[172:175], v[48:63]
    v_mov_b32 v26, 27
    ds_write_b32 v23, v26
    ds_read_b64_tr_b16 a[12:13], v18 offset:2048
    ds_read_b64_tr_b16 a[14:15], v18 offset:3072
    v_exp_f32 v253, v253
    v_mfma_f32_16x16x32_bf16 a[124:127], a[128:131], v[176:179], a[124:127]
    s_waitcnt lgkmcnt(5)
    v_mfma_f32_32x32x16_bf16 v[32:47], a[0:3], v[176:179], v[32:47]
    ds_read_b64_tr_b16 a[16:17], v17 offset:4096
    ds_read_b64_tr_b16 a[18:19], v17 offset:5120
    v_exp_f32 v254, v254
    v_cvt_pk_bf16_f32 v246, v252, v253
    v_mfma_f32_32x32x16_bf16 v[48:63], a[4:7], v[176:179], v[48:63]
    ds_read_b64_tr_b16 a[20:21], v18 offset:4096
    ds_read_b64_tr_b16 a[22:23], v18 offset:5120
    v_exp_f32 v255, v255
    s_nop 0
    v_cvt_pk_bf16_f32 v247, v254, v255
    v_mfma_f32_16x16x32_bf16 a[124:127], a[128:131], v[180:183], a[124:127]
    s_waitcnt lgkmcnt(4)
    v_mfma_f32_32x32x16_bf16 v[32:47], a[8:11], v[180:183], v[32:47]
    ds_read_b64_tr_b16 a[24:25], v17 offset:6144
    ds_read_b64_tr_b16 a[26:27], v17 offset:7168
    v_mfma_f32_32x32x16_bf16 v[48:63], a[12:15], v[180:183], v[48:63]
    ds_read_b64_tr_b16 a[28:29], v18 offset:6144
    ds_read_b64_tr_b16 a[30:31], v18 offset:7168
    v_mfma_f32_16x16x32_bf16 a[124:127], a[128:131], v[184:187], a[124:127]
    s_waitcnt lgkmcnt(4)
    v_mfma_f32_32x32x16_bf16 v[32:47], a[16:19], v[184:187], v[32:47]
    ds_read_b64_tr_b16 a[0:1], v17 offset:8192
    ds_read_b64_tr_b16 a[2:3], v17 offset:9216
    v_mfma_f32_32x32x16_bf16 v[48:63], a[20:23], v[184:187], v[48:63]
    ds_read_b64_tr_b16 a[4:5], v18 offset:8192
    ds_read_b64_tr_b16 a[6:7], v18 offset:9216
    v_mfma_f32_16x16x32_bf16 a[124:127], a[128:131], v[188:191], a[124:127]
    s_waitcnt lgkmcnt(4)
    v_mfma_f32_32x32x16_bf16 v[32:47], a[24:27], v[188:191], v[32:47]
    ds_read_b64_tr_b16 a[8:9], v17 offset:10240
    ds_read_b64_tr_b16 a[10:11], v17 offset:11264
    v_mfma_f32_32x32x16_bf16 v[48:63], a[28:31], v[188:191], v[48:63]
    ds_read_b64_tr_b16 a[12:13], v18 offset:10240
    ds_read_b64_tr_b16 a[14:15], v18 offset:11264
    v_mfma_f32_16x16x32_bf16 a[124:127], a[128:131], v[224:227], a[124:127]
    s_waitcnt lgkmcnt(4)
    v_mfma_f32_32x32x16_bf16 v[32:47], a[0:3], v[224:227], v[32:47]
    ds_read_b64_tr_b16 a[16:17], v17 offset:12288
    ds_read_b64_tr_b16 a[18:19], v17 offset:13312
    v_mfma_f32_32x32x16_bf16 v[48:63], a[4:7], v[224:227], v[48:63]
    ds_read_b64_tr_b16 a[20:21], v18 offset:12288
    ds_read_b64_tr_b16 a[22:23], v18 offset:13312
    v_mfma_f32_16x16x32_bf16 a[124:127], a[128:131], v[228:231], a[124:127]
    ds_read_b32 v21, v22
    s_waitcnt lgkmcnt(5)
    v_mfma_f32_32x32x16_bf16 v[32:47], a[8:11], v[228:231], v[32:47]
    ds_read_b64_tr_b16 a[24:25], v17 offset:14336
    ds_read_b64_tr_b16 a[26:27], v17 offset:15360
    v_mfma_f32_32x32x16_bf16 v[48:63], a[12:15], v[228:231], v[48:63]
    s_waitcnt lgkmcnt(2)
    s_movk_i32 s59, 28
    v_cmp_ge_u32 vcc, s59, v21
    ds_read_b64_tr_b16 a[28:29], v18 offset:14336
    ds_read_b64_tr_b16 a[30:31], v18 offset:15360
    v_mfma_f32_16x16x32_bf16 a[124:127], a[128:131], v[240:243], a[124:127]
    s_getpc_b64 s[44:45]
    s_cbranch_vccnz A_spin
    v_add_u32 v17, s92, v17
    ds_read_b64_tr_b16 a[0:1], v17 offset:0
    ds_read_b64_tr_b16 a[2:3], v17 offset:1024
    v_mfma_f32_32x32x16_bf16 v[32:47], a[16:19], v[240:243], v[32:47]
    v_add_u32 v18, s92, v18
    ds_read_b64_tr_b16 a[4:5], v18 offset:0
    ds_read_b64_tr_b16 a[6:7], v18 offset:1024
    v_mfma_f32_32x32x16_bf16 v[48:63], a[20:23], v[240:243], v[48:63]
    ds_read_b64_tr_b16 a[8:9], v17 offset:2048
    ds_read_b64_tr_b16 a[10:11], v17 offset:3072
    v_mfma_f32_16x16x32_bf16 a[124:127], a[128:131], v[244:247], a[124:127]
    ds_read_b64_tr_b16 a[12:13], v18 offset:2048
    ds_read_b64_tr_b16 a[14:15], v18 offset:3072
    s_waitcnt lgkmcnt(8)
    v_mfma_f32_32x32x16_bf16 v[32:47], a[24:27], v[244:247], v[32:47]
    ds_read_b64_tr_b16 a[16:17], v17 offset:4096
    ds_read_b64_tr_b16 a[18:19], v17 offset:5120
    v_mfma_f32_32x32x16_bf16 v[48:63], a[28:31], v[244:247], v[48:63]
    v_mov_b32 v26, 28
    ds_write_b32 v23, v26
    ds_read_b64_tr_b16 a[20:21], v18 offset:4096
    ds_read_b64_tr_b16 a[22:23], v18 offset:5120
    s_waitcnt lgkmcnt(9)
    v_mfma_f32_32x32x16_bf16 v[64:79], a[0:3], v[96:99], 0
    ds_read_b64_tr_b16 a[24:25], v17 offset:6144
    ds_read_b64_tr_b16 a[26:27], v17 offset:7168
    v_mfma_f32_32x32x16_bf16 v[80:95], a[4:7], v[96:99], 0
    ds_read_b64_tr_b16 a[28:29], v18 offset:6144
    ds_read_b64_tr_b16 a[30:31], v18 offset:7168
    v_accvgpr_read_b32 v28, a124
    v_rcp_f32 v28, v28
    s_waitcnt lgkmcnt(9)
    v_mfma_f32_32x32x16_bf16 v[64:79], a[8:11], v[100:103], v[64:79]
    ds_read_b64_tr_b16 a[0:1], v17 offset:8192
    ds_read_b64_tr_b16 a[2:3], v17 offset:9216
    v_mfma_f32_32x32x16_bf16 v[80:95], a[12:15], v[100:103], v[80:95]
    ds_read_b64_tr_b16 a[4:5], v18 offset:8192
    ds_read_b64_tr_b16 a[6:7], v18 offset:9216
    v_pk_mul_f32 v[32:33], v[32:33], v[28:29] op_sel_hi:[1,0]
    v_pk_mul_f32 v[34:35], v[34:35], v[28:29] op_sel_hi:[1,0]
    v_pk_mul_f32 v[36:37], v[36:37], v[28:29] op_sel_hi:[1,0]
    s_waitcnt lgkmcnt(8)
    v_mfma_f32_32x32x16_bf16 v[64:79], a[16:19], v[104:107], v[64:79]
    ds_read_b64_tr_b16 a[8:9], v17 offset:10240
    ds_read_b64_tr_b16 a[10:11], v17 offset:11264
    v_pk_mul_f32 v[38:39], v[38:39], v[28:29] op_sel_hi:[1,0]
    v_pk_mul_f32 v[40:41], v[40:41], v[28:29] op_sel_hi:[1,0]
    v_pk_mul_f32 v[42:43], v[42:43], v[28:29] op_sel_hi:[1,0]
    v_pk_mul_f32 v[44:45], v[44:45], v[28:29] op_sel_hi:[1,0]
    v_mfma_f32_32x32x16_bf16 v[80:95], a[20:23], v[104:107], v[80:95]
    ds_read_b64_tr_b16 a[12:13], v18 offset:10240
    ds_read_b64_tr_b16 a[14:15], v18 offset:11264
    v_pk_mul_f32 v[46:47], v[46:47], v[28:29] op_sel_hi:[1,0]
    v_cvt_pk_bf16_f32 v32, v32, v33
    v_cvt_pk_bf16_f32 v33, v34, v35
    s_waitcnt lgkmcnt(8)
    v_mfma_f32_32x32x16_bf16 v[64:79], a[24:27], v[108:111], v[64:79]
    ds_read_b64_tr_b16 a[16:17], v17 offset:12288
    ds_read_b64_tr_b16 a[18:19], v17 offset:13312
    v_cvt_pk_bf16_f32 v34, v36, v37
    v_cvt_pk_bf16_f32 v35, v38, v39
    buffer_store_dwordx4 v[32:35], v1, s[40:43], s52 offen offset:0 sc1
    v_cvt_pk_bf16_f32 v36, v40, v41
    v_mfma_f32_32x32x16_bf16 v[80:95], a[28:31], v[108:111], v[80:95]
    ds_read_b32 v21, v22
    ds_read_b64_tr_b16 a[20:21], v18 offset:12288
    ds_read_b64_tr_b16 a[22:23], v18 offset:13312
    v_cvt_pk_bf16_f32 v37, v42, v43
    v_cvt_pk_bf16_f32 v38, v44, v45
    s_waitcnt lgkmcnt(9)
    v_mfma_f32_32x32x16_bf16 v[64:79], a[0:3], v[112:115], v[64:79]
    ds_read_b64_tr_b16 a[24:25], v17 offset:14336
    ds_read_b64_tr_b16 a[26:27], v17 offset:15360
    v_cvt_pk_bf16_f32 v39, v46, v47
    buffer_store_dwordx4 v[36:39], v1, s[40:43], s52 offen offset:1024 sc1
    v_pk_mul_f32 v[48:49], v[48:49], v[28:29] op_sel_hi:[1,0]
    v_pk_mul_f32 v[50:51], v[50:51], v[28:29] op_sel_hi:[1,0]
    v_mfma_f32_32x32x16_bf16 v[80:95], a[4:7], v[112:115], v[80:95]
    s_waitcnt lgkmcnt(4)
    s_movk_i32 s59, 29
    v_cmp_ge_u32 vcc, s59, v21
    ds_read_b64_tr_b16 a[28:29], v18 offset:14336
    ds_read_b64_tr_b16 a[30:31], v18 offset:15360
    v_mfma_f32_32x32x16_bf16 v[64:79], a[8:11], v[116:119], v[64:79]
    s_getpc_b64 s[44:45]
    s_cbranch_vccnz A_spin
    v_add_u32 v17, s93, v17
    ds_read_b64_tr_b16 a[0:1], v17 offset:0
    ds_read_b64_tr_b16 a[2:3], v17 offset:1024
    v_mfma_f32_32x32x16_bf16 v[80:95], a[12:15], v[116:119], v[80:95]
    v_add_u32 v18, s93, v18
    ds_read_b64_tr_b16 a[4:5], v18 offset:0
    ds_read_b64_tr_b16 a[6:7], v18 offset:1024
    v_pk_mul_f32 v[52:53], v[52:53], v[28:29] op_sel_hi:[1,0]
    v_pk_mul_f32 v[54:55], v[54:55], v[28:29] op_sel_hi:[1,0]
    v_pk_mul_f32 v[56:57], v[56:57], v[28:29] op_sel_hi:[1,0]
    s_waitcnt lgkmcnt(8)
    v_mfma_f32_32x32x16_bf16 v[64:79], a[16:19], v[120:123], v[64:79]
    ds_read_b64_tr_b16 a[8:9], v17 offset:2048
    ds_read_b64_tr_b16 a[10:11], v17 offset:3072
    v_pk_mul_f32 v[58:59], v[58:59], v[28:29] op_sel_hi:[1,0]
    v_pk_mul_f32 v[60:61], v[60:61], v[28:29] op_sel_hi:[1,0]
    v_pk_mul_f32 v[62:63], v[62:63], v[28:29] op_sel_hi:[1,0]
    v_cvt_pk_bf16_f32 v40, v48, v49
    v_cvt_pk_bf16_f32 v41, v50, v51
    v_cvt_pk_bf16_f32 v42, v52, v53
    v_cvt_pk_bf16_f32 v43, v54, v55
    buffer_store_dwordx4 v[40:43], v1, s[40:43], s52 offen offset:2048 sc1
    v_cvt_pk_bf16_f32 v44, v56, v57
    v_cvt_pk_bf16_f32 v45, v58, v59
    v_cvt_pk_bf16_f32 v46, v60, v61
    v_cvt_pk_bf16_f32 v47, v62, v63
    buffer_store_dwordx4 v[44:47], v1, s[40:43], s52 offen offset:3072 sc1
    v_mfma_f32_32x32x16_bf16 v[80:95], a[20:23], v[120:123], v[80:95]
    ds_read_b64_tr_b16 a[12:13], v18 offset:2048
    ds_read_b64_tr_b16 a[14:15], v18 offset:3072
    s_waitcnt lgkmcnt(8)
    v_mfma_f32_32x32x16_bf16 v[64:79], a[24:27], v[124:127], v[64:79]
    ds_read_b64_tr_b16 a[16:17], v17 offset:4096
    ds_read_b64_tr_b16 a[18:19], v17 offset:5120
    v_mfma_f32_32x32x16_bf16 v[80:95], a[28:31], v[124:127], v[80:95]
    v_mov_b32 v26, 29
    ds_write_b32 v23, v26
    ds_read_b64_tr_b16 a[20:21], v18 offset:4096
    ds_read_b64_tr_b16 a[22:23], v18 offset:5120
    s_waitcnt lgkmcnt(9)
    v_mfma_f32_32x32x16_bf16 v[64:79], a[0:3], v[128:131], v[64:79]
    ds_read_b64_tr_b16 a[24:25], v17 offset:6144
    ds_read_b64_tr_b16 a[26:27], v17 offset:7168
    v_accvgpr_read_b32 v11, a139
    v_accvgpr_read_b32 v12, a140
    v_accvgpr_read_b32 v13, a141
    v_mfma_f32_32x32x16_bf16 v[80:95], a[4:7], v[128:131], v[80:95]
    ds_read_b64_tr_b16 a[28:29], v18 offset:6144
    ds_read_b64_tr_b16 a[30:31], v18 offset:7168
    s_waitcnt lgkmcnt(9)
    v_mfma_f32_32x32x16_bf16 v[64:79], a[8:11], v[132:135], v[64:79]
    ds_read_b64_tr_b16 a[0:1], v17 offset:8192
    ds_read_b64_tr_b16 a[2:3], v17 offset:9216
    v_mfma_f32_32x32x16_bf16 v[80:95], a[12:15], v[132:135], v[80:95]
    ds_read_b64_tr_b16 a[4:5], v18 offset:8192
    ds_read_b64_tr_b16 a[6:7], v18 offset:9216
    s_waitcnt lgkmcnt(8)
    v_mfma_f32_32x32x16_bf16 v[64:79], a[16:19], v[192:195], v[64:79]
    ds_read_b64_tr_b16 a[8:9], v17 offset:10240
    ds_read_b64_tr_b16 a[10:11], v17 offset:11264
    v_mfma_f32_32x32x16_bf16 v[80:95], a[20:23], v[192:195], v[80:95]
    ds_read_b64_tr_b16 a[12:13], v18 offset:10240
    ds_read_b64_tr_b16 a[14:15], v18 offset:11264
    s_waitcnt lgkmcnt(8)
    v_mfma_f32_32x32x16_bf16 v[64:79], a[24:27], v[196:199], v[64:79]
    ds_read_b64_tr_b16 a[16:17], v17 offset:12288
    ds_read_b64_tr_b16 a[18:19], v17 offset:13312
    v_mfma_f32_32x32x16_bf16 v[80:95], a[28:31], v[196:199], v[80:95]
    ds_read_b32 v21, v22
    ds_read_b64_tr_b16 a[20:21], v18 offset:12288
    ds_read_b64_tr_b16 a[22:23], v18 offset:13312
    s_waitcnt lgkmcnt(9)
    v_mfma_f32_32x32x16_bf16 v[64:79], a[0:3], v[136:139], v[64:79]
    ds_read_b64_tr_b16 a[24:25], v17 offset:14336
    ds_read_b64_tr_b16 a[26:27], v17 offset:15360
    v_mfma_f32_32x32x16_bf16 v[80:95], a[4:7], v[136:139], v[80:95]
    s_waitcnt lgkmcnt(4)
    s_movk_i32 s59, 30
    v_cmp_ge_u32 vcc, s59, v21
    ds_read_b64_tr_b16 a[28:29], v18 offset:14336
    ds_read_b64_tr_b16 a[30:31], v18 offset:15360
    buffer_load_dword v27, v4, s[24:27], 0 offen sc1
    s_waitcnt vmcnt(1)
    s_mov_b64 exec, 1
    buffer_store_dword v8, v5, s[24:27], 0 offen offset:0
    buffer_store_dword v8, v5, s[24:27], 0 offen offset:128 sc1
    s_mov_b64 exec, -1
    v_mfma_f32_32x32x16_bf16 v[64:79], a[8:11], v[140:143], v[64:79]
    s_getpc_b64 s[44:45]
    s_cbranch_vccnz A_decide
    v_add_u32 v17, s94, v17
    ds_read_b64_tr_b16 a[0:1], v17 offset:0
    ds_read_b64_tr_b16 a[2:3], v17 offset:1024
    v_mfma_f32_32x32x16_bf16 v[80:95], a[12:15], v[140:143], v[80:95]
    v_add_u32 v18, s94, v18
    ds_read_b64_tr_b16 a[4:5], v18 offset:0
    ds_read_b64_tr_b16 a[6:7], v18 offset:1024
    s_waitcnt lgkmcnt(8)
    v_mfma_f32_32x32x16_bf16 v[64:79], a[16:19], v[144:147], v[64:79]
    ds_read_b64_tr_b16 a[8:9], v17 offset:2048
    ds_read_b64_tr_b16 a[10:11], v17 offset:3072
    v_mfma_f32_32x32x16_bf16 v[80:95], a[20:23], v[144:147], v[80:95]
    ds_read_b64_tr_b16 a[12:13], v18 offset:2048
    ds_read_b64_tr_b16 a[14:15], v18 offset:3072
    s_waitcnt lgkmcnt(8)
    v_mfma_f32_32x32x16_bf16 v[64:79], a[24:27], v[148:151], v[64:79]
    ds_read_b64_tr_b16 a[16:17], v17 offset:4096
    ds_read_b64_tr_b16 a[18:19], v17 offset:5120
    v_mfma_f32_32x32x16_bf16 v[80:95], a[28:31], v[148:151], v[80:95]
    v_mov_b32 v26, 30
    ds_write_b32 v23, v26
    ds_read_b64_tr_b16 a[20:21], v18 offset:4096
    ds_read_b64_tr_b16 a[22:23], v18 offset:5120
    s_waitcnt lgkmcnt(9)
    v_mfma_f32_32x32x16_bf16 v[64:79], a[0:3], v[152:155], v[64:79]
    ds_read_b64_tr_b16 a[24:25], v17 offset:6144
    ds_read_b64_tr_b16 a[26:27], v17 offset:7168
    v_mfma_f32_32x32x16_bf16 v[80:95], a[4:7], v[152:155], v[80:95]
    ds_read_b64_tr_b16 a[28:29], v18 offset:6144
    ds_read_b64_tr_b16 a[30:31], v18 offset:7168
    s_waitcnt lgkmcnt(9)
    v_mfma_f32_32x32x16_bf16 v[64:79], a[8:11], v[156:159], v[64:79]
    ds_read_b64_tr_b16 a[0:1], v17 offset:8192
    ds_read_b64_tr_b16 a[2:3], v17 offset:9216
    v_mfma_f32_32x32x16_bf16 v[80:95], a[12:15], v[156:159], v[80:95]
    ds_read_b64_tr_b16 a[4:5], v18 offset:8192
    ds_read_b64_tr_b16 a[6:7], v18 offset:9216
    s_waitcnt lgkmcnt(8)
    v_mfma_f32_32x32x16_bf16 v[64:79], a[16:19], v[160:163], v[64:79]
    ds_read_b64_tr_b16 a[8:9], v17 offset:10240
    ds_read_b64_tr_b16 a[10:11], v17 offset:11264
    v_mfma_f32_32x32x16_bf16 v[80:95], a[20:23], v[160:163], v[80:95]
    ds_read_b64_tr_b16 a[12:13], v18 offset:10240
    ds_read_b64_tr_b16 a[14:15], v18 offset:11264
    s_waitcnt lgkmcnt(8)
    v_mfma_f32_32x32x16_bf16 v[64:79], a[24:27], v[164:167], v[64:79]
    ds_read_b64_tr_b16 a[16:17], v17 offset:12288
    ds_read_b64_tr_b16 a[18:19], v17 offset:13312
    v_mfma_f32_32x32x16_bf16 v[80:95], a[28:31], v[164:167], v[80:95]
    ds_read_b32 v21, v22
    ds_read_b64_tr_b16 a[20:21], v18 offset:12288
    ds_read_b64_tr_b16 a[22:23], v18 offset:13312
    s_waitcnt lgkmcnt(9)
    v_mfma_f32_32x32x16_bf16 v[64:79], a[0:3], v[208:211], v[64:79]
    ds_read_b64_tr_b16 a[24:25], v17 offset:14336
    ds_read_b64_tr_b16 a[26:27], v17 offset:15360
    v_mfma_f32_32x32x16_bf16 v[80:95], a[4:7], v[208:211], v[80:95]
    s_waitcnt lgkmcnt(4)
    s_movk_i32 s59, 31
    v_cmp_ge_u32 vcc, s59, v21
    ds_read_b64_tr_b16 a[28:29], v18 offset:14336
    ds_read_b64_tr_b16 a[30:31], v18 offset:15360
    v_mfma_f32_32x32x16_bf16 v[64:79], a[8:11], v[212:215], v[64:79]
    s_getpc_b64 s[44:45]
    s_cbranch_vccnz A_spin
    v_add_u32 v17, s95, v17
    ds_read_b64_tr_b16 a[0:1], v17 offset:0
    ds_read_b64_tr_b16 a[2:3], v17 offset:1024
    v_mfma_f32_32x32x16_bf16 v[80:95], a[12:15], v[212:215], v[80:95]
    v_add_u32 v18, s95, v18
    ds_read_b64_tr_b16 a[4:5], v18 offset:0
    ds_read_b64_tr_b16 a[6:7], v18 offset:1024
    s_waitcnt lgkmcnt(8)
    v_mfma_f32_32x32x16_bf16 v[64:79], a[16:19], v[168:171], v[64:79]
    ds_read_b64_tr_b16 a[8:9], v17 offset:2048
    ds_read_b64_tr_b16 a[10:11], v17 offset:3072
    v_mfma_f32_32x32x16_bf16 v[80:95], a[20:23], v[168:171], v[80:95]
    ds_read_b64_tr_b16 a[12:13], v18 offset:2048
    ds_read_b64_tr_b16 a[14:15], v18 offset:3072
    s_waitcnt lgkmcnt(8)
    v_mfma_f32_32x32x16_bf16 v[64:79], a[24:27], v[172:175], v[64:79]
    ds_read_b64_tr_b16 a[16:17], v17 offset:4096
    ds_read_b64_tr_b16 a[18:19], v17 offset:5120
    v_mfma_f32_32x32x16_bf16 v[80:95], a[28:31], v[172:175], v[80:95]
    v_mov_b32 v26, 31
    ds_write_b32 v23, v26
    ds_read_b32 v21, v22
    ds_read_b64_tr_b16 a[20:21], v18 offset:4096
    ds_read_b64_tr_b16 a[22:23], v18 offset:5120
    s_waitcnt lgkmcnt(10)
    v_mfma_f32_32x32x16_bf16 v[64:79], a[0:3], v[176:179], v[64:79]
    ds_read_b64_tr_b16 a[24:25], v17 offset:6144
    ds_read_b64_tr_b16 a[26:27], v17 offset:7168
    v_mfma_f32_32x32x16_bf16 v[80:95], a[4:7], v[176:179], v[80:95]
    s_waitcnt lgkmcnt(4)
    s_movk_i32 s59, 32
    v_cmp_ge_u32 vcc, s59, v21
    ds_read_b64_tr_b16 a[28:29], v18 offset:6144
    ds_read_b64_tr_b16 a[30:31], v18 offset:7168
    v_mfma_f32_32x32x16_bf16 v[64:79], a[8:11], v[180:183], v[64:79]
    s_getpc_b64 s[44:45]
    s_cbranch_vccnz A_spin
    ds_read_b64_tr_b16 a[0:1], v17 offset:8192
    ds_read_b64_tr_b16 a[2:3], v17 offset:9216
    v_mfma_f32_32x32x16_bf16 v[80:95], a[12:15], v[180:183], v[80:95]
    ds_read_b64_tr_b16 a[4:5], v18 offset:8192
    ds_read_b64_tr_b16 a[6:7], v18 offset:9216
    s_waitcnt lgkmcnt(8)
    v_mfma_f32_32x32x16_bf16 v[64:79], a[16:19], v[184:187], v[64:79]
    ds_read_b64_tr_b16 a[8:9], v17 offset:10240
    ds_read_b64_tr_b16 a[10:11], v17 offset:11264
    s_waitcnt vmcnt(2)
    v_cmp_eq_u32 s[22:23], s56, v27
    s_nop 0
    s_or_b32 s53, s53, s22
    v_mfma_f32_32x32x16_bf16 v[80:95], a[20:23], v[184:187], v[80:95]
    ds_read_b64_tr_b16 a[12:13], v18 offset:10240
    ds_read_b64_tr_b16 a[14:15], v18 offset:11264
    s_getpc_b64 s[44:45]
    s_andn2_b32 s22, s53, s54
    s_cbranch_scc0 A_selslow
    s_waitcnt lgkmcnt(8)
    v_mfma_f32_32x32x16_bf16 v[64:79], a[24:27], v[188:191], v[64:79]
    ds_read_b64_tr_b16 a[16:17], v17 offset:12288
    ds_read_b64_tr_b16 a[18:19], v17 offset:13312
    s_ff1_i32_b32 s22, s22
    s_bitset1_b32 s54, s22
    v_readlane_b32 s99, v19, s22
    v_readlane_b32 s9, v20, s22
    buffer_load_dword v27, v4, s[24:27], 0 offen sc1
    v_mfma_f32_32x32x16_bf16 v[80:95], a[28:31], v[188:191], v[80:95]
    ds_read_b32 v21, v22
    ds_read_b64_tr_b16 a[20:21], v18 offset:12288
    ds_read_b64_tr_b16 a[22:23], v18 offset:13312
    buffer_load_dwordx4 v[96:99], v1, s[40:43], s99 offen offset:0 sc1
    s_waitcnt lgkmcnt(9)
    v_mfma_f32_32x32x16_bf16 v[64:79], a[0:3], v[224:227], v[64:79]
    ds_read_b64_tr_b16 a[24:25], v17 offset:14336
    ds_read_b64_tr_b16 a[26:27], v17 offset:15360
    buffer_load_dwordx4 v[100:103], v1, s[40:43], s99 offen offset:1024 sc1
    v_mfma_f32_32x32x16_bf16 v[80:95], a[4:7], v[224:227], v[80:95]
    s_waitcnt lgkmcnt(4)
    s_add_u32 s59, s16, 33
    v_cmp_ge_u32 vcc, s59, v21
    ds_read_b64_tr_b16 a[28:29], v18 offset:14336
    ds_read_b64_tr_b16 a[30:31], v18 offset:15360
    buffer_load_dwordx4 v[104:107], v1, s[40:43], s99 offen offset:2048 sc1
    v_mfma_f32_32x32x16_bf16 v[64:79], a[8:11], v[228:231], v[64:79]
    s_getpc_b64 s[44:45]
    s_cbranch_vccnz A_spin
    v_add_u32 v9, s96, v2
    ds_read_b64_tr_b16 a[92:93], v9 offset:0
    ds_read_b64_tr_b16 a[94:95], v9 offset:512
    buffer_load_dwordx4 v[108:111], v1, s[40:43], s99 offen offset:3072 sc1
    v_mfma_f32_32x32x16_bf16 v[80:95], a[12:15], v[228:231], v[80:95]
    v_add_u32 v10, s96, v3
    ds_read_b64_tr_b16 a[96:97], v10 offset:0
    ds_read_b64_tr_b16 a[98:99], v10 offset:512
    s_waitcnt lgkmcnt(8)
    v_mfma_f32_32x32x16_bf16 v[64:79], a[16:19], v[240:243], v[64:79]
    ds_read_b64_tr_b16 a[100:101], v9 offset:2048
    ds_read_b64_tr_b16 a[102:103], v9 offset:2560
    s_getpc_b64 s[44:45]
    s_andn2_b32 s22, s53, s54
    s_cbranch_scc0 A_selslow
    v_mfma_f32_32x32x16_bf16 v[80:95], a[20:23], v[240:243], v[80:95]
    ds_read_b64_tr_b16 a[104:105], v10 offset:2048
    ds_read_b64_tr_b16 a[106:107], v10 offset:2560
    s_ff1_i32_b32 s22, s22
    s_bitset1_b32 s54, s22
    v_readlane_b32 s98, v19, s22
    v_readlane_b32 s10, v20, s22
    s_waitcnt lgkmcnt(8)
    v_mfma_f32_32x32x16_bf16 v[64:79], a[24:27], v[244:247], v[64:79]
    ds_read_b64_tr_b16 a[108:109], v9 offset:4096
    ds_read_b64_tr_b16 a[110:111], v9 offset:4608
    buffer_load_dwordx4 v[112:115], v1, s[40:43], s98 offen offset:0 sc1
    v_mfma_f32_32x32x16_bf16 v[80:95], a[28:31], v[244:247], v[80:95]
    ds_read_b32 v21, v22
    ds_read_b64_tr_b16 a[112:113], v10 offset:4096
    ds_read_b64_tr_b16 a[114:115], v10 offset:4608
    buffer_load_dwordx4 v[116:119], v1, s[40:43], s98 offen offset:1024 sc1
    s_waitcnt lgkmcnt(9)
    v_mfma_f32_32x32x16_bf16 v[48:63], a[92:95], v[32:35], 0
    ds_read_b64_tr_b16 a[116:117], v9 offset:6144
    ds_read_b64_tr_b16 a[118:119], v9 offset:6656
    buffer_load_dwordx4 v[120:123], v1, s[40:43], s98 offen offset:2048 sc1
    v_mfma_f32_32x32x16_bf16 v[192:207], a[96:99], v[32:35], 0
    s_waitcnt lgkmcnt(4)
    s_movk_i32 s59, 36
    v_cmp_ge_u32 vcc, s59, v21
    ds_read_b64_tr_b16 a[120:121], v10 offset:6144
    ds_read_b64_tr_b16 a[122:123], v10 offset:6656
    buffer_load_dwordx4 v[124:127], v1, s[40:43], s98 offen offset:3072 sc1
    v_mfma_f32_32x32x16_bf16 v[48:63], a[100:103], v[36:39], v[48:63]
    s_getpc_b64 s[44:45]
    s_cbranch_vccnz A_spin
    v_add_u32 v9, s9, v2
    ds_read_b64_tr_b16 a[92:93], v9 offset:0
    ds_read_b64_tr_b16 a[94:95], v9 offset:512
    v_pk_mul_f32 v[64:65], v[64:65], v[28:29] op_sel_hi:[1,0]
    v_pk_mul_f32 v[66:67], v[66:67], v[28:29] op_sel_hi:[1,0]
    v_pk_mul_f32 v[68:69], v[68:69], v[28:29] op_sel_hi:[1,0]
    v_pk_mul_f32 v[70:71], v[70:71], v[28:29] op_sel_hi:[1,0]
    v_pk_mul_f32 v[72:73], v[72:73], v[28:29] op_sel_hi:[1,0]
    v_pk_mul_f32 v[74:75], v[74:75], v[28:29] op_sel_hi:[1,0]
    v_pk_mul_f32 v[76:77], v[76:77], v[28:29] op_sel_hi:[1,0]
    v_pk_mul_f32 v[78:79], v[78:79], v[28:29] op_sel_hi:[1,0]
    v_cvt_pk_bf16_f32 v64, v64, v65
    v_mfma_f32_32x32x16_bf16 v[192:207], a[104:107], v[36:39], v[192:207]
    v_add_u32 v10, s9, v3
    ds_read_b64_tr_b16 a[96:97], v10 offset:0
    ds_read_b64_tr_b16 a[98:99], v10 offset:512
    v_cvt_pk_bf16_f32 v65, v66, v67
    v_cvt_pk_bf16_f32 v66, v68, v69
    v_cvt_pk_bf16_f32 v67, v70, v71
    buffer_store_dwordx4 v[64:67], v1, s[40:43], s35 offen offset:0 sc1
    v_cvt_pk_bf16_f32 v68, v72, v73
    v_cvt_pk_bf16_f32 v69, v74, v75
    v_cvt_pk_bf16_f32 v70, v76, v77
    v_cvt_pk_bf16_f32 v71, v78, v79
    buffer_store_dwordx4 v[68:71], v1, s[40:43], s35 offen offset:1024 sc1
    s_waitcnt lgkmcnt(8)
    v_mfma_f32_32x32x16_bf16 v[48:63], a[108:111], v[40:43], v[48:63]
    ds_read_b64_tr_b16 a[100:101], v9 offset:2048
    ds_read_b64_tr_b16 a[102:103], v9 offset:2560
    v_pk_mul_f32 v[80:81], v[80:81], v[28:29] op_sel_hi:[1,0]
    v_pk_mul_f32 v[82:83], v[82:83], v[28:29] op_sel_hi:[1,0]
    v_pk_mul_f32 v[84:85], v[84:85], v[28:29] op_sel_hi:[1,0]
    v_pk_mul_f32 v[86:87], v[86:87], v[28:29] op_sel_hi:[1,0]
    v_pk_mul_f32 v[88:89], v[88:89], v[28:29] op_sel_hi:[1,0]
    v_pk_mul_f32 v[90:91], v[90:91], v[28:29] op_sel_hi:[1,0]
    v_pk_mul_f32 v[92:93], v[92:93], v[28:29] op_sel_hi:[1,0]
    v_pk_mul_f32 v[94:95], v[94:95], v[28:29] op_sel_hi:[1,0]
    v_cvt_pk_bf16_f32 v72, v80, v81
    s_waitcnt vmcnt(10)
    v_cmp_eq_u32 s[22:23], s56, v27
    s_nop 0
    s_or_b32 s53, s53, s22
    v_mfma_f32_32x32x16_bf16 v[192:207], a[112:115], v[40:43], v[192:207]
    ds_read_b64_tr_b16 a[104:105], v10 offset:2048
    ds_read_b64_tr_b16 a[106:107], v10 offset:2560
    v_cvt_pk_bf16_f32 v73, v82, v83
    v_cvt_pk_bf16_f32 v74, v84, v85
    v_cvt_pk_bf16_f32 v75, v86, v87
    buffer_store_dwordx4 v[72:75], v1, s[40:43], s35 offen offset:2048 sc1
    v_cvt_pk_bf16_f32 v76, v88, v89
    v_cvt_pk_bf16_f32 v77, v90, v91
    v_cvt_pk_bf16_f32 v78, v92, v93
    v_cvt_pk_bf16_f32 v79, v94, v95
    buffer_store_dwordx4 v[76:79], v1, s[40:43], s35 offen offset:3072 sc1
    s_getpc_b64 s[44:45]
    s_andn2_b32 s22, s53, s54
    s_cbranch_scc0 A_selslow
    s_waitcnt lgkmcnt(8)
    v_mfma_f32_32x32x16_bf16 v[48:63], a[116:119], v[44:47], v[48:63]
    ds_read_b64_tr_b16 a[108:109], v9 offset:4096
    ds_read_b64_tr_b16 a[110:111], v9 offset:4608
    s_ff1_i32_b32 s22, s22
    s_bitset1_b32 s54, s22
    v_readlane_b32 s99, v19, s22
    v_readlane_b32 s11, v20, s22
    buffer_load_dword v27, v4, s[24:27], 0 offen sc1
    v_mfma_f32_32x32x16_bf16 v[192:207], a[120:123], v[44:47], v[192:207]
    ds_read_b64_tr_b16 a[112:113], v10 offset:4096
    ds_read_b64_tr_b16 a[114:115], v10 offset:4608
    buffer_load_dwordx4 v[128:131], v1, s[40:43], s99 offen offset:0 sc1
    s_waitcnt vmcnt(13) lgkmcnt(8)
    v_mfma_f32_32x32x16_bf16 v[48:63], a[92:95], v[96:99], v[48:63]
    ds_read_b64_tr_b16 a[116:117], v9 offset:6144
    ds_read_b64_tr_b16 a[118:119], v9 offset:6656
    buffer_load_dwordx4 v[132:135], v1, s[40:43], s99 offen offset:1024 sc1
    v_mfma_f32_32x32x16_bf16 v[192:207], a[96:99], v[96:99], v[192:207]
    ds_read_b64_tr_b16 a[120:121], v10 offset:6144
    ds_read_b64_tr_b16 a[122:123], v10 offset:6656
    buffer_load_dwordx4 v[136:139], v1, s[40:43], s99 offen offset:2048 sc1
    s_waitcnt vmcnt(14) lgkmcnt(8)
    v_mfma_f32_32x32x16_bf16 v[48:63], a[100:103], v[100:103], v[48:63]
    v_add_u32 v9, s10, v2
    ds_read_b64_tr_b16 a[92:93], v9 offset:0
    ds_read_b64_tr_b16 a[94:95], v9 offset:512
    buffer_load_dwordx4 v[140:143], v1, s[40:43], s99 offen offset:3072 sc1
    v_mfma_f32_32x32x16_bf16 v[192:207], a[104:107], v[100:103], v[192:207]
    v_add_u32 v10, s10, v3
    ds_read_b64_tr_b16 a[96:97], v10 offset:0
    ds_read_b64_tr_b16 a[98:99], v10 offset:512
    s_waitcnt vmcnt(14) lgkmcnt(8)
    v_mfma_f32_32x32x16_bf16 v[48:63], a[108:111], v[104:107], v[48:63]
    ds_read_b64_tr_b16 a[100:101], v9 offset:2048
    ds_read_b64_tr_b16 a[102:103], v9 offset:2560
    s_getpc_b64 s[44:45]
    s_andn2_b32 s22, s53, s54
    s_cbranch_scc0 A_selslow
    v_mfma_f32_32x32x16_bf16 v[192:207], a[112:115], v[104:107], v[192:207]
    ds_read_b64_tr_b16 a[104:105], v10 offset:2048
    ds_read_b64_tr_b16 a[106:107], v10 offset:2560
    s_ff1_i32_b32 s22, s22
    s_bitset1_b32 s54, s22
    v_readlane_b32 s98, v19, s22
    v_readlane_b32 s8, v20, s22
    s_waitcnt vmcnt(13) lgkmcnt(8)
    v_mfma_f32_32x32x16_bf16 v[48:63], a[116:119], v[108:111], v[48:63]
    ds_read_b64_tr_b16 a[108:109], v9 offset:4096
    ds_read_b64_tr_b16 a[110:111], v9 offset:4608
    buffer_load_dwordx4 v[144:147], v1, s[40:43], s98 offen offset:0 sc1
    v_mfma_f32_32x32x16_bf16 v[192:207], a[120:123], v[108:111], v[192:207]
    ds_read_b64_tr_b16 a[112:113], v10 offset:4096
    ds_read_b64_tr_b16 a[114:115], v10 offset:4608
    buffer_load_dwordx4 v[148:151], v1, s[40:43], s98 offen offset:1024 sc1
    s_waitcnt vmcnt(14) lgkmcnt(8)
    v_mfma_f32_32x32x16_bf16 v[48:63], a[92:95], v[112:115], v[48:63]
    ds_read_b64_tr_b16 a[116:117], v9 offset:6144
    ds_read_b64_tr_b16 a[118:119], v9 offset:6656
    buffer_load_dwordx4 v[152:155], v1, s[40:43], s98 offen offset:2048 sc1
    v_mfma_f32_32x32x16_bf16 v[192:207], a[96:99], v[112:115], v[192:207]
    ds_read_b64_tr_b16 a[120:121], v10 offset:6144
    ds_read_b64_tr_b16 a[122:123], v10 offset:6656
    buffer_load_dwordx4 v[156:159], v1, s[40:43], s98 offen offset:3072 sc1
    s_waitcnt vmcnt(15) lgkmcnt(8)
    v_mfma_f32_32x32x16_bf16 v[48:63], a[100:103], v[116:119], v[48:63]
    v_add_u32 v9, s11, v2
    ds_read_b64_tr_b16 a[92:93], v9 offset:0
    ds_read_b64_tr_b16 a[94:95], v9 offset:512
    v_mfma_f32_32x32x16_bf16 v[192:207], a[104:107], v[116:119], v[192:207]
    v_add_u32 v10, s11, v3
    ds_read_b64_tr_b16 a[96:97], v10 offset:0
    ds_read_b64_tr_b16 a[98:99], v10 offset:512
    s_waitcnt vmcnt(14) lgkmcnt(8)
    v_mfma_f32_32x32x16_bf16 v[48:63], a[108:111], v[120:123], v[48:63]
    ds_read_b64_tr_b16 a[100:101], v9 offset:2048
    ds_read_b64_tr_b16 a[102:103], v9 offset:2560
    s_waitcnt vmcnt(9)
    s_mov_b64 exec, 1
    buffer_store_dword v8, v5, s[24:27], 0 offen offset:32
    buffer_store_dword v8, v5, s[24:27], 0 offen offset:160 sc1
    s_mov_b64 exec, -1
    s_mov_b32 s12, 1
    s_waitcnt vmcnt(10)
    v_cmp_eq_u32 s[22:23], s56, v27
    s_nop 0
    s_or_b32 s53, s53, s22
    v_mfma_f32_32x32x16_bf16 v[192:207], a[112:115], v[120:123], v[192:207]
    ds_read_b64_tr_b16 a[104:105], v10 offset:2048
    ds_read_b64_tr_b16 a[106:107], v10 offset:2560
    s_getpc_b64 s[44:45]
    s_andn2_b32 s22, s53, s54
    s_cbranch_scc0 A_selslow
    s_waitcnt lgkmcnt(8)
    v_mfma_f32_32x32x16_bf16 v[48:63], a[116:119], v[124:127], v[48:63]
    ds_read_b64_tr_b16 a[108:109], v9 offset:4096
    ds_read_b64_tr_b16 a[110:111], v9 offset:4608
    s_ff1_i32_b32 s22, s22
    s_bitset1_b32 s54, s22
    v_readlane_b32 s99, v19, s22
    v_readlane_b32 s9, v20, s22
    buffer_load_dword v27, v4, s[24:27], 0 offen sc1
    v_mfma_f32_32x32x16_bf16 v[192:207], a[120:123], v[124:127], v[192:207]
    ds_read_b64_tr_b16 a[112:113], v10 offset:4096
    ds_read_b64_tr_b16 a[114:115], v10 offset:4608
    buffer_load_dwordx4 v[160:163], v1, s[40:43], s99 offen offset:0 sc1
    s_waitcnt vmcnt(11) lgkmcnt(8)
    v_mfma_f32_32x32x16_bf16 v[48:63], a[92:95], v[128:131], v[48:63]
    ds_read_b64_tr_b16 a[116:117], v9 offset:6144
    ds_read_b64_tr_b16 a[118:119], v9 offset:6656
    buffer_load_dwordx4 v[164:167], v1, s[40:43], s99 offen offset:1024 sc1
    v_mfma_f32_32x32x16_bf16 v[192:207], a[96:99], v[128:131], v[192:207]
    ds_read_b64_tr_b16 a[120:121], v10 offset:6144
    ds_read_b64_tr_b16 a[122:123], v10 offset:6656
    buffer_load_dwordx4 v[168:171], v1, s[40:43], s99 offen offset:2048 sc1
    s_waitcnt vmcnt(12) lgkmcnt(8)
    v_mfma_f32_32x32x16_bf16 v[48:63], a[100:103], v[132:135], v[48:63]
    v_add_u32 v9, s8, v2
    ds_read_b64_tr_b16 a[92:93], v9 offset:0
    ds_read_b64_tr_b16 a[94:95], v9 offset:512
    buffer_load_dwordx4 v[172:175], v1, s[40:43], s99 offen offset:3072 sc1
    v_mfma_f32_32x32x16_bf16 v[192:207], a[104:107], v[132:135], v[192:207]
    v_add_u32 v10, s8, v3
    ds_read_b64_tr_b16 a[96:97], v10 offset:0
    ds_read_b64_tr_b16 a[98:99], v10 offset:512
    s_waitcnt vmcnt(12) lgkmcnt(8)
    v_mfma_f32_32x32x16_bf16 v[48:63], a[108:111], v[136:139], v[48:63]
    ds_read_b64_tr_b16 a[100:101], v9 offset:2048
    ds_read_b64_tr_b16 a[102:103], v9 offset:2560
    s_getpc_b64 s[44:45]
    s_andn2_b32 s22, s53, s54
    s_cbranch_scc0 A_selslow
    v_mfma_f32_32x32x16_bf16 v[192:207], a[112:115], v[136:139], v[192:207]
    ds_read_b64_tr_b16 a[104:105], v10 offset:2048
    ds_read_b64_tr_b16 a[106:107], v10 offset:2560
    s_ff1_i32_b32 s22, s22
    s_bitset1_b32 s54, s22
    v_readlane_b32 s98, v19, s22
    v_readlane_b32 s10, v20, s22
    s_waitcnt vmcnt(11) lgkmcnt(8)
    v_mfma_f32_32x32x16_bf16 v[48:63], a[116:119], v[140:143], v[48:63]
    ds_read_b64_tr_b16 a[108:109], v9 offset:4096
    ds_read_b64_tr_b16 a[110:111], v9 offset:4608
    buffer_load_dwordx4 v[176:179], v1, s[40:43], s98 offen offset:0 sc1
    v_mfma_f32_32x32x16_bf16 v[192:207], a[120:123], v[140:143], v[192:207]
    ds_read_b64_tr_b16 a[112:113], v10 offset:4096
    ds_read_b64_tr_b16 a[114:115], v10 offset:4608
    buffer_load_dwordx4 v[180:183], v1, s[40:43], s98 offen offset:1024 sc1
    s_waitcnt vmcnt(12) lgkmcnt(8)
    v_mfma_f32_32x32x16_bf16 v[48:63], a[92:95], v[144:147], v[48:63]
    ds_read_b64_tr_b16 a[116:117], v9 offset:6144
    ds_read_b64_tr_b16 a[118:119], v9 offset:6656
    buffer_load_dwordx4 v[184:187], v1, s[40:43], s98 offen offset:2048 sc1
    v_mfma_f32_32x32x16_bf16 v[192:207], a[96:99], v[144:147], v[192:207]
    ds_read_b64_tr_b16 a[120:121], v10 offset:6144
    ds_read_b64_tr_b16 a[122:123], v10 offset:6656
    buffer_load_dwordx4 v[188:191], v1, s[40:43], s98 offen offset:3072 sc1
    s_waitcnt vmcnt(13) lgkmcnt(8)
    v_mfma_f32_32x32x16_bf16 v[48:63], a[100:103], v[148:151], v[48:63]
    v_add_u32 v9, s9, v2
    ds_read_b64_tr_b16 a[92:93], v9 offset:0
    ds_read_b64_tr_b16 a[94:95], v9 offset:512
    v_mfma_f32_32x32x16_bf16 v[192:207], a[104:107], v[148:151], v[192:207]
    v_add_u32 v10, s9, v3
    ds_read_b64_tr_b16 a[96:97], v10 offset:0
    ds_read_b64_tr_b16 a[98:99], v10 offset:512
    s_waitcnt vmcnt(12) lgkmcnt(8)
    v_mfma_f32_32x32x16_bf16 v[48:63], a[108:111], v[152:155], v[48:63]
    ds_read_b64_tr_b16 a[100:101], v9 offset:2048
    ds_read_b64_tr_b16 a[102:103], v9 offset:2560
    s_waitcnt vmcnt(8)
    v_cmp_eq_u32 s[22:23], s56, v27
    s_nop 0
    s_or_b32 s53, s53, s22
    v_mfma_f32_32x32x16_bf16 v[192:207], a[112:115], v[152:155], v[192:207]
    ds_read_b64_tr_b16 a[104:105], v10 offset:2048
    ds_read_b64_tr_b16 a[106:107], v10 offset:2560
    s_getpc_b64 s[44:45]
    s_andn2_b32 s22, s53, s54
    s_cbranch_scc0 A_selslow
    s_waitcnt lgkmcnt(8)
    v_mfma_f32_32x32x16_bf16 v[48:63], a[116:119], v[156:159], v[48:63]
    ds_read_b64_tr_b16 a[108:109], v9 offset:4096
    ds_read_b64_tr_b16 a[110:111], v9 offset:4608
    s_ff1_i32_b32 s22, s22
    s_bitset1_b32 s54, s22
    v_readlane_b32 s99, v19, s22
    v_readlane_b32 s11, v20, s22
    buffer_load_dword v27, v4, s[24:27], 0 offen sc1
    v_mfma_f32_32x32x16_bf16 v[192:207], a[120:123], v[156:159], v[192:207]
    ds_read_b64_tr_b16 a[112:113], v10 offset:4096
    ds_read_b64_tr_b16 a[114:115], v10 offset:4608
    buffer_load_dwordx4 v[96:99], v1, s[40:43], s99 offen offset:0 sc1
    s_waitcnt vmcnt(9) lgkmcnt(8)
    v_mfma_f32_32x32x16_bf16 v[48:63], a[92:95], v[160:163], v[48:63]
    ds_read_b64_tr_b16 a[116:117], v9 offset:6144
    ds_read_b64_tr_b16 a[118:119], v9 offset:6656
    buffer_load_dwordx4 v[100:103], v1, s[40:43], s99 offen offset:1024 sc1
    v_mfma_f32_32x32x16_bf16 v[192:207], a[96:99], v[160:163], v[192:207]
    ds_read_b64_tr_b16 a[120:121], v10 offset:6144
    ds_read_b64_tr_b16 a[122:123], v10 offset:6656
    buffer_load_dwordx4 v[104:107], v1, s[40:43], s99 offen offset:2048 sc1
    s_waitcnt vmcnt(10) lgkmcnt(8)
    v_mfma_f32_32x32x16_bf16 v[48:63], a[100:103], v[164:167], v[48:63]
    v_add_u32 v9, s10, v2
    ds_read_b64_tr_b16 a[92:93], v9 offset:0
    ds_read_b64_tr_b16 a[94:95], v9 offset:512
    buffer_load_dwordx4 v[108:111], v1, s[40:43], s99 offen offset:3072 sc1
    v_mfma_f32_32x32x16_bf16 v[192:207], a[104:107], v[164:167], v[192:207]
    v_add_u32 v10, s10, v3
    ds_read_b64_tr_b16 a[96:97], v10 offset:0
    ds_read_b64_tr_b16 a[98:99], v10 offset:512
    s_waitcnt vmcnt(10) lgkmcnt(8)
    v_mfma_f32_32x32x16_bf16 v[48:63], a[108:111], v[168:171], v[48:63]
    ds_read_b64_tr_b16 a[100:101], v9 offset:2048
    ds_read_b64_tr_b16 a[102:103], v9 offset:2560
    v_mfma_f32_32x32x16_bf16 v[192:207], a[112:115], v[168:171], v[192:207]
    ds_read_b64_tr_b16 a[104:105], v10 offset:2048
    ds_read_b64_tr_b16 a[106:107], v10 offset:2560
    s_waitcnt vmcnt(9) lgkmcnt(8)
    v_mfma_f32_32x32x16_bf16 v[48:63], a[116:119], v[172:175], v[48:63]
    ds_read_b64_tr_b16 a[108:109], v9 offset:4096
    ds_read_b64_tr_b16 a[110:111], v9 offset:4608
    v_mfma_f32_32x32x16_bf16 v[192:207], a[120:123], v[172:175], v[192:207]
    ds_read_b64_tr_b16 a[112:113], v10 offset:4096
    ds_read_b64_tr_b16 a[114:115], v10 offset:4608
    s_waitcnt vmcnt(8) lgkmcnt(8)
    v_mfma_f32_32x32x16_bf16 v[48:63], a[92:95], v[176:179], v[48:63]
    ds_read_b64_tr_b16 a[116:117], v9 offset:6144
    ds_read_b64_tr_b16 a[118:119], v9 offset:6656
    v_mfma_f32_32x32x16_bf16 v[192:207], a[96:99], v[176:179], v[192:207]
    ds_read_b64_tr_b16 a[120:121], v10 offset:6144
    ds_read_b64_tr_b16 a[122:123], v10 offset:6656
    s_waitcnt vmcnt(7) lgkmcnt(8)
    v_mfma_f32_32x32x16_bf16 v[48:63], a[100:103], v[180:183], v[48:63]
    v_add_u32 v9, s11, v2
    ds_read_b64_tr_b16 a[92:93], v9 offset:0
    ds_read_b64_tr_b16 a[94:95], v9 offset:512
    v_mfma_f32_32x32x16_bf16 v[192:207], a[104:107], v[180:183], v[192:207]
    v_add_u32 v10, s11, v3
    ds_read_b64_tr_b16 a[96:97], v10 offset:0
    ds_read_b64_tr_b16 a[98:99], v10 offset:512
    s_waitcnt vmcnt(6) lgkmcnt(8)
    v_mfma_f32_32x32x16_bf16 v[48:63], a[108:111], v[184:187], v[48:63]
    ds_read_b64_tr_b16 a[100:101], v9 offset:2048
    ds_read_b64_tr_b16 a[102:103], v9 offset:2560
    s_mov_b32 s54, 0xffff01ff
    s_getpc_b64 s[44:45]
    s_andn2_b32 s22, s53, s54
    s_cbranch_scc0 A_selslow1
    v_mfma_f32_32x32x16_bf16 v[192:207], a[112:115], v[184:187], v[192:207]
    ds_read_b64_tr_b16 a[104:105], v10 offset:2048
    ds_read_b64_tr_b16 a[106:107], v10 offset:2560
    s_ff1_i32_b32 s22, s22
    s_bitset1_b32 s54, s22
    v_readlane_b32 s99, v19, s22
    v_readlane_b32 s9, v20, s22
    s_waitcnt vmcnt(5) lgkmcnt(8)
    v_mfma_f32_32x32x16_bf16 v[48:63], a[116:119], v[188:191], v[48:63]
    ds_read_b64_tr_b16 a[108:109], v9 offset:4096
    ds_read_b64_tr_b16 a[110:111], v9 offset:4608
    buffer_load_dwordx4 v[112:115], v1, s[4:7], s99 offen offset:0 sc1
    v_mfma_f32_32x32x16_bf16 v[192:207], a[120:123], v[188:191], v[192:207]
    ds_read_b32 v21, v22
    ds_read_b64_tr_b16 a[112:113], v10 offset:4096
    ds_read_b64_tr_b16 a[114:115], v10 offset:4608
    buffer_load_dwordx4 v[116:119], v1, s[4:7], s99 offen offset:1024 sc1
    s_waitcnt vmcnt(5) lgkmcnt(9)
    v_mfma_f32_32x32x16_bf16 v[48:63], a[92:95], v[96:99], v[48:63]
    ds_read_b64_tr_b16 a[116:117], v9 offset:6144
    ds_read_b64_tr_b16 a[118:119], v9 offset:6656
    buffer_load_dwordx4 v[120:123], v1, s[4:7], s99 offen offset:2048 sc1
    v_mfma_f32_32x32x16_bf16 v[192:207], a[96:99], v[96:99], v[192:207]
    s_waitcnt lgkmcnt(4)
    s_add_u32 s59, s16, 37
    v_cmp_ge_u32 vcc, s59, v21
    ds_read_b64_tr_b16 a[120:121], v10 offset:6144
    ds_read_b64_tr_b16 a[122:123], v10 offset:6656
    buffer_load_dwordx4 v[124:127], v1, s[4:7], s99 offen offset:3072 sc1
    s_waitcnt vmcnt(6)
    v_mfma_f32_32x32x16_bf16 v[48:63], a[100:103], v[100:103], v[48:63]
    s_getpc_b64 s[44:45]
    s_cbranch_vccnz A_spin
    v_add_u32 v9, s97, v2
    ds_read_b64_tr_b16 a[92:93], v9 offset:0
    ds_read_b64_tr_b16 a[94:95], v9 offset:512
    v_mfma_f32_32x32x16_bf16 v[192:207], a[104:107], v[100:103], v[192:207]
    v_add_u32 v10, s97, v3
    ds_read_b64_tr_b16 a[96:97], v10 offset:0
    ds_read_b64_tr_b16 a[98:99], v10 offset:512
    s_waitcnt vmcnt(5) lgkmcnt(8)
    v_mfma_f32_32x32x16_bf16 v[48:63], a[108:111], v[104:107], v[48:63]
    ds_read_b64_tr_b16 a[100:101], v9 offset:2048
    ds_read_b64_tr_b16 a[102:103], v9 offset:2560
    v_cmp_eq_u32 s[22:23], s56, v27
    s_nop 0
    s_or_b32 s53, s53, s22
    v_mfma_f32_32x32x16_bf16 v[192:207], a[112:115], v[104:107], v[192:207]
    ds_read_b64_tr_b16 a[104:105], v10 offset:2048
    ds_read_b64_tr_b16 a[106:107], v10 offset:2560
    s_getpc_b64 s[44:45]
    s_andn2_b32 s22, s53, s54
    s_cbranch_scc0 A_selslow1
    s_waitcnt vmcnt(4) lgkmcnt(8)
    v_mfma_f32_32x32x16_bf16 v[48:63], a[116:119], v[108:111], v[48:63]
    ds_read_b64_tr_b16 a[108:109], v9 offset:4096
    ds_read_b64_tr_b16 a[110:111], v9 offset:4608
    s_ff1_i32_b32 s22, s22
    s_bitset1_b32 s54, s22
    v_readlane_b32 s98, v19, s22
    v_readlane_b32 s10, v20, s22
    buffer_load_dword v27, v4, s[24:27], 0 offen sc1
    v_mfma_f32_32x32x16_bf16 v[192:207], a[120:123], v[108:111], v[192:207]
    ds_read_b32 v21, v22
    ds_read_b64_tr_b16 a[112:113], v10 offset:4096
    ds_read_b64_tr_b16 a[114:115], v10 offset:4608
    buffer_load_dwordx4 v[128:131], v1, s[4:7], s98 offen offset:0 sc1
    s_waitcnt lgkmcnt(9)
    v_mfma_f32_32x32x16_bf16 v[48:63], a[92:95], v[64:67], v[48:63]
    ds_read_b64_tr_b16 a[116:117], v9 offset:6144
    ds_read_b64_tr_b16 a[118:119], v9 offset:6656
    buffer_load_dwordx4 v[132:135], v1, s[4:7], s98 offen offset:1024 sc1
    v_mfma_f32_32x32x16_bf16 v[192:207], a[96:99], v[64:67], v[192:207]
    s_waitcnt lgkmcnt(4)
    s_movk_i32 s59, 40
    v_cmp_ge_u32 vcc, s59, v21
    ds_read_b64_tr_b16 a[120:121], v10 offset:6144
    ds_read_b64_tr_b16 a[122:123], v10 offset:6656
    buffer_load_dwordx4 v[136:139], v1, s[4:7], s98 offen offset:2048 sc1
    v_mfma_f32_32x32x16_bf16 v[48:63], a[100:103], v[68:71], v[48:63]
    s_getpc_b64 s[44:45]
    s_cbranch_vccnz A_spin
    v_add_u32 v9, s9, v2
    ds_read_b64_tr_b16 a[92:93], v9 offset:0
    ds_read_b64_tr_b16 a[94:95], v9 offset:512
    buffer_load_dwordx4 v[140:143], v1, s[4:7], s98 offen offset:3072 sc1
    v_mfma_f32_32x32x16_bf16 v[192:207], a[104:107], v[68:71], v[192:207]
    v_add_u32 v10, s9, v3
    ds_read_b64_tr_b16 a[96:97], v10 offset:0
    ds_read_b64_tr_b16 a[98:99], v10 offset:512
    s_waitcnt lgkmcnt(8)
    v_mfma_f32_32x32x16_bf16 v[48:63], a[108:111], v[72:75], v[48:63]
    ds_read_b64_tr_b16 a[100:101], v9 offset:2048
    ds_read_b64_tr_b16 a[102:103], v9 offset:2560
    s_getpc_b64 s[44:45]
    s_andn2_b32 s22, s53, s54
    s_cbranch_scc0 A_selslow1
    v_mfma_f32_32x32x16_bf16 v[192:207], a[112:115], v[72:75], v[192:207]
    ds_read_b64_tr_b16 a[104:105], v10 offset:2048
    ds_read_b64_tr_b16 a[106:107], v10 offset:2560
    s_ff1_i32_b32 s22, s22
    s_bitset1_b32 s54, s22
    v_readlane_b32 s99, v19, s22
    v_readlane_b32 s11, v20, s22
    s_waitcnt lgkmcnt(8)
    v_mfma_f32_32x32x16_bf16 v[48:63], a[116:119], v[76:79], v[48:63]
    ds_read_b64_tr_b16 a[108:109], v9 offset:4096
    ds_read_b64_tr_b16 a[110:111], v9 offset:4608
    buffer_load_dwordx4 v[144:147], v1, s[4:7], s99 offen offset:0 sc1
    v_mfma_f32_32x32x16_bf16 v[192:207], a[120:123], v[76:79], v[192:207]
    ds_read_b64_tr_b16 a[112:113], v10 offset:4096
    ds_read_b64_tr_b16 a[114:115], v10 offset:4608
    buffer_load_dwordx4 v[148:151], v1, s[4:7], s99 offen offset:1024 sc1
    s_waitcnt vmcnt(10) lgkmcnt(8)
    v_mfma_f32_32x32x16_bf16 v[48:63], a[92:95], v[112:115], v[48:63]
    ds_read_b64_tr_b16 a[116:117], v9 offset:6144
    ds_read_b64_tr_b16 a[118:119], v9 offset:6656
    buffer_load_dwordx4 v[152:155], v1, s[4:7], s99 offen offset:2048 sc1
    v_mfma_f32_32x32x16_bf16 v[192:207], a[96:99], v[112:115], v[192:207]
    ds_read_b64_tr_b16 a[120:121], v10 offset:6144
    ds_read_b64_tr_b16 a[122:123], v10 offset:6656
    buffer_load_dwordx4 v[156:159], v1, s[4:7], s99 offen offset:3072 sc1
    s_waitcnt vmcnt(11) lgkmcnt(8)
    v_mfma_f32_32x32x16_bf16 v[48:63], a[100:103], v[116:119], v[48:63]
    v_add_u32 v9, s10, v2
    ds_read_b64_tr_b16 a[92:93], v9 offset:0
    ds_read_b64_tr_b16 a[94:95], v9 offset:512
    v_mfma_f32_32x32x16_bf16 v[192:207], a[104:107], v[116:119], v[192:207]
    v_add_u32 v10, s10, v3
    ds_read_b64_tr_b16 a[96:97], v10 offset:0
    ds_read_b64_tr_b16 a[98:99], v10 offset:512
    s_waitcnt vmcnt(10) lgkmcnt(8)
    v_mfma_f32_32x32x16_bf16 v[48:63], a[108:111], v[120:123], v[48:63]
    ds_read_b64_tr_b16 a[100:101], v9 offset:2048
    ds_read_b64_tr_b16 a[102:103], v9 offset:2560
    s_waitcnt vmcnt(8)
    v_cmp_eq_u32 s[22:23], s56, v27
    s_nop 0
    s_or_b32 s53, s53, s22
    v_mfma_f32_32x32x16_bf16 v[192:207], a[112:115], v[120:123], v[192:207]
    ds_read_b64_tr_b16 a[104:105], v10 offset:2048
    ds_read_b64_tr_b16 a[106:107], v10 offset:2560
    s_getpc_b64 s[44:45]
    s_andn2_b32 s22, s53, s54
    s_cbranch_scc0 A_selslow1
    s_waitcnt lgkmcnt(8)
    v_mfma_f32_32x32x16_bf16 v[48:63], a[116:119], v[124:127], v[48:63]
    ds_read_b64_tr_b16 a[108:109], v9 offset:4096
    ds_read_b64_tr_b16 a[110:111], v9 offset:4608
    s_ff1_i32_b32 s22, s22
    s_bitset1_b32 s54, s22
    v_readlane_b32 s98, v19, s22
    v_readlane_b32 s8, v20, s22
    buffer_load_dword v27, v4, s[24:27], 0 offen sc1
    v_mfma_f32_32x32x16_bf16 v[192:207], a[120:123], v[124:127], v[192:207]
    ds_read_b64_tr_b16 a[112:113], v10 offset:4096
    ds_read_b64_tr_b16 a[114:115], v10 offset:4608
    buffer_load_dwordx4 v[160:163], v1, s[4:7], s98 offen offset:0 sc1
    s_waitcnt vmcnt(9) lgkmcnt(8)
    v_mfma_f32_32x32x16_bf16 v[48:63], a[92:95], v[128:131], v[48:63]
    ds_read_b64_tr_b16 a[116:117], v9 offset:6144
    ds_read_b64_tr_b16 a[118:119], v9 offset:6656
    buffer_load_dwordx4 v[164:167], v1, s[4:7], s98 offen offset:1024 sc1
    v_mfma_f32_32x32x16_bf16 v[192:207], a[96:99], v[128:131], v[192:207]
    ds_read_b64_tr_b16 a[120:121], v10 offset:6144
    ds_read_b64_tr_b16 a[122:123], v10 offset:6656
    buffer_load_dwordx4 v[168:171], v1, s[4:7], s98 offen offset:2048 sc1
    s_waitcnt vmcnt(10) lgkmcnt(8)
    v_mfma_f32_32x32x16_bf16 v[48:63], a[100:103], v[132:135], v[48:63]
    v_add_u32 v9, s11, v2
    ds_read_b64_tr_b16 a[92:93], v9 offset:0
    ds_read_b64_tr_b16 a[94:95], v9 offset:512
    buffer_load_dwordx4 v[172:175], v1, s[4:7], s98 offen offset:3072 sc1
    v_mfma_f32_32x32x16_bf16 v[192:207], a[104:107], v[132:135], v[192:207]
    v_add_u32 v10, s11, v3
    ds_read_b64_tr_b16 a[96:97], v10 offset:0
    ds_read_b64_tr_b16 a[98:99], v10 offset:512
    s_waitcnt vmcnt(10) lgkmcnt(8)
    v_mfma_f32_32x32x16_bf16 v[48:63], a[108:111], v[136:139], v[48:63]
    ds_read_b64_tr_b16 a[100:101], v9 offset:2048
    ds_read_b64_tr_b16 a[102:103], v9 offset:2560
    s_getpc_b64 s[44:45]
    s_andn2_b32 s22, s53, s54
    s_cbranch_scc0 A_selslow1
    v_mfma_f32_32x32x16_bf16 v[192:207], a[112:115], v[136:139], v[192:207]
    ds_read_b64_tr_b16 a[104:105], v10 offset:2048
    ds_read_b64_tr_b16 a[106:107], v10 offset:2560
    s_ff1_i32_b32 s22, s22
    s_bitset1_b32 s54, s22
    v_readlane_b32 s99, v19, s22
    v_readlane_b32 s9, v20, s22
    s_waitcnt vmcnt(9) lgkmcnt(8)
    v_mfma_f32_32x32x16_bf16 v[48:63], a[116:119], v[140:143], v[48:63]
    ds_read_b64_tr_b16 a[108:109], v9 offset:4096
    ds_read_b64_tr_b16 a[110:111], v9 offset:4608
    buffer_load_dwordx4 v[176:179], v1, s[4:7], s99 offen offset:0 sc1
    v_mfma_f32_32x32x16_bf16 v[192:207], a[120:123], v[140:143], v[192:207]
    ds_read_b64_tr_b16 a[112:113], v10 offset:4096
    ds_read_b64_tr_b16 a[114:115], v10 offset:4608
    buffer_load_dwordx4 v[180:183], v1, s[4:7], s99 offen offset:1024 sc1
    s_waitcnt vmcnt(10) lgkmcnt(8)
    v_mfma_f32_32x32x16_bf16 v[48:63], a[92:95], v[144:147], v[48:63]
    ds_read_b64_tr_b16 a[116:117], v9 offset:6144
    ds_read_b64_tr_b16 a[118:119], v9 offset:6656
    buffer_load_dwordx4 v[184:187], v1, s[4:7], s99 offen offset:2048 sc1
    v_mfma_f32_32x32x16_bf16 v[192:207], a[96:99], v[144:147], v[192:207]
    ds_read_b64_tr_b16 a[120:121], v10 offset:6144
    ds_read_b64_tr_b16 a[122:123], v10 offset:6656
    buffer_load_dwordx4 v[188:191], v1, s[4:7], s99 offen offset:3072 sc1
    s_waitcnt vmcnt(11) lgkmcnt(8)
    v_mfma_f32_32x32x16_bf16 v[48:63], a[100:103], v[148:151], v[48:63]
    v_add_u32 v9, s8, v2
    ds_read_b64_tr_b16 a[92:93], v9 offset:0
    ds_read_b64_tr_b16 a[94:95], v9 offset:512
    s_waitcnt vmcnt(8)
    v_cmp_eq_u32 s[22:23], s56, v27
    s_nop 0
    s_or_b32 s53, s53, s22
    v_mfma_f32_32x32x16_bf16 v[192:207], a[104:107], v[148:151], v[192:207]
    v_add_u32 v10, s8, v3
    ds_read_b64_tr_b16 a[96:97], v10 offset:0
    ds_read_b64_tr_b16 a[98:99], v10 offset:512
    s_getpc_b64 s[44:45]
    s_andn2_b32 s22, s53, s54
    s_cbranch_scc0 A_selslow1
    s_waitcnt lgkmcnt(8)
    v_mfma_f32_32x32x16_bf16 v[48:63], a[108:111], v[152:155], v[48:63]
    ds_read_b64_tr_b16 a[100:101], v9 offset:2048
    ds_read_b64_tr_b16 a[102:103], v9 offset:2560
    s_ff1_i32_b32 s22, s22
    s_bitset1_b32 s54, s22
    v_readlane_b32 s98, v19, s22
    v_readlane_b32 s10, v20, s22
    v_mfma_f32_32x32x16_bf16 v[192:207], a[112:115], v[152:155], v[192:207]
    ds_read_b64_tr_b16 a[104:105], v10 offset:2048
    ds_read_b64_tr_b16 a[106:107], v10 offset:2560
    s_nop 0
    buffer_load_dwordx4 v[96:99], v1, s[4:7], s98 offen offset:0 sc1
    s_waitcnt lgkmcnt(8)
    v_mfma_f32_32x32x16_bf16 v[48:63], a[116:119], v[156:159], v[48:63]
    ds_read_b64_tr_b16 a[108:109], v9 offset:4096
    ds_read_b64_tr_b16 a[110:111], v9 offset:4608
    buffer_load_dwordx4 v[100:103], v1, s[4:7], s98 offen offset:1024 sc1
    v_mfma_f32_32x32x16_bf16 v[192:207], a[120:123], v[156:159], v[192:207]
    ds_read_b64_tr_b16 a[112:113], v10 offset:4096
    ds_read_b64_tr_b16 a[114:115], v10 offset:4608
    buffer_load_dwordx4 v[104:107], v1, s[4:7], s98 offen offset:2048 sc1
    s_waitcnt vmcnt(10) lgkmcnt(8)
    v_mfma_f32_32x32x16_bf16 v[48:63], a[92:95], v[160:163], v[48:63]
    ds_read_b64_tr_b16 a[116:117], v9 offset:6144
    ds_read_b64_tr_b16 a[118:119], v9 offset:6656
    buffer_load_dwordx4 v[108:111], v1, s[4:7], s98 offen offset:3072 sc1
    v_mfma_f32_32x32x16_bf16 v[192:207], a[96:99], v[160:163], v[192:207]
    ds_read_b64_tr_b16 a[120:121], v10 offset:6144
    ds_read_b64_tr_b16 a[122:123], v10 offset:6656
    s_getpc_b64 s[44:45]
    s_andn2_b32 s22, s53, s54
    s_cbranch_scc0 A_selslow1
    s_waitcnt vmcnt(10) lgkmcnt(8)
    v_mfma_f32_32x32x16_bf16 v[48:63], a[100:103], v[164:167], v[48:63]
    v_add_u32 v9, s9, v2
    ds_read_b64_tr_b16 a[92:93], v9 offset:0
    ds_read_b64_tr_b16 a[94:95], v9 offset:512
    s_ff1_i32_b32 s22, s22
    s_bitset1_b32 s54, s22
    v_readlane_b32 s99, v19, s22
    v_readlane_b32 s11, v20, s22
    v_mfma_f32_32x32x16_bf16 v[192:207], a[104:107], v[164:167], v[192:207]
    ds_read_b64_tr_b16 a[96:97], v9 offset:2048
    ds_read_b64_tr_b16 a[98:99], v9 offset:2560
    s_nop 0
    buffer_load_dwordx4 v[112:115], v1, s[4:7], s99 offen offset:0 sc1
    buffer_load_dwordx4 v[116:119], v1, s[4:7], s99 offen offset:1024 sc1
    s_waitcnt vmcnt(11) lgkmcnt(8)
    v_mfma_f32_32x32x16_bf16 v[48:63], a[108:111], v[168:171], v[48:63]
    ds_read_b64_tr_b16 a[100:101], v9 offset:4096
    ds_read_b64_tr_b16 a[102:103], v9 offset:4608
    buffer_load_dwordx4 v[120:123], v1, s[4:7], s99 offen offset:2048 sc1
    buffer_load_dwordx4 v[124:127], v1, s[4:7], s99 offen offset:3072 sc1
    v_mfma_f32_32x32x16_bf16 v[192:207], a[112:115], v[168:171], v[192:207]
    ds_read_b64_tr_b16 a[104:105], v9 offset:6144
    ds_read_b64_tr_b16 a[106:107], v9 offset:6656
    s_waitcnt vmcnt(12) lgkmcnt(8)
    v_mfma_f32_32x32x16_bf16 v[48:63], a[116:119], v[172:175], v[48:63]
    v_add_u32 v9, s10, v2
    ds_read_b64_tr_b16 a[108:109], v9 offset:0
    ds_read_b64_tr_b16 a[110:111], v9 offset:512
    v_mfma_f32_32x32x16_bf16 v[192:207], a[120:123], v[172:175], v[192:207]
    ds_read_b64_tr_b16 a[112:113], v9 offset:2048
    ds_read_b64_tr_b16 a[114:115], v9 offset:2560
    s_waitcnt vmcnt(11) lgkmcnt(8)
    v_mfma_f32_32x32x16_bf16 v[48:63], a[92:95], v[176:179], v[48:63]
    ds_read_b64_tr_b16 a[116:117], v9 offset:4096
    ds_read_b64_tr_b16 a[118:119], v9 offset:4608
    s_waitcnt vmcnt(10)
    v_mfma_f32_32x32x16_bf16 v[48:63], a[96:99], v[180:183], v[48:63]
    ds_read_b64_tr_b16 a[120:121], v9 offset:6144
    ds_read_b64_tr_b16 a[122:123], v9 offset:6656
    s_waitcnt vmcnt(9) lgkmcnt(8)
    v_mfma_f32_32x32x16_bf16 v[48:63], a[100:103], v[184:187], v[48:63]
    v_add_u32 v9, s11, v2
    ds_read_b64_tr_b16 a[92:93], v9 offset:0
    ds_read_b64_tr_b16 a[94:95], v9 offset:512
    s_waitcnt vmcnt(8)
    v_mfma_f32_32x32x16_bf16 v[48:63], a[104:107], v[188:191], v[48:63]
    ds_read_b64_tr_b16 a[96:97], v9 offset:2048
    ds_read_b64_tr_b16 a[98:99], v9 offset:2560
    s_waitcnt vmcnt(7) lgkmcnt(8)
    v_mfma_f32_32x32x16_bf16 v[48:63], a[108:111], v[96:99], v[48:63]
    ds_read_b64_tr_b16 a[100:101], v9 offset:4096
    ds_read_b64_tr_b16 a[102:103], v9 offset:4608
    s_waitcnt vmcnt(6)
    v_mfma_f32_32x32x16_bf16 v[48:63], a[112:115], v[100:103], v[48:63]
    ds_read_b64_tr_b16 a[104:105], v9 offset:6144
    ds_read_b64_tr_b16 a[106:107], v9 offset:6656
    s_waitcnt vmcnt(5) lgkmcnt(8)
    v_mfma_f32_32x32x16_bf16 v[48:63], a[116:119], v[104:107], v[48:63]
    v_add_u32 v10, s9, v3
    ds_read_b64_tr_b16 a[108:109], v10 offset:0
    ds_read_b64_tr_b16 a[110:111], v10 offset:512
    s_waitcnt vmcnt(4)
    v_mfma_f32_32x32x16_bf16 v[48:63], a[120:123], v[108:111], v[48:63]
    ds_read_b64_tr_b16 a[112:113], v10 offset:2048
    ds_read_b64_tr_b16 a[114:115], v10 offset:2560
    s_waitcnt vmcnt(3) lgkmcnt(8)
    v_mfma_f32_32x32x16_bf16 v[48:63], a[92:95], v[112:115], v[48:63]
    ds_read_b64_tr_b16 a[116:117], v10 offset:4096
    ds_read_b64_tr_b16 a[118:119], v10 offset:4608
    s_waitcnt vmcnt(2)
    v_mfma_f32_32x32x16_bf16 v[48:63], a[96:99], v[116:119], v[48:63]
    ds_read_b64_tr_b16 a[120:121], v10 offset:6144
    ds_read_b64_tr_b16 a[122:123], v10 offset:6656
    s_waitcnt vmcnt(1) lgkmcnt(8)
    v_mfma_f32_32x32x16_bf16 v[48:63], a[100:103], v[120:123], v[48:63]
    v_add_u32 v10, s10, v3
    ds_read_b64_tr_b16 a[92:93], v10 offset:0
    ds_read_b64_tr_b16 a[94:95], v10 offset:512
    s_waitcnt vmcnt(0)
    v_mfma_f32_32x32x16_bf16 v[48:63], a[104:107], v[124:127], v[48:63]
    ds_read_b64_tr_b16 a[96:97], v10 offset:2048
    ds_read_b64_tr_b16 a[98:99], v10 offset:2560
    s_waitcnt lgkmcnt(8)
    v_mfma_f32_32x32x16_bf16 v[192:207], a[108:111], v[176:179], v[192:207]
    ds_read_b64_tr_b16 a[100:101], v10 offset:4096
    ds_read_b64_tr_b16 a[102:103], v10 offset:4608
    v_mfma_f32_32x32x16_bf16 v[192:207], a[112:115], v[180:183], v[192:207]
    ds_read_b64_tr_b16 a[104:105], v10 offset:6144
    ds_read_b64_tr_b16 a[106:107], v10 offset:6656
    buffer_load_dword v30, v13, s[28:31], s37 offen offset:384 sc1
    s_waitcnt lgkmcnt(8)
    v_mfma_f32_32x32x16_bf16 v[192:207], a[116:119], v[184:187], v[192:207]
    v_add_u32 v10, s11, v3
    ds_read_b64_tr_b16 a[108:109], v10 offset:0
    ds_read_b64_tr_b16 a[110:111], v10 offset:512
    v_mov_b32_sdwa v48, v8 dst_sel:BYTE_0 dst_unused:UNUSED_PRESERVE src0_sel:BYTE_0
    v_mov_b32_sdwa v52, v8 dst_sel:BYTE_0 dst_unused:UNUSED_PRESERVE src0_sel:BYTE_0
    v_mov_b32_sdwa v56, v8 dst_sel:BYTE_0 dst_unused:UNUSED_PRESERVE src0_sel:BYTE_0
    v_mov_b32_sdwa v60, v8 dst_sel:BYTE_0 dst_unused:UNUSED_PRESERVE src0_sel:BYTE_0
    v_mfma_f32_32x32x16_bf16 v[192:207], a[120:123], v[188:191], v[192:207]
    ds_read_b64_tr_b16 a[112:113], v10 offset:2048
    ds_read_b64_tr_b16 a[114:115], v10 offset:2560
    s_not_b32 exec_lo, s13
    s_not_b32 exec_hi, s13
    buffer_store_dwordx4 v[48:51], v6, s[28:31], s36 offen offset:0 sc1
    buffer_store_dwordx4 v[52:55], v6, s[28:31], s36 offen offset:256 sc1
    buffer_store_dwordx4 v[56:59], v6, s[28:31], s36 offen offset:512 sc1
    buffer_store_dwordx4 v[60:63], v6, s[28:31], s36 offen offset:768 sc1
    s_mov_b64 exec, -1
    s_waitcnt lgkmcnt(8)
    v_mfma_f32_32x32x16_bf16 v[192:207], a[92:95], v[96:99], v[192:207]
    ds_read_b64_tr_b16 a[116:117], v10 offset:4096
    ds_read_b64_tr_b16 a[118:119], v10 offset:4608
    v_mfma_f32_32x32x16_bf16 v[192:207], a[96:99], v[100:103], v[192:207]
    ds_read_b64_tr_b16 a[120:121], v10 offset:6144
    ds_read_b64_tr_b16 a[122:123], v10 offset:6656
    s_waitcnt lgkmcnt(8)
    v_mfma_f32_32x32x16_bf16 v[192:207], a[100:103], v[104:107], v[192:207]
    v_mfma_f32_32x32x16_bf16 v[192:207], a[104:107], v[108:111], v[192:207]
    s_waitcnt lgkmcnt(4)
    v_mfma_f32_32x32x16_bf16 v[192:207], a[108:111], v[112:115], v[192:207]
    v_mfma_f32_32x32x16_bf16 v[192:207], a[112:115], v[116:119], v[192:207]
    s_waitcnt lgkmcnt(0)
    v_mfma_f32_32x32x16_bf16 v[192:207], a[116:119], v[120:123], v[192:207]
    s_mov_b32 exec_lo, s13
    s_mov_b32 exec_hi, s13
    ds_write_b128 v11, v[48:51] offset:0
    ds_write_b128 v11, v[52:55] offset:256
    ds_write_b128 v11, v[56:59] offset:512
    ds_write_b128 v11, v[60:63] offset:768
    s_mov_b64 exec, -1
    v_mfma_f32_32x32x16_bf16 v[192:207], a[120:123], v[124:127], v[192:207]
A_tail:
    s_nop 11
    v_mov_b32_sdwa v192, v8 dst_sel:BYTE_0 dst_unused:UNUSED_PRESERVE src0_sel:BYTE_0
    v_mov_b32_sdwa v196, v8 dst_sel:BYTE_0 dst_unused:UNUSED_PRESERVE src0_sel:BYTE_0
    v_mov_b32_sdwa v200, v8 dst_sel:BYTE_0 dst_unused:UNUSED_PRESERVE src0_sel:BYTE_0
    v_mov_b32_sdwa v204, v8 dst_sel:BYTE_0 dst_unused:UNUSED_PRESERVE src0_sel:BYTE_0
    s_not_b32 exec_lo, s13
    s_not_b32 exec_hi, s13
    buffer_store_dwordx4 v[192:195], v6, s[28:31], s36 offen offset:1024 sc1
    buffer_store_dwordx4 v[196:199], v6, s[28:31], s36 offen offset:1280 sc1
    buffer_store_dwordx4 v[200:203], v6, s[28:31], s36 offen offset:1536 sc1
    buffer_store_dwordx4 v[204:207], v6, s[28:31], s36 offen offset:1792 sc1
    s_mov_b64 exec, -1
    s_waitcnt vmcnt(8)
    v_cmp_ne_u32_sdwa vcc, v30, s39 src0_sel:BYTE_0 src1_sel:DWORD
    s_cbranch_vccz A_p2
A_p2s:
    buffer_load_dword v30, v13, s[28:31], s37 offen offset:384 sc1
    s_sub_u32 s57, s57, 1
    s_cbranch_scc1 A_end
    s_waitcnt vmcnt(0)
    v_cmp_ne_u32_sdwa vcc, v30, s39 src0_sel:BYTE_0 src1_sel:DWORD
    s_cbranch_vccnz A_p2s
A_p2:
    buffer_load_dwordx4 v[96:99], v1, s[28:31], s17 offen offset:0 sc1
    buffer_load_dwordx4 v[100:103], v1, s[28:31], s17 offen offset:1024 sc1
    buffer_load_dwordx4 v[104:107], v1, s[28:31], s100 offen offset:0 sc1
    buffer_load_dwordx4 v[108:111], v1, s[28:31], s100 offen offset:1024 sc1
    buffer_load_dwordx4 v[112:115], v1, s[28:31], s101 offen offset:0 sc1
    buffer_load_dwordx4 v[116:119], v1, s[28:31], s101 offen offset:1024 sc1
    s_mov_b32 exec_lo, s13
    s_mov_b32 exec_hi, s13
    ds_write_b128 v11, v[192:195] offset:1024
    ds_write_b128 v11, v[196:199] offset:1280
    ds_write_b128 v11, v[200:203] offset:1536
    ds_write_b128 v11, v[204:207] offset:1792
    s_mov_b64 exec, -1
    s_sub_u32 s57, s57, 1
    s_cbranch_scc1 A_end
    s_waitcnt lgkmcnt(0)
    ds_read_b128 v[120:123], v12 offset:0
    ds_read_b128 v[124:127], v12 offset:1024
    s_waitcnt lgkmcnt(0)
    v_xor_b32 v120, s39, v120
    v_xor_b32 v124, s39, v124
    s_waitcnt vmcnt(4)
    v_xor_b32 v96, s39, v96
    v_xor_b32 v100, s39, v100
    v_or_b32 v28, v96, v100
    v_add_f32 v128, v96, v120
    v_add_f32 v129, v97, v121
    v_add_f32 v130, v98, v122
    v_add_f32 v131, v99, v123
    v_add_f32 v132, v100, v124
    v_add_f32 v133, v101, v125
    v_add_f32 v134, v102, v126
    v_add_f32 v135, v103, v127
    s_waitcnt vmcnt(2)
    v_xor_b32 v104, s39, v104
    v_xor_b32 v108, s39, v108
    v_or3_b32 v28, v28, v104, v108
    v_add_f32 v128, v104, v128
    v_add_f32 v129, v105, v129
    v_add_f32 v130, v106, v130
    v_add_f32 v131, v107, v131
    v_add_f32 v132, v108, v132
    v_add_f32 v133, v109, v133
    v_add_f32 v134, v110, v134
    v_add_f32 v135, v111, v135
    s_waitcnt vmcnt(0)
    v_xor_b32 v112, s39, v112
    v_xor_b32 v116, s39, v116
    v_or3_b32 v28, v28, v112, v116
    v_and_b32 v28, 255, v28
    v_cmp_ne_u32 vcc, 0, v28
    v_add_f32 v128, v112, v128
    v_add_f32 v129, v113, v129
    v_add_f32 v130, v114, v130
    v_add_f32 v131, v115, v131
    v_add_f32 v132, v116, v132
    v_add_f32 v133, v117, v133
    v_add_f32 v134, v118, v134
    v_add_f32 v135, v119, v135
    v_cvt_pk_bf16_f32 v64, v128, v129
    v_cvt_pk_bf16_f32 v65, v130, v131
    v_cvt_pk_bf16_f32 v66, v132, v133
    v_cvt_pk_bf16_f32 v67, v134, v135
    s_cbranch_vccnz A_p2
    buffer_store_dword v8, off, s[84:87], 0 sc1
    buffer_store_dwordx2 v[64:65], v7, s[48:51], s38 offen offset:0 nt
    buffer_store_dwordx2 v[66:67], v7, s[48:51], s38 offen offset:64 nt
A_end:
    s_endpgm
A_late:
    s_getpc_b64 s[44:45]
    s_andn2_b32 s22, s53, s54
    s_cbranch_scc0 A_selslow
    s_ff1_i32_b32 s22, s22
    s_bitset1_b32 s54, s22
    v_readlane_b32 s99, v19, s22
    v_readlane_b32 s9, v20, s22
    s_nop 3
    buffer_load_dwordx4 v[96:99], v1, s[40:43], s99 offen offset:0 sc1
    buffer_load_dwordx4 v[100:103], v1, s[40:43], s99 offen offset:1024 sc1
    buffer_load_dwordx4 v[104:107], v1, s[40:43], s99 offen offset:2048 sc1
    buffer_load_dwordx4 v[108:111], v1, s[40:43], s99 offen offset:3072 sc1
    s_getpc_b64 s[44:45]
    s_cbranch_vccnz A_spin
    v_add_u32 v17, s94, v17
    ds_read_b64_tr_b16 a[0:1], v17 offset:0
    ds_read_b64_tr_b16 a[2:3], v17 offset:1024
    v_mfma_f32_32x32x16_bf16 v[80:95], a[12:15], v[140:143], v[80:95]
    v_add_u32 v18, s94, v18
    ds_read_b64_tr_b16 a[4:5], v18 offset:0
    ds_read_b64_tr_b16 a[6:7], v18 offset:1024
    s_waitcnt lgkmcnt(8)
    v_mfma_f32_32x32x16_bf16 v[64:79], a[16:19], v[144:147], v[64:79]
    ds_read_b64_tr_b16 a[8:9], v17 offset:2048
    ds_read_b64_tr_b16 a[10:11], v17 offset:3072
    v_mfma_f32_32x32x16_bf16 v[80:95], a[20:23], v[144:147], v[80:95]
    ds_read_b64_tr_b16 a[12:13], v18 offset:2048
    ds_read_b64_tr_b16 a[14:15], v18 offset:3072
    s_waitcnt lgkmcnt(8)
    v_mfma_f32_32x32x16_bf16 v[64:79], a[24:27], v[148:151], v[64:79]
    ds_read_b64_tr_b16 a[16:17], v17 offset:4096
    ds_read_b64_tr_b16 a[18:19], v17 offset:5120
    v_mfma_f32_32x32x16_bf16 v[80:95], a[28:31], v[148:151], v[80:95]
    v_mov_b32 v26, 30
    ds_write_b32 v23, v26
    ds_read_b64_tr_b16 a[20:21], v18 offset:4096
    ds_read_b64_tr_b16 a[22:23], v18 offset:5120
    s_waitcnt lgkmcnt(9)
    v_mfma_f32_32x32x16_bf16 v[64:79], a[0:3], v[152:155], v[64:79]
    ds_read_b64_tr_b16 a[24:25], v17 offset:6144
    ds_read_b64_tr_b16 a[26:27], v17 offset:7168
    v_mfma_f32_32x32x16_bf16 v[80:95], a[4:7], v[152:155], v[80:95]
    ds_read_b64_tr_b16 a[28:29], v18 offset:6144
    ds_read_b64_tr_b16 a[30:31], v18 offset:7168
    s_waitcnt lgkmcnt(9)
    v_mfma_f32_32x32x16_bf16 v[64:79], a[8:11], v[156:159], v[64:79]
    ds_read_b64_tr_b16 a[0:1], v17 offset:8192
    ds_read_b64_tr_b16 a[2:3], v17 offset:9216
    v_mfma_f32_32x32x16_bf16 v[80:95], a[12:15], v[156:159], v[80:95]
    ds_read_b64_tr_b16 a[4:5], v18 offset:8192
    ds_read_b64_tr_b16 a[6:7], v18 offset:9216
    s_waitcnt lgkmcnt(8)
    v_mfma_f32_32x32x16_bf16 v[64:79], a[16:19], v[160:163], v[64:79]
    ds_read_b64_tr_b16 a[8:9], v17 offset:10240
    ds_read_b64_tr_b16 a[10:11], v17 offset:11264
    v_mfma_f32_32x32x16_bf16 v[80:95], a[20:23], v[160:163], v[80:95]
    ds_read_b64_tr_b16 a[12:13], v18 offset:10240
    ds_read_b64_tr_b16 a[14:15], v18 offset:11264
    s_waitcnt lgkmcnt(8)
    v_mfma_f32_32x32x16_bf16 v[64:79], a[24:27], v[164:167], v[64:79]
    ds_read_b64_tr_b16 a[16:17], v17 offset:12288
    ds_read_b64_tr_b16 a[18:19], v17 offset:13312
    v_mfma_f32_32x32x16_bf16 v[80:95], a[28:31], v[164:167], v[80:95]
    ds_read_b64_tr_b16 a[20:21], v18 offset:12288
    ds_read_b64_tr_b16 a[22:23], v18 offset:13312
    s_waitcnt lgkmcnt(8)
    v_mfma_f32_32x32x16_bf16 v[64:79], a[0:3], v[208:211], v[64:79]
    ds_read_b64_tr_b16 a[24:25], v17 offset:14336
    ds_read_b64_tr_b16 a[26:27], v17 offset:15360
    buffer_load_dword v27, v4, s[24:27], 0 offen sc1
    v_mfma_f32_32x32x16_bf16 v[80:95], a[4:7], v[208:211], v[80:95]
    ds_read_b64_tr_b16 a[28:29], v18 offset:14336
    ds_read_b64_tr_b16 a[30:31], v18 offset:15360
    s_waitcnt lgkmcnt(8)
    v_mfma_f32_32x32x16_bf16 v[64:79], a[8:11], v[212:215], v[64:79]
    v_add_u32 v9, s96, v2
    ds_read_b64_tr_b16 a[92:93], v9 offset:0
    ds_read_b64_tr_b16 a[94:95], v9 offset:512
    v_mfma_f32_32x32x16_bf16 v[80:95], a[12:15], v[212:215], v[80:95]
    v_add_u32 v10, s96, v3
    ds_read_b64_tr_b16 a[96:97], v10 offset:0
    ds_read_b64_tr_b16 a[98:99], v10 offset:512
    s_waitcnt lgkmcnt(8)
    v_mfma_f32_32x32x16_bf16 v[64:79], a[16:19], v[168:171], v[64:79]
    ds_read_b64_tr_b16 a[100:101], v9 offset:2048
    ds_read_b64_tr_b16 a[102:103], v9 offset:2560
    v_mfma_f32_32x32x16_bf16 v[80:95], a[20:23], v[168:171], v[80:95]
    ds_read_b64_tr_b16 a[104:105], v10 offset:2048
    ds_read_b64_tr_b16 a[106:107], v10 offset:2560
    s_waitcnt lgkmcnt(8)
    v_mfma_f32_32x32x16_bf16 v[64:79], a[24:27], v[172:175], v[64:79]
    ds_read_b64_tr_b16 a[108:109], v9 offset:4096
    ds_read_b64_tr_b16 a[110:111], v9 offset:4608
    v_mfma_f32_32x32x16_bf16 v[80:95], a[28:31], v[172:175], v[80:95]
    v_mov_b32 v26, 31
    ds_write_b32 v23, v26
    ds_read_b64_tr_b16 a[112:113], v10 offset:4096
    ds_read_b64_tr_b16 a[114:115], v10 offset:4608
    s_waitcnt lgkmcnt(9)
    v_mfma_f32_32x32x16_bf16 v[48:63], a[92:95], v[32:35], 0
    ds_read_b64_tr_b16 a[116:117], v9 offset:6144
    ds_read_b64_tr_b16 a[118:119], v9 offset:6656
    v_mfma_f32_32x32x16_bf16 v[192:207], a[96:99], v[32:35], 0
    ds_read_b64_tr_b16 a[120:121], v10 offset:6144
    ds_read_b64_tr_b16 a[122:123], v10 offset:6656
    s_waitcnt lgkmcnt(9)
    v_mfma_f32_32x32x16_bf16 v[48:63], a[100:103], v[36:39], v[48:63]
    v_add_u32 v9, s9, v2
    ds_read_b64_tr_b16 a[92:93], v9 offset:0
    ds_read_b64_tr_b16 a[94:95], v9 offset:512
    v_mfma_f32_32x32x16_bf16 v[192:207], a[104:107], v[36:39], v[192:207]
    v_add_u32 v10, s9, v3
    ds_read_b64_tr_b16 a[96:97], v10 offset:0
    ds_read_b64_tr_b16 a[98:99], v10 offset:512
    s_waitcnt lgkmcnt(8)
    v_mfma_f32_32x32x16_bf16 v[48:63], a[108:111], v[40:43], v[48:63]
    ds_read_b64_tr_b16 a[100:101], v9 offset:2048
    ds_read_b64_tr_b16 a[102:103], v9 offset:2560
    v_mfma_f32_32x32x16_bf16 v[192:207], a[112:115], v[40:43], v[192:207]
    ds_read_b64_tr_b16 a[104:105], v10 offset:2048
    ds_read_b64_tr_b16 a[106:107], v10 offset:2560
    s_waitcnt lgkmcnt(8)
    v_mfma_f32_32x32x16_bf16 v[48:63], a[116:119], v[44:47], v[48:63]
    ds_read_b64_tr_b16 a[108:109], v9 offset:4096
    ds_read_b64_tr_b16 a[110:111], v9 offset:4608
    v_mfma_f32_32x32x16_bf16 v[192:207], a[120:123], v[44:47], v[192:207]
    ds_read_b32 v21, v22
    ds_read_b64_tr_b16 a[112:113], v10 offset:4096
    ds_read_b64_tr_b16 a[114:115], v10 offset:4608
    s_waitcnt vmcnt(4) lgkmcnt(9)
    v_mfma_f32_32x32x16_bf16 v[48:63], a[92:95], v[96:99], v[48:63]
    ds_read_b64_tr_b16 a[116:117], v9 offset:6144
    ds_read_b64_tr_b16 a[118:119], v9 offset:6656
    v_mfma_f32_32x32x16_bf16 v[192:207], a[96:99], v[96:99], v[192:207]
    s_waitcnt lgkmcnt(4)
    s_movk_i32 s59, 31
    v_cmp_ge_u32 vcc, s59, v21
    ds_read_b64_tr_b16 a[120:121], v10 offset:6144
    ds_read_b64_tr_b16 a[122:123], v10 offset:6656
    s_waitcnt vmcnt(3)
    v_mfma_f32_32x32x16_bf16 v[48:63], a[100:103], v[100:103], v[48:63]
    s_getpc_b64 s[44:45]
    s_cbranch_vccnz A_spin
    v_add_u32 v17, s95, v17
    ds_read_b64_tr_b16 a[0:1], v17 offset:0
    ds_read_b64_tr_b16 a[2:3], v17 offset:1024
    v_mfma_f32_32x32x16_bf16 v[192:207], a[104:107], v[100:103], v[192:207]
    v_add_u32 v18, s95, v18
    ds_read_b64_tr_b16 a[4:5], v18 offset:0
    ds_read_b64_tr_b16 a[6:7], v18 offset:1024
    s_waitcnt vmcnt(2) lgkmcnt(8)
    v_mfma_f32_32x32x16_bf16 v[48:63], a[108:111], v[104:107], v[48:63]
    ds_read_b64_tr_b16 a[8:9], v17 offset:2048
    ds_read_b64_tr_b16 a[10:11], v17 offset:3072
    s_waitcnt vmcnt(0)
    v_cmp_eq_u32 s[22:23], s56, v27
    s_nop 0
    s_or_b32 s53, s53, s22
    v_mfma_f32_32x32x16_bf16 v[192:207], a[112:115], v[104:107], v[192:207]
    ds_read_b64_tr_b16 a[12:13], v18 offset:2048
    ds_read_b64_tr_b16 a[14:15], v18 offset:3072
    s_getpc_b64 s[44:45]
    s_andn2_b32 s22, s53, s54
    s_cbranch_scc0 A_selslow
    s_waitcnt lgkmcnt(8)
    v_mfma_f32_32x32x16_bf16 v[48:63], a[116:119], v[108:111], v[48:63]
    ds_read_b64_tr_b16 a[16:17], v17 offset:4096
    ds_read_b64_tr_b16 a[18:19], v17 offset:5120
    s_ff1_i32_b32 s22, s22
    s_bitset1_b32 s54, s22
    v_readlane_b32 s98, v19, s22
    v_readlane_b32 s10, v20, s22
    buffer_load_dword v27, v4, s[24:27], 0 offen sc1
    v_mfma_f32_32x32x16_bf16 v[192:207], a[120:123], v[108:111], v[192:207]
    ds_read_b32 v21, v22
    ds_read_b64_tr_b16 a[20:21], v18 offset:4096
    ds_read_b64_tr_b16 a[22:23], v18 offset:5120
    buffer_load_dwordx4 v[112:115], v1, s[40:43], s98 offen offset:0 sc1
    s_waitcnt lgkmcnt(9)
    v_mfma_f32_32x32x16_bf16 v[64:79], a[0:3], v[176:179], v[64:79]
    ds_read_b64_tr_b16 a[24:25], v17 offset:6144
    ds_read_b64_tr_b16 a[26:27], v17 offset:7168
    buffer_load_dwordx4 v[116:119], v1, s[40:43], s98 offen offset:1024 sc1
    v_mfma_f32_32x32x16_bf16 v[80:95], a[4:7], v[176:179], v[80:95]
    s_waitcnt lgkmcnt(4)
    s_movk_i32 s59, 32
    v_cmp_ge_u32 vcc, s59, v21
    ds_read_b64_tr_b16 a[28:29], v18 offset:6144
    ds_read_b64_tr_b16 a[30:31], v18 offset:7168
    buffer_load_dwordx4 v[120:123], v1, s[40:43], s98 offen offset:2048 sc1
    v_mfma_f32_32x32x16_bf16 v[64:79], a[8:11], v[180:183], v[64:79]
    s_getpc_b64 s[44:45]
    s_cbranch_vccnz A_spin
    ds_read_b64_tr_b16 a[0:1], v17 offset:8192
    ds_read_b64_tr_b16 a[2:3], v17 offset:9216
    buffer_load_dwordx4 v[124:127], v1, s[40:43], s98 offen offset:3072 sc1
    v_mfma_f32_32x32x16_bf16 v[80:95], a[12:15], v[180:183], v[80:95]
    ds_read_b64_tr_b16 a[4:5], v18 offset:8192
    ds_read_b64_tr_b16 a[6:7], v18 offset:9216
    s_waitcnt lgkmcnt(8)
    v_mfma_f32_32x32x16_bf16 v[64:79], a[16:19], v[184:187], v[64:79]
    ds_read_b64_tr_b16 a[8:9], v17 offset:10240
    ds_read_b64_tr_b16 a[10:11], v17 offset:11264
    s_getpc_b64 s[44:45]
    s_andn2_b32 s22, s53, s54
    s_cbranch_scc0 A_selslow
    v_mfma_f32_32x32x16_bf16 v[80:95], a[20:23], v[184:187], v[80:95]
    ds_read_b64_tr_b16 a[12:13], v18 offset:10240
    ds_read_b64_tr_b16 a[14:15], v18 offset:11264
    s_ff1_i32_b32 s22, s22
    s_bitset1_b32 s54, s22
    v_readlane_b32 s99, v19, s22
    v_readlane_b32 s11, v20, s22
    s_waitcnt lgkmcnt(8)
    v_mfma_f32_32x32x16_bf16 v[64:79], a[24:27], v[188:191], v[64:79]
    ds_read_b64_tr_b16 a[16:17], v17 offset:12288
    ds_read_b64_tr_b16 a[18:19], v17 offset:13312
    buffer_load_dwordx4 v[128:131], v1, s[40:43], s99 offen offset:0 sc1
    v_mfma_f32_32x32x16_bf16 v[80:95], a[28:31], v[188:191], v[80:95]
    ds_read_b64_tr_b16 a[20:21], v18 offset:12288
    ds_read_b64_tr_b16 a[22:23], v18 offset:13312
    buffer_load_dwordx4 v[132:135], v1, s[40:43], s99 offen offset:1024 sc1
    s_waitcnt lgkmcnt(8)
    v_mfma_f32_32x32x16_bf16 v[64:79], a[0:3], v[224:227], v[64:79]
    ds_read_b64_tr_b16 a[24:25], v17 offset:14336
    ds_read_b64_tr_b16 a[26:27], v17 offset:15360
    buffer_load_dwordx4 v[136:139], v1, s[40:43], s99 offen offset:2048 sc1
    v_mfma_f32_32x32x16_bf16 v[80:95], a[4:7], v[224:227], v[80:95]
    ds_read_b64_tr_b16 a[28:29], v18 offset:14336
    ds_read_b64_tr_b16 a[30:31], v18 offset:15360
    buffer_load_dwordx4 v[140:143], v1, s[40:43], s99 offen offset:3072 sc1
    s_waitcnt lgkmcnt(8)
    v_mfma_f32_32x32x16_bf16 v[64:79], a[8:11], v[228:231], v[64:79]
    v_add_u32 v9, s10, v2
    ds_read_b64_tr_b16 a[92:93], v9 offset:0
    ds_read_b64_tr_b16 a[94:95], v9 offset:512
    v_mfma_f32_32x32x16_bf16 v[80:95], a[12:15], v[228:231], v[80:95]
    v_add_u32 v10, s10, v3
    ds_read_b64_tr_b16 a[96:97], v10 offset:0
    ds_read_b64_tr_b16 a[98:99], v10 offset:512
    s_waitcnt lgkmcnt(8)
    v_mfma_f32_32x32x16_bf16 v[64:79], a[16:19], v[240:243], v[64:79]
    ds_read_b64_tr_b16 a[100:101], v9 offset:2048
    ds_read_b64_tr_b16 a[102:103], v9 offset:2560
    s_waitcnt vmcnt(8)
    v_cmp_eq_u32 s[22:23], s56, v27
    s_nop 0
    s_or_b32 s53, s53, s22
    v_mfma_f32_32x32x16_bf16 v[80:95], a[20:23], v[240:243], v[80:95]
    ds_read_b64_tr_b16 a[104:105], v10 offset:2048
    ds_read_b64_tr_b16 a[106:107], v10 offset:2560
    s_getpc_b64 s[44:45]
    s_andn2_b32 s22, s53, s54
    s_cbranch_scc0 A_selslow
    s_waitcnt lgkmcnt(8)
    v_mfma_f32_32x32x16_bf16 v[64:79], a[24:27], v[244:247], v[64:79]
    ds_read_b64_tr_b16 a[108:109], v9 offset:4096
    ds_read_b64_tr_b16 a[110:111], v9 offset:4608
    s_ff1_i32_b32 s22, s22
    s_bitset1_b32 s54, s22
    v_readlane_b32 s98, v19, s22
    v_readlane_b32 s8, v20, s22
    buffer_load_dword v27, v4, s[24:27], 0 offen sc1
    v_mfma_f32_32x32x16_bf16 v[80:95], a[28:31], v[244:247], v[80:95]
    ds_read_b64_tr_b16 a[112:113], v10 offset:4096
    ds_read_b64_tr_b16 a[114:115], v10 offset:4608
    buffer_load_dwordx4 v[144:147], v1, s[40:43], s98 offen offset:0 sc1
    s_waitcnt vmcnt(9) lgkmcnt(8)
    v_mfma_f32_32x32x16_bf16 v[48:63], a[92:95], v[112:115], v[48:63]
    ds_read_b64_tr_b16 a[116:117], v9 offset:6144
    ds_read_b64_tr_b16 a[118:119], v9 offset:6656
    buffer_load_dwordx4 v[148:151], v1, s[40:43], s98 offen offset:1024 sc1
    v_mfma_f32_32x32x16_bf16 v[192:207], a[96:99], v[112:115], v[192:207]
    ds_read_b64_tr_b16 a[120:121], v10 offset:6144
    ds_read_b64_tr_b16 a[122:123], v10 offset:6656
    buffer_load_dwordx4 v[152:155], v1, s[40:43], s98 offen offset:2048 sc1
    s_waitcnt vmcnt(10) lgkmcnt(8)
    v_mfma_f32_32x32x16_bf16 v[48:63], a[100:103], v[116:119], v[48:63]
    v_add_u32 v9, s11, v2
    ds_read_b64_tr_b16 a[92:93], v9 offset:0
    ds_read_b64_tr_b16 a[94:95], v9 offset:512
    v_pk_mul_f32 v[64:65], v[64:65], v[28:29] op_sel_hi:[1,0]
    v_pk_mul_f32 v[66:67], v[66:67], v[28:29] op_sel_hi:[1,0]
    v_pk_mul_f32 v[68:69], v[68:69], v[28:29] op_sel_hi:[1,0]
    v_pk_mul_f32 v[70:71], v[70:71], v[28:29] op_sel_hi:[1,0]
    v_pk_mul_f32 v[72:73], v[72:73], v[28:29] op_sel_hi:[1,0]
    v_pk_mul_f32 v[74:75], v[74:75], v[28:29] op_sel_hi:[1,0]
    v_pk_mul_f32 v[76:77], v[76:77], v[28:29] op_sel_hi:[1,0]
    v_pk_mul_f32 v[78:79], v[78:79], v[28:29] op_sel_hi:[1,0]
    v_cvt_pk_bf16_f32 v64, v64, v65
    buffer_load_dwordx4 v[156:159], v1, s[40:43], s98 offen offset:3072 sc1
    v_mfma_f32_32x32x16_bf16 v[192:207], a[104:107], v[116:119], v[192:207]
    v_add_u32 v10, s11, v3
    ds_read_b64_tr_b16 a[96:97], v10 offset:0
    ds_read_b64_tr_b16 a[98:99], v10 offset:512
    v_cvt_pk_bf16_f32 v65, v66, v67
    v_cvt_pk_bf16_f32 v66, v68, v69
    v_cvt_pk_bf16_f32 v67, v70, v71
    buffer_store_dwordx4 v[64:67], v1, s[40:43], s35 offen offset:0 sc1
    v_cvt_pk_bf16_f32 v68, v72, v73
    v_cvt_pk_bf16_f32 v69, v74, v75
    v_cvt_pk_bf16_f32 v70, v76, v77
    v_cvt_pk_bf16_f32 v71, v78, v79
    buffer_store_dwordx4 v[68:71], v1, s[40:43], s35 offen offset:1024 sc1
    s_waitcnt vmcnt(12) lgkmcnt(8)
    v_mfma_f32_32x32x16_bf16 v[48:63], a[108:111], v[120:123], v[48:63]
    ds_read_b64_tr_b16 a[100:101], v9 offset:2048
    ds_read_b64_tr_b16 a[102:103], v9 offset:2560
    v_pk_mul_f32 v[80:81], v[80:81], v[28:29] op_sel_hi:[1,0]
    v_pk_mul_f32 v[82:83], v[82:83], v[28:29] op_sel_hi:[1,0]
    v_pk_mul_f32 v[84:85], v[84:85], v[28:29] op_sel_hi:[1,0]
    v_pk_mul_f32 v[86:87], v[86:87], v[28:29] op_sel_hi:[1,0]
    v_pk_mul_f32 v[88:89], v[88:89], v[28:29] op_sel_hi:[1,0]
    v_pk_mul_f32 v[90:91], v[90:91], v[28:29] op_sel_hi:[1,0]
    v_pk_mul_f32 v[92:93], v[92:93], v[28:29] op_sel_hi:[1,0]
    v_pk_mul_f32 v[94:95], v[94:95], v[28:29] op_sel_hi:[1,0]
    v_cvt_pk_bf16_f32 v72, v80, v81
    s_getpc_b64 s[44:45]
    s_andn2_b32 s22, s53, s54
    s_cbranch_scc0 A_selslow
    v_mfma_f32_32x32x16_bf16 v[192:207], a[112:115], v[120:123], v[192:207]
    ds_read_b64_tr_b16 a[104:105], v10 offset:2048
    ds_read_b64_tr_b16 a[106:107], v10 offset:2560
    v_cvt_pk_bf16_f32 v73, v82, v83
    v_cvt_pk_bf16_f32 v74, v84, v85
    v_cvt_pk_bf16_f32 v75, v86, v87
    buffer_store_dwordx4 v[72:75], v1, s[40:43], s35 offen offset:2048 sc1
    v_cvt_pk_bf16_f32 v76, v88, v89
    v_cvt_pk_bf16_f32 v77, v90, v91
    v_cvt_pk_bf16_f32 v78, v92, v93
    v_cvt_pk_bf16_f32 v79, v94, v95
    buffer_store_dwordx4 v[76:79], v1, s[40:43], s35 offen offset:3072 sc1
    s_ff1_i32_b32 s22, s22
    s_bitset1_b32 s54, s22
    v_readlane_b32 s99, v19, s22
    v_readlane_b32 s9, v20, s22
    s_waitcnt vmcnt(13) lgkmcnt(8)
    v_mfma_f32_32x32x16_bf16 v[48:63], a[116:119], v[124:127], v[48:63]
    ds_read_b64_tr_b16 a[108:109], v9 offset:4096
    ds_read_b64_tr_b16 a[110:111], v9 offset:4608
    buffer_load_dwordx4 v[160:163], v1, s[40:43], s99 offen offset:0 sc1
    v_mfma_f32_32x32x16_bf16 v[192:207], a[120:123], v[124:127], v[192:207]
    ds_read_b64_tr_b16 a[112:113], v10 offset:4096
    ds_read_b64_tr_b16 a[114:115], v10 offset:4608
    buffer_load_dwordx4 v[164:167], v1, s[40:43], s99 offen offset:1024 sc1
    s_waitcnt vmcnt(14) lgkmcnt(8)
    v_mfma_f32_32x32x16_bf16 v[48:63], a[92:95], v[128:131], v[48:63]
    ds_read_b64_tr_b16 a[116:117], v9 offset:6144
    ds_read_b64_tr_b16 a[118:119], v9 offset:6656
    buffer_load_dwordx4 v[168:171], v1, s[40:43], s99 offen offset:2048 sc1
    v_mfma_f32_32x32x16_bf16 v[192:207], a[96:99], v[128:131], v[192:207]
    ds_read_b64_tr_b16 a[120:121], v10 offset:6144
    ds_read_b64_tr_b16 a[122:123], v10 offset:6656
    buffer_load_dwordx4 v[172:175], v1, s[40:43], s99 offen offset:3072 sc1
    s_waitcnt vmcnt(15) lgkmcnt(8)
    v_mfma_f32_32x32x16_bf16 v[48:63], a[100:103], v[132:135], v[48:63]
    v_add_u32 v9, s8, v2
    ds_read_b64_tr_b16 a[92:93], v9 offset:0
    ds_read_b64_tr_b16 a[94:95], v9 offset:512
    v_mfma_f32_32x32x16_bf16 v[192:207], a[104:107], v[132:135], v[192:207]
    v_add_u32 v10, s8, v3
    ds_read_b64_tr_b16 a[96:97], v10 offset:0
    ds_read_b64_tr_b16 a[98:99], v10 offset:512
    s_waitcnt vmcnt(14) lgkmcnt(8)
    v_mfma_f32_32x32x16_bf16 v[48:63], a[108:111], v[136:139], v[48:63]
    ds_read_b64_tr_b16 a[100:101], v9 offset:2048
    ds_read_b64_tr_b16 a[102:103], v9 offset:2560
    s_waitcnt vmcnt(12)
    v_cmp_eq_u32 s[22:23], s56, v27
    s_nop 0
    s_or_b32 s53, s53, s22
    v_mfma_f32_32x32x16_bf16 v[192:207], a[112:115], v[136:139], v[192:207]
    ds_read_b64_tr_b16 a[104:105], v10 offset:2048
    ds_read_b64_tr_b16 a[106:107], v10 offset:2560
    s_getpc_b64 s[44:45]
    s_andn2_b32 s22, s53, s54
    s_cbranch_scc0 A_selslow
    s_waitcnt lgkmcnt(8)
    v_mfma_f32_32x32x16_bf16 v[48:63], a[116:119], v[140:143], v[48:63]
    ds_read_b64_tr_b16 a[108:109], v9 offset:4096
    ds_read_b64_tr_b16 a[110:111], v9 offset:4608
    s_ff1_i32_b32 s22, s22
    s_bitset1_b32 s54, s22
    v_readlane_b32 s98, v19, s22
    v_readlane_b32 s10, v20, s22
    buffer_load_dword v27, v4, s[24:27], 0 offen sc1
    v_mfma_f32_32x32x16_bf16 v[192:207], a[120:123], v[140:143], v[192:207]
    ds_read_b64_tr_b16 a[112:113], v10 offset:4096
    ds_read_b64_tr_b16 a[114:115], v10 offset:4608
    buffer_load_dwordx4 v[176:179], v1, s[40:43], s98 offen offset:0 sc1
    s_waitcnt vmcnt(13) lgkmcnt(8)
    v_mfma_f32_32x32x16_bf16 v[48:63], a[92:95], v[144:147], v[48:63]
    ds_read_b64_tr_b16 a[116:117], v9 offset:6144
    ds_read_b64_tr_b16 a[118:119], v9 offset:6656
    buffer_load_dwordx4 v[180:183], v1, s[40:43], s98 offen offset:1024 sc1
    v_mfma_f32_32x32x16_bf16 v[192:207], a[96:99], v[144:147], v[192:207]
    ds_read_b64_tr_b16 a[120:121], v10 offset:6144
    ds_read_b64_tr_b16 a[122:123], v10 offset:6656
    buffer_load_dwordx4 v[184:187], v1, s[40:43], s98 offen offset:2048 sc1
    s_waitcnt vmcnt(14) lgkmcnt(8)
    v_mfma_f32_32x32x16_bf16 v[48:63], a[100:103], v[148:151], v[48:63]
    v_add_u32 v9, s9, v2
    ds_read_b64_tr_b16 a[92:93], v9 offset:0
    ds_read_b64_tr_b16 a[94:95], v9 offset:512
    buffer_load_dwordx4 v[188:191], v1, s[40:43], s98 offen offset:3072 sc1
    v_mfma_f32_32x32x16_bf16 v[192:207], a[104:107], v[148:151], v[192:207]
    v_add_u32 v10, s9, v3
    ds_read_b64_tr_b16 a[96:97], v10 offset:0
    ds_read_b64_tr_b16 a[98:99], v10 offset:512
    s_waitcnt vmcnt(14) lgkmcnt(8)
    v_mfma_f32_32x32x16_bf16 v[48:63], a[108:111], v[152:155], v[48:63]
    ds_read_b64_tr_b16 a[100:101], v9 offset:2048
    ds_read_b64_tr_b16 a[102:103], v9 offset:2560
    s_waitcnt vmcnt(9)
    s_mov_b64 exec, 1
    buffer_store_dword v8, v5, s[24:27], 0 offen offset:32
    buffer_store_dword v8, v5, s[24:27], 0 offen offset:160 sc1
    s_mov_b64 exec, -1
    s_mov_b32 s12, 1
    s_getpc_b64 s[44:45]
    s_andn2_b32 s22, s53, s54
    s_cbranch_scc0 A_selslow
    v_mfma_f32_32x32x16_bf16 v[192:207], a[112:115], v[152:155], v[192:207]
    ds_read_b64_tr_b16 a[104:105], v10 offset:2048
    ds_read_b64_tr_b16 a[106:107], v10 offset:2560
    s_ff1_i32_b32 s22, s22
    s_bitset1_b32 s54, s22
    v_readlane_b32 s99, v19, s22
    v_readlane_b32 s11, v20, s22
    s_waitcnt lgkmcnt(8)
    v_mfma_f32_32x32x16_bf16 v[48:63], a[116:119], v[156:159], v[48:63]
    ds_read_b64_tr_b16 a[108:109], v9 offset:4096
    ds_read_b64_tr_b16 a[110:111], v9 offset:4608
    buffer_load_dwordx4 v[96:99], v1, s[40:43], s99 offen offset:0 sc1
    v_mfma_f32_32x32x16_bf16 v[192:207], a[120:123], v[156:159], v[192:207]
    ds_read_b64_tr_b16 a[112:113], v10 offset:4096
    ds_read_b64_tr_b16 a[114:115], v10 offset:4608
    buffer_load_dwordx4 v[100:103], v1, s[40:43], s99 offen offset:1024 sc1
    s_waitcnt vmcnt(12) lgkmcnt(8)
    v_mfma_f32_32x32x16_bf16 v[48:63], a[92:95], v[160:163], v[48:63]
    ds_read_b64_tr_b16 a[116:117], v9 offset:6144
    ds_read_b64_tr_b16 a[118:119], v9 offset:6656
    buffer_load_dwordx4 v[104:107], v1, s[40:43], s99 offen offset:2048 sc1
    v_mfma_f32_32x32x16_bf16 v[192:207], a[96:99], v[160:163], v[192:207]
    ds_read_b64_tr_b16 a[120:121], v10 offset:6144
    ds_read_b64_tr_b16 a[122:123], v10 offset:6656
    buffer_load_dwordx4 v[108:111], v1, s[40:43], s99 offen offset:3072 sc1
    s_waitcnt vmcnt(13) lgkmcnt(8)
    v_mfma_f32_32x32x16_bf16 v[48:63], a[100:103], v[164:167], v[48:63]
    v_add_u32 v9, s10, v2
    ds_read_b64_tr_b16 a[92:93], v9 offset:0
    ds_read_b64_tr_b16 a[94:95], v9 offset:512
    v_mfma_f32_32x32x16_bf16 v[192:207], a[104:107], v[164:167], v[192:207]
    v_add_u32 v10, s10, v3
    ds_read_b64_tr_b16 a[96:97], v10 offset:0
    ds_read_b64_tr_b16 a[98:99], v10 offset:512
    s_waitcnt vmcnt(12) lgkmcnt(8)
    v_mfma_f32_32x32x16_bf16 v[48:63], a[108:111], v[168:171], v[48:63]
    ds_read_b64_tr_b16 a[100:101], v9 offset:2048
    ds_read_b64_tr_b16 a[102:103], v9 offset:2560
    v_mfma_f32_32x32x16_bf16 v[192:207], a[112:115], v[168:171], v[192:207]
    ds_read_b64_tr_b16 a[104:105], v10 offset:2048
    ds_read_b64_tr_b16 a[106:107], v10 offset:2560
    s_waitcnt vmcnt(11) lgkmcnt(8)
    v_mfma_f32_32x32x16_bf16 v[48:63], a[116:119], v[172:175], v[48:63]
    ds_read_b64_tr_b16 a[108:109], v9 offset:4096
    ds_read_b64_tr_b16 a[110:111], v9 offset:4608
    v_mfma_f32_32x32x16_bf16 v[192:207], a[120:123], v[172:175], v[192:207]
    ds_read_b64_tr_b16 a[112:113], v10 offset:4096
    ds_read_b64_tr_b16 a[114:115], v10 offset:4608
    s_waitcnt vmcnt(9) lgkmcnt(8)
    v_mfma_f32_32x32x16_bf16 v[48:63], a[92:95], v[176:179], v[48:63]
    ds_read_b64_tr_b16 a[116:117], v9 offset:6144
    ds_read_b64_tr_b16 a[118:119], v9 offset:6656
    v_mfma_f32_32x32x16_bf16 v[192:207], a[96:99], v[176:179], v[192:207]
    ds_read_b64_tr_b16 a[120:121], v10 offset:6144
    ds_read_b64_tr_b16 a[122:123], v10 offset:6656
    s_waitcnt vmcnt(8) lgkmcnt(8)
    v_mfma_f32_32x32x16_bf16 v[48:63], a[100:103], v[180:183], v[48:63]
    v_add_u32 v9, s11, v2
    ds_read_b64_tr_b16 a[92:93], v9 offset:0
    ds_read_b64_tr_b16 a[94:95], v9 offset:512
    v_mfma_f32_32x32x16_bf16 v[192:207], a[104:107], v[180:183], v[192:207]
    v_add_u32 v10, s11, v3
    ds_read_b64_tr_b16 a[96:97], v10 offset:0
    ds_read_b64_tr_b16 a[98:99], v10 offset:512
    s_waitcnt vmcnt(7) lgkmcnt(8)
    v_mfma_f32_32x32x16_bf16 v[48:63], a[108:111], v[184:187], v[48:63]
    ds_read_b64_tr_b16 a[100:101], v9 offset:2048
    ds_read_b64_tr_b16 a[102:103], v9 offset:2560
    v_cmp_eq_u32 s[22:23], s56, v27
    s_nop 0
    s_or_b32 s53, s53, s22
    s_mov_b32 s54, 0xffff01ff
    v_mfma_f32_32x32x16_bf16 v[192:207], a[112:115], v[184:187], v[192:207]
    ds_read_b64_tr_b16 a[104:105], v10 offset:2048
    ds_read_b64_tr_b16 a[106:107], v10 offset:2560
    s_getpc_b64 s[44:45]
    s_andn2_b32 s22, s53, s54
    s_cbranch_scc0 A_selslow1
    s_waitcnt vmcnt(6) lgkmcnt(8)
    v_mfma_f32_32x32x16_bf16 v[48:63], a[116:119], v[188:191], v[48:63]
    ds_read_b64_tr_b16 a[108:109], v9 offset:4096
    ds_read_b64_tr_b16 a[110:111], v9 offset:4608
    s_ff1_i32_b32 s22, s22
    s_bitset1_b32 s54, s22
    v_readlane_b32 s99, v19, s22
    v_readlane_b32 s9, v20, s22
    buffer_load_dword v27, v4, s[24:27], 0 offen sc1
    v_mfma_f32_32x32x16_bf16 v[192:207], a[120:123], v[188:191], v[192:207]
    ds_read_b32 v21, v22
    ds_read_b64_tr_b16 a[112:113], v10 offset:4096
    ds_read_b64_tr_b16 a[114:115], v10 offset:4608
    buffer_load_dwordx4 v[112:115], v1, s[4:7], s99 offen offset:0 sc1
    s_waitcnt vmcnt(5) lgkmcnt(9)
    v_mfma_f32_32x32x16_bf16 v[48:63], a[92:95], v[96:99], v[48:63]
    ds_read_b64_tr_b16 a[116:117], v9 offset:6144
    ds_read_b64_tr_b16 a[118:119], v9 offset:6656
    buffer_load_dwordx4 v[116:119], v1, s[4:7], s99 offen offset:1024 sc1
    v_mfma_f32_32x32x16_bf16 v[192:207], a[96:99], v[96:99], v[192:207]
    s_waitcnt lgkmcnt(4)
    s_add_u32 s59, s16, 37
    v_cmp_ge_u32 vcc, s59, v21
    ds_read_b64_tr_b16 a[120:121], v10 offset:6144
    ds_read_b64_tr_b16 a[122:123], v10 offset:6656
    buffer_load_dwordx4 v[120:123], v1, s[4:7], s99 offen offset:2048 sc1
    s_waitcnt vmcnt(6)
    v_mfma_f32_32x32x16_bf16 v[48:63], a[100:103], v[100:103], v[48:63]
    s_getpc_b64 s[44:45]
    s_cbranch_vccnz A_spin
    v_add_u32 v9, s97, v2
    ds_read_b64_tr_b16 a[92:93], v9 offset:0
    ds_read_b64_tr_b16 a[94:95], v9 offset:512
    buffer_load_dwordx4 v[124:127], v1, s[4:7], s99 offen offset:3072 sc1
    v_mfma_f32_32x32x16_bf16 v[192:207], a[104:107], v[100:103], v[192:207]
    v_add_u32 v10, s97, v3
    ds_read_b64_tr_b16 a[96:97], v10 offset:0
    ds_read_b64_tr_b16 a[98:99], v10 offset:512
    s_waitcnt vmcnt(6) lgkmcnt(8)
    v_mfma_f32_32x32x16_bf16 v[48:63], a[108:111], v[104:107], v[48:63]
    ds_read_b64_tr_b16 a[100:101], v9 offset:2048
    ds_read_b64_tr_b16 a[102:103], v9 offset:2560
    s_getpc_b64 s[44:45]
    s_andn2_b32 s22, s53, s54
    s_cbranch_scc0 A_selslow1
    v_mfma_f32_32x32x16_bf16 v[192:207], a[112:115], v[104:107], v[192:207]
    ds_read_b64_tr_b16 a[104:105], v10 offset:2048
    ds_read_b64_tr_b16 a[106:107], v10 offset:2560
    s_ff1_i32_b32 s22, s22
    s_bitset1_b32 s54, s22
    v_readlane_b32 s98, v19, s22
    v_readlane_b32 s10, v20, s22
    s_waitcnt vmcnt(5) lgkmcnt(8)
    v_mfma_f32_32x32x16_bf16 v[48:63], a[116:119], v[108:111], v[48:63]
    ds_read_b64_tr_b16 a[108:109], v9 offset:4096
    ds_read_b64_tr_b16 a[110:111], v9 offset:4608
    buffer_load_dwordx4 v[128:131], v1, s[4:7], s98 offen offset:0 sc1
    v_mfma_f32_32x32x16_bf16 v[192:207], a[120:123], v[108:111], v[192:207]
    ds_read_b32 v21, v22
    ds_read_b64_tr_b16 a[112:113], v10 offset:4096
    ds_read_b64_tr_b16 a[114:115], v10 offset:4608
    buffer_load_dwordx4 v[132:135], v1, s[4:7], s98 offen offset:1024 sc1
    s_waitcnt lgkmcnt(9)
    v_mfma_f32_32x32x16_bf16 v[48:63], a[92:95], v[64:67], v[48:63]
    ds_read_b64_tr_b16 a[116:117], v9 offset:6144
    ds_read_b64_tr_b16 a[118:119], v9 offset:6656
    buffer_load_dwordx4 v[136:139], v1, s[4:7], s98 offen offset:2048 sc1
    v_mfma_f32_32x32x16_bf16 v[192:207], a[96:99], v[64:67], v[192:207]
    s_waitcnt lgkmcnt(4)
    s_movk_i32 s59, 40
    v_cmp_ge_u32 vcc, s59, v21
    ds_read_b64_tr_b16 a[120:121], v10 offset:6144
    ds_read_b64_tr_b16 a[122:123], v10 offset:6656
    buffer_load_dwordx4 v[140:143], v1, s[4:7], s98 offen offset:3072 sc1
    v_mfma_f32_32x32x16_bf16 v[48:63], a[100:103], v[68:71], v[48:63]
    s_getpc_b64 s[44:45]
    s_cbranch_vccnz A_spin
    v_add_u32 v9, s9, v2
    ds_read_b64_tr_b16 a[92:93], v9 offset:0
    ds_read_b64_tr_b16 a[94:95], v9 offset:512
    v_mfma_f32_32x32x16_bf16 v[192:207], a[104:107], v[68:71], v[192:207]
    v_add_u32 v10, s9, v3
    ds_read_b64_tr_b16 a[96:97], v10 offset:0
    ds_read_b64_tr_b16 a[98:99], v10 offset:512
    s_waitcnt lgkmcnt(8)
    v_mfma_f32_32x32x16_bf16 v[48:63], a[108:111], v[72:75], v[48:63]
    ds_read_b64_tr_b16 a[100:101], v9 offset:2048
    ds_read_b64_tr_b16 a[102:103], v9 offset:2560
    s_waitcnt vmcnt(8)
    v_cmp_eq_u32 s[22:23], s56, v27
    s_nop 0
    s_or_b32 s53, s53, s22
    v_mfma_f32_32x32x16_bf16 v[192:207], a[112:115], v[72:75], v[192:207]
    ds_read_b64_tr_b16 a[104:105], v10 offset:2048
    ds_read_b64_tr_b16 a[106:107], v10 offset:2560
    s_getpc_b64 s[44:45]
    s_andn2_b32 s22, s53, s54
    s_cbranch_scc0 A_selslow1
    s_waitcnt lgkmcnt(8)
    v_mfma_f32_32x32x16_bf16 v[48:63], a[116:119], v[76:79], v[48:63]
    ds_read_b64_tr_b16 a[108:109], v9 offset:4096
    ds_read_b64_tr_b16 a[110:111], v9 offset:4608
    s_ff1_i32_b32 s22, s22
    s_bitset1_b32 s54, s22
    v_readlane_b32 s99, v19, s22
    v_readlane_b32 s11, v20, s22
    buffer_load_dword v27, v4, s[24:27], 0 offen sc1
    v_mfma_f32_32x32x16_bf16 v[192:207], a[120:123], v[76:79], v[192:207]
    ds_read_b64_tr_b16 a[112:113], v10 offset:4096
    ds_read_b64_tr_b16 a[114:115], v10 offset:4608
    buffer_load_dwordx4 v[144:147], v1, s[4:7], s99 offen offset:0 sc1
    s_waitcnt vmcnt(9) lgkmcnt(8)
    v_mfma_f32_32x32x16_bf16 v[48:63], a[92:95], v[112:115], v[48:63]
    ds_read_b64_tr_b16 a[116:117], v9 offset:6144
    ds_read_b64_tr_b16 a[118:119], v9 offset:6656
    buffer_load_dwordx4 v[148:151], v1, s[4:7], s99 offen offset:1024 sc1
    v_mfma_f32_32x32x16_bf16 v[192:207], a[96:99], v[112:115], v[192:207]
    ds_read_b64_tr_b16 a[120:121], v10 offset:6144
    ds_read_b64_tr_b16 a[122:123], v10 offset:6656
    buffer_load_dwordx4 v[152:155], v1, s[4:7], s99 offen offset:2048 sc1
    s_waitcnt vmcnt(10) lgkmcnt(8)
    v_mfma_f32_32x32x16_bf16 v[48:63], a[100:103], v[116:119], v[48:63]
    v_add_u32 v9, s10, v2
    ds_read_b64_tr_b16 a[92:93], v9 offset:0
    ds_read_b64_tr_b16 a[94:95], v9 offset:512
    buffer_load_dwordx4 v[156:159], v1, s[4:7], s99 offen offset:3072 sc1
    v_mfma_f32_32x32x16_bf16 v[192:207], a[104:107], v[116:119], v[192:207]
    v_add_u32 v10, s10, v3
    ds_read_b64_tr_b16 a[96:97], v10 offset:0
    ds_read_b64_tr_b16 a[98:99], v10 offset:512
    s_waitcnt vmcnt(10) lgkmcnt(8)
    v_mfma_f32_32x32x16_bf16 v[48:63], a[108:111], v[120:123], v[48:63]
    ds_read_b64_tr_b16 a[100:101], v9 offset:2048
    ds_read_b64_tr_b16 a[102:103], v9 offset:2560
    s_getpc_b64 s[44:45]
    s_andn2_b32 s22, s53, s54
    s_cbranch_scc0 A_selslow1
    v_mfma_f32_32x32x16_bf16 v[192:207], a[112:115], v[120:123], v[192:207]
    ds_read_b64_tr_b16 a[104:105], v10 offset:2048
    ds_read_b64_tr_b16 a[106:107], v10 offset:2560
    s_ff1_i32_b32 s22, s22
    s_bitset1_b32 s54, s22
    v_readlane_b32 s98, v19, s22
    v_readlane_b32 s8, v20, s22
    s_waitcnt vmcnt(9) lgkmcnt(8)
    v_mfma_f32_32x32x16_bf16 v[48:63], a[116:119], v[124:127], v[48:63]
    ds_read_b64_tr_b16 a[108:109], v9 offset:4096
    ds_read_b64_tr_b16 a[110:111], v9 offset:4608
    buffer_load_dwordx4 v[160:163], v1, s[4:7], s98 offen offset:0 sc1
    v_mfma_f32_32x32x16_bf16 v[192:207], a[120:123], v[124:127], v[192:207]
    ds_read_b64_tr_b16 a[112:113], v10 offset:4096
    ds_read_b64_tr_b16 a[114:115], v10 offset:4608
    buffer_load_dwordx4 v[164:167], v1, s[4:7], s98 offen offset:1024 sc1
    s_waitcnt vmcnt(10) lgkmcnt(8)
    v_mfma_f32_32x32x16_bf16 v[48:63], a[92:95], v[128:131], v[48:63]
    ds_read_b64_tr_b16 a[116:117], v9 offset:6144
    ds_read_b64_tr_b16 a[118:119], v9 offset:6656
    buffer_load_dwordx4 v[168:171], v1, s[4:7], s98 offen offset:2048 sc1
    v_mfma_f32_32x32x16_bf16 v[192:207], a[96:99], v[128:131], v[192:207]
    ds_read_b64_tr_b16 a[120:121], v10 offset:6144
    ds_read_b64_tr_b16 a[122:123], v10 offset:6656
    buffer_load_dwordx4 v[172:175], v1, s[4:7], s98 offen offset:3072 sc1
    s_waitcnt vmcnt(11) lgkmcnt(8)
    v_mfma_f32_32x32x16_bf16 v[48:63], a[100:103], v[132:135], v[48:63]
    v_add_u32 v9, s11, v2
    ds_read_b64_tr_b16 a[92:93], v9 offset:0
    ds_read_b64_tr_b16 a[94:95], v9 offset:512
    v_mfma_f32_32x32x16_bf16 v[192:207], a[104:107], v[132:135], v[192:207]
    v_add_u32 v10, s11, v3
    ds_read_b64_tr_b16 a[96:97], v10 offset:0
    ds_read_b64_tr_b16 a[98:99], v10 offset:512
    s_waitcnt vmcnt(10) lgkmcnt(8)
    v_mfma_f32_32x32x16_bf16 v[48:63], a[108:111], v[136:139], v[48:63]
    ds_read_b64_tr_b16 a[100:101], v9 offset:2048
    ds_read_b64_tr_b16 a[102:103], v9 offset:2560
    s_waitcnt vmcnt(8)
    v_cmp_eq_u32 s[22:23], s56, v27
    s_nop 0
    s_or_b32 s53, s53, s22
    v_mfma_f32_32x32x16_bf16 v[192:207], a[112:115], v[136:139], v[192:207]
    ds_read_b64_tr_b16 a[104:105], v10 offset:2048
    ds_read_b64_tr_b16 a[106:107], v10 offset:2560
    s_getpc_b64 s[44:45]
    s_andn2_b32 s22, s53, s54
    s_cbranch_scc0 A_selslow1
    s_waitcnt lgkmcnt(8)
    v_mfma_f32_32x32x16_bf16 v[48:63], a[116:119], v[140:143], v[48:63]
    ds_read_b64_tr_b16 a[108:109], v9 offset:4096
    ds_read_b64_tr_b16 a[110:111], v9 offset:4608
    s_ff1_i32_b32 s22, s22
    s_bitset1_b32 s54, s22
    v_readlane_b32 s99, v19, s22
    v_readlane_b32 s9, v20, s22
    buffer_load_dword v27, v4, s[24:27], 0 offen sc1
    v_mfma_f32_32x32x16_bf16 v[192:207], a[120:123], v[140:143], v[192:207]
    ds_read_b64_tr_b16 a[112:113], v10 offset:4096
    ds_read_b64_tr_b16 a[114:115], v10 offset:4608
    buffer_load_dwordx4 v[176:179], v1, s[4:7], s99 offen offset:0 sc1
    s_waitcnt vmcnt(9) lgkmcnt(8)
    v_mfma_f32_32x32x16_bf16 v[48:63], a[92:95], v[144:147], v[48:63]
    ds_read_b64_tr_b16 a[116:117], v9 offset:6144
    ds_read_b64_tr_b16 a[118:119], v9 offset:6656
    buffer_load_dwordx4 v[180:183], v1, s[4:7], s99 offen offset:1024 sc1
    v_mfma_f32_32x32x16_bf16 v[192:207], a[96:99], v[144:147], v[192:207]
    ds_read_b64_tr_b16 a[120:121], v10 offset:6144
    ds_read_b64_tr_b16 a[122:123], v10 offset:6656
    buffer_load_dwordx4 v[184:187], v1, s[4:7], s99 offen offset:2048 sc1
    s_waitcnt vmcnt(10) lgkmcnt(8)
    v_mfma_f32_32x32x16_bf16 v[48:63], a[100:103], v[148:151], v[48:63]
    v_add_u32 v9, s8, v2
    ds_read_b64_tr_b16 a[92:93], v9 offset:0
    ds_read_b64_tr_b16 a[94:95], v9 offset:512
    buffer_load_dwordx4 v[188:191], v1, s[4:7], s99 offen offset:3072 sc1
    v_mfma_f32_32x32x16_bf16 v[192:207], a[104:107], v[148:151], v[192:207]
    v_add_u32 v10, s8, v3
    ds_read_b64_tr_b16 a[96:97], v10 offset:0
    ds_read_b64_tr_b16 a[98:99], v10 offset:512
    s_getpc_b64 s[44:45]
    s_andn2_b32 s22, s53, s54
    s_cbranch_scc0 A_selslow1
    s_waitcnt vmcnt(10) lgkmcnt(8)
    v_mfma_f32_32x32x16_bf16 v[48:63], a[108:111], v[152:155], v[48:63]
    ds_read_b64_tr_b16 a[100:101], v9 offset:2048
    ds_read_b64_tr_b16 a[102:103], v9 offset:2560
    s_ff1_i32_b32 s22, s22
    s_bitset1_b32 s54, s22
    v_readlane_b32 s98, v19, s22
    v_readlane_b32 s10, v20, s22
    v_mfma_f32_32x32x16_bf16 v[192:207], a[112:115], v[152:155], v[192:207]
    ds_read_b64_tr_b16 a[104:105], v10 offset:2048
    ds_read_b64_tr_b16 a[106:107], v10 offset:2560
    s_nop 0
    buffer_load_dwordx4 v[96:99], v1, s[4:7], s98 offen offset:0 sc1
    s_waitcnt vmcnt(10) lgkmcnt(8)
    v_mfma_f32_32x32x16_bf16 v[48:63], a[116:119], v[156:159], v[48:63]
    ds_read_b64_tr_b16 a[108:109], v9 offset:4096
    ds_read_b64_tr_b16 a[110:111], v9 offset:4608
    buffer_load_dwordx4 v[100:103], v1, s[4:7], s98 offen offset:1024 sc1
    v_mfma_f32_32x32x16_bf16 v[192:207], a[120:123], v[156:159], v[192:207]
    ds_read_b64_tr_b16 a[112:113], v10 offset:4096
    ds_read_b64_tr_b16 a[114:115], v10 offset:4608
    buffer_load_dwordx4 v[104:107], v1, s[4:7], s98 offen offset:2048 sc1
    s_waitcnt vmcnt(11) lgkmcnt(8)
    v_mfma_f32_32x32x16_bf16 v[48:63], a[92:95], v[160:163], v[48:63]
    ds_read_b64_tr_b16 a[116:117], v9 offset:6144
    ds_read_b64_tr_b16 a[118:119], v9 offset:6656
    buffer_load_dwordx4 v[108:111], v1, s[4:7], s98 offen offset:3072 sc1
    v_mfma_f32_32x32x16_bf16 v[192:207], a[96:99], v[160:163], v[192:207]
    ds_read_b64_tr_b16 a[120:121], v10 offset:6144
    ds_read_b64_tr_b16 a[122:123], v10 offset:6656
    s_waitcnt vmcnt(8)
    v_cmp_eq_u32 s[22:23], s56, v27
    s_nop 0
    s_or_b32 s53, s53, s22
    s_getpc_b64 s[44:45]
    s_andn2_b32 s22, s53, s54
    s_cbranch_scc0 A_selslow1
    s_waitcnt lgkmcnt(8)
    v_mfma_f32_32x32x16_bf16 v[48:63], a[100:103], v[164:167], v[48:63]
    v_add_u32 v9, s9, v2
    ds_read_b64_tr_b16 a[92:93], v9 offset:0
    ds_read_b64_tr_b16 a[94:95], v9 offset:512
    s_ff1_i32_b32 s22, s22
    s_bitset1_b32 s54, s22
    v_readlane_b32 s99, v19, s22
    v_readlane_b32 s11, v20, s22
    v_mfma_f32_32x32x16_bf16 v[192:207], a[104:107], v[164:167], v[192:207]
    ds_read_b64_tr_b16 a[96:97], v9 offset:2048
    ds_read_b64_tr_b16 a[98:99], v9 offset:2560
    s_nop 0
    buffer_load_dwordx4 v[112:115], v1, s[4:7], s99 offen offset:0 sc1
    buffer_load_dwordx4 v[116:119], v1, s[4:7], s99 offen offset:1024 sc1
    s_waitcnt lgkmcnt(8)
    v_mfma_f32_32x32x16_bf16 v[48:63], a[108:111], v[168:171], v[48:63]
    ds_read_b64_tr_b16 a[100:101], v9 offset:4096
    ds_read_b64_tr_b16 a[102:103], v9 offset:4608
    buffer_load_dwordx4 v[120:123], v1, s[4:7], s99 offen offset:2048 sc1
    buffer_load_dwordx4 v[124:127], v1, s[4:7], s99 offen offset:3072 sc1
    v_mfma_f32_32x32x16_bf16 v[192:207], a[112:115], v[168:171], v[192:207]
    ds_read_b64_tr_b16 a[104:105], v9 offset:6144
    ds_read_b64_tr_b16 a[106:107], v9 offset:6656
    s_waitcnt lgkmcnt(8)
    v_mfma_f32_32x32x16_bf16 v[48:63], a[116:119], v[172:175], v[48:63]
    v_add_u32 v9, s10, v2
    ds_read_b64_tr_b16 a[108:109], v9 offset:0
    ds_read_b64_tr_b16 a[110:111], v9 offset:512
    v_mfma_f32_32x32x16_bf16 v[192:207], a[120:123], v[172:175], v[192:207]
    ds_read_b64_tr_b16 a[112:113], v9 offset:2048
    ds_read_b64_tr_b16 a[114:115], v9 offset:2560
    s_waitcnt vmcnt(11) lgkmcnt(8)
    v_mfma_f32_32x32x16_bf16 v[48:63], a[92:95], v[176:179], v[48:63]
    ds_read_b64_tr_b16 a[116:117], v9 offset:4096
    ds_read_b64_tr_b16 a[118:119], v9 offset:4608
    s_waitcnt vmcnt(10)
    v_mfma_f32_32x32x16_bf16 v[48:63], a[96:99], v[180:183], v[48:63]
    ds_read_b64_tr_b16 a[120:121], v9 offset:6144
    ds_read_b64_tr_b16 a[122:123], v9 offset:6656
    s_waitcnt vmcnt(9) lgkmcnt(8)
    v_mfma_f32_32x32x16_bf16 v[48:63], a[100:103], v[184:187], v[48:63]
    v_add_u32 v9, s11, v2
    ds_read_b64_tr_b16 a[92:93], v9 offset:0
    ds_read_b64_tr_b16 a[94:95], v9 offset:512
    s_waitcnt vmcnt(8)
    v_mfma_f32_32x32x16_bf16 v[48:63], a[104:107], v[188:191], v[48:63]
    ds_read_b64_tr_b16 a[96:97], v9 offset:2048
    ds_read_b64_tr_b16 a[98:99], v9 offset:2560
    s_waitcnt vmcnt(7) lgkmcnt(8)
    v_mfma_f32_32x32x16_bf16 v[48:63], a[108:111], v[96:99], v[48:63]
    ds_read_b64_tr_b16 a[100:101], v9 offset:4096
    ds_read_b64_tr_b16 a[102:103], v9 offset:4608
    s_waitcnt vmcnt(6)
    v_mfma_f32_32x32x16_bf16 v[48:63], a[112:115], v[100:103], v[48:63]
    ds_read_b64_tr_b16 a[104:105], v9 offset:6144
    ds_read_b64_tr_b16 a[106:107], v9 offset:6656
    s_waitcnt vmcnt(5) lgkmcnt(8)
    v_mfma_f32_32x32x16_bf16 v[48:63], a[116:119], v[104:107], v[48:63]
    v_add_u32 v10, s9, v3
    ds_read_b64_tr_b16 a[108:109], v10 offset:0
    ds_read_b64_tr_b16 a[110:111], v10 offset:512
    s_waitcnt vmcnt(4)
    v_mfma_f32_32x32x16_bf16 v[48:63], a[120:123], v[108:111], v[48:63]
    ds_read_b64_tr_b16 a[112:113], v10 offset:2048
    ds_read_b64_tr_b16 a[114:115], v10 offset:2560
    s_waitcnt vmcnt(3) lgkmcnt(8)
    v_mfma_f32_32x32x16_bf16 v[48:63], a[92:95], v[112:115], v[48:63]
    ds_read_b64_tr_b16 a[116:117], v10 offset:4096
    ds_read_b64_tr_b16 a[118:119], v10 offset:4608
    s_waitcnt vmcnt(2)
    v_mfma_f32_32x32x16_bf16 v[48:63], a[96:99], v[116:119], v[48:63]
    ds_read_b64_tr_b16 a[120:121], v10 offset:6144
    ds_read_b64_tr_b16 a[122:123], v10 offset:6656
    s_waitcnt vmcnt(1) lgkmcnt(8)
    v_mfma_f32_32x32x16_bf16 v[48:63], a[100:103], v[120:123], v[48:63]
    v_add_u32 v10, s10, v3
    ds_read_b64_tr_b16 a[92:93], v10 offset:0
    ds_read_b64_tr_b16 a[94:95], v10 offset:512
    s_waitcnt vmcnt(0)
    v_mfma_f32_32x32x16_bf16 v[48:63], a[104:107], v[124:127], v[48:63]
    ds_read_b64_tr_b16 a[96:97], v10 offset:2048
    ds_read_b64_tr_b16 a[98:99], v10 offset:2560
    s_waitcnt lgkmcnt(8)
    v_mfma_f32_32x32x16_bf16 v[192:207], a[108:111], v[176:179], v[192:207]
    ds_read_b64_tr_b16 a[100:101], v10 offset:4096
    ds_read_b64_tr_b16 a[102:103], v10 offset:4608
    v_mfma_f32_32x32x16_bf16 v[192:207], a[112:115], v[180:183], v[192:207]
    ds_read_b64_tr_b16 a[104:105], v10 offset:6144
    ds_read_b64_tr_b16 a[106:107], v10 offset:6656
    buffer_load_dword v30, v13, s[28:31], s37 offen offset:384 sc1
    s_waitcnt lgkmcnt(8)
    v_mfma_f32_32x32x16_bf16 v[192:207], a[116:119], v[184:187], v[192:207]
    v_add_u32 v10, s11, v3
    ds_read_b64_tr_b16 a[108:109], v10 offset:0
    ds_read_b64_tr_b16 a[110:111], v10 offset:512
    v_mov_b32_sdwa v48, v8 dst_sel:BYTE_0 dst_unused:UNUSED_PRESERVE src0_sel:BYTE_0
    v_mov_b32_sdwa v52, v8 dst_sel:BYTE_0 dst_unused:UNUSED_PRESERVE src0_sel:BYTE_0
    v_mov_b32_sdwa v56, v8 dst_sel:BYTE_0 dst_unused:UNUSED_PRESERVE src0_sel:BYTE_0
    v_mov_b32_sdwa v60, v8 dst_sel:BYTE_0 dst_unused:UNUSED_PRESERVE src0_sel:BYTE_0
    v_mfma_f32_32x32x16_bf16 v[192:207], a[120:123], v[188:191], v[192:207]
    ds_read_b64_tr_b16 a[112:113], v10 offset:2048
    ds_read_b64_tr_b16 a[114:115], v10 offset:2560
    s_not_b32 exec_lo, s13
    s_not_b32 exec_hi, s13
    buffer_store_dwordx4 v[48:51], v6, s[28:31], s36 offen offset:0 sc1
    buffer_store_dwordx4 v[52:55], v6, s[28:31], s36 offen offset:256 sc1
    buffer_store_dwordx4 v[56:59], v6, s[28:31], s36 offen offset:512 sc1
    buffer_store_dwordx4 v[60:63], v6, s[28:31], s36 offen offset:768 sc1
    s_mov_b64 exec, -1
    s_waitcnt lgkmcnt(8)
    v_mfma_f32_32x32x16_bf16 v[192:207], a[92:95], v[96:99], v[192:207]
    ds_read_b64_tr_b16 a[116:117], v10 offset:4096
    ds_read_b64_tr_b16 a[118:119], v10 offset:4608
    v_mfma_f32_32x32x16_bf16 v[192:207], a[96:99], v[100:103], v[192:207]
    ds_read_b64_tr_b16 a[120:121], v10 offset:6144
    ds_read_b64_tr_b16 a[122:123], v10 offset:6656
    s_waitcnt lgkmcnt(8)
    v_mfma_f32_32x32x16_bf16 v[192:207], a[100:103], v[104:107], v[192:207]
    v_mfma_f32_32x32x16_bf16 v[192:207], a[104:107], v[108:111], v[192:207]
    s_waitcnt lgkmcnt(4)
    v_mfma_f32_32x32x16_bf16 v[192:207], a[108:111], v[112:115], v[192:207]
    v_mfma_f32_32x32x16_bf16 v[192:207], a[112:115], v[116:119], v[192:207]
    s_waitcnt lgkmcnt(0)
    v_mfma_f32_32x32x16_bf16 v[192:207], a[116:119], v[120:123], v[192:207]
    s_mov_b32 exec_lo, s13
    s_mov_b32 exec_hi, s13
    ds_write_b128 v11, v[48:51] offset:0
    ds_write_b128 v11, v[52:55] offset:256
    ds_write_b128 v11, v[56:59] offset:512
    ds_write_b128 v11, v[60:63] offset:768
    s_mov_b64 exec, -1
    v_mfma_f32_32x32x16_bf16 v[192:207], a[120:123], v[124:127], v[192:207]
    s_branch A_tail
A_decide:
    ds_read_b32 v25, v22 offset:4
    s_waitcnt vmcnt(2)
    v_cmp_eq_u32 s[22:23], s56, v27
    s_nop 0
    s_or_b32 s53, s53, s22
    s_and_b32 s22, s53, 0xfe
    s_bcnt1_i32_b32 s22, s22
    s_waitcnt lgkmcnt(0)
    v_readfirstlane_b32 s23, v25
    s_nop 0
    s_mul_i32 s22, s22, s23
    s_cmp_ge_u32 s22, 1
    s_cbranch_scc1 A_late
    s_branch A_spin
A_codeend:
.section .rodata,"a"
.p2align 6
.amdhsa_kernel standalone__mha_block_cached__near_ridge_kernel
  .amdhsa_next_free_vgpr 512
  .amdhsa_next_free_sgpr 102
  .amdhsa_accum_offset 256
  .amdhsa_group_segment_fixed_size 0
  .amdhsa_kernarg_size 64
  .amdhsa_user_sgpr_count 2
  .amdhsa_user_sgpr_kernarg_segment_ptr 1
  .amdhsa_system_sgpr_workgroup_id_x 1
.end_amdhsa_kernel
```
